```python
import torch

def _softmax(x, axis=-1):
    return torch.softmax(x, dim=axis)
def _gelu(x):
    return torch.nn.functional.gelu(x, approximate="tanh")
def _silu(x):
    return torch.nn.functional.silu(x)
def _sigmoid(x):
    return torch.sigmoid(x)
def _layernorm(x, axis=-1, eps=1e-5):
    m = x.mean(dim=axis, keepdim=True)
    v = x.var(dim=axis, keepdim=True, unbiased=False)
    return (x - m) / torch.sqrt(v + eps)
def _scatter_add(tgt, idx, src, axis=0):
    return tgt.clone().index_add_(axis, idx, src)
def _segment_sum(src, seg, n):
    out = torch.zeros((n,) + src.shape[1:], dtype=src.dtype)
    return out.index_add_(0, seg, src)
def _pad(x, pw):
    flat = tuple(v for pair in reversed(pw) for v in pair)
    return torch.nn.functional.pad(x, flat)

kernel_name = 'concat_heads__gqa_block_cached__mha_block_cached__near_ridge'

def setup_inputs():

    _w = (lambda a: (lambda t: t.to(torch.bfloat16) if t.is_floating_point() else t)(torch.as_tensor(a)))
    def _A_setup():
        B, Sq, D = 16, 32, 1024
        Hq, Hkv, Sk, Dh = 32, 4, 512, 128
        assert Hq % Hkv == 0, (Hq, Hkv)
        return {
            "x": _w((lambda *s: torch.randn(*s, dtype=torch.bfloat16) * 0.8)(B, Sq, D)),
            "k_cache": _w((lambda *s: torch.randn(*s, dtype=torch.bfloat16) * 0.8)(B, Hkv, Sk, Dh)),
            "v_cache": _w((lambda *s: torch.randn(*s, dtype=torch.bfloat16) * 0.05)(B, Hkv, Sk, Dh)),
            "wq": _w((lambda *s: torch.randn(*s, dtype=torch.bfloat16) * 0.8)(D, Hq * Dh) * (D ** -0.5)),
            "wo": _w((lambda *s: torch.randn(*s, dtype=torch.bfloat16) * 0.05)(Hq * Dh, D) * ((Hq * Dh) ** -0.5)),
        }
    _A_in = _A_setup()

    def _B_setup():
        B, Sq, D = 16, 32, 1024
        H, Sk, Dh = 32, 512, 128
        return {
            "x": _w((lambda *s: torch.randn(*s, dtype=torch.bfloat16) * 0.8)(B, Sq, D)),
            "k_cache": _w((lambda *s: torch.randn(*s, dtype=torch.bfloat16) * 0.8)(B, H, Sk, Dh)),
            "v_cache": _w((lambda *s: torch.randn(*s, dtype=torch.bfloat16) * 0.05)(B, H, Sk, Dh)),
            "wq": _w((lambda *s: torch.randn(*s, dtype=torch.bfloat16) * 0.8)(D, H * Dh) * (D ** -0.5)),
            "wo": _w((lambda *s: torch.randn(*s, dtype=torch.bfloat16) * 0.05)(H * Dh, D) * ((H * Dh) ** -0.5)),
        }
    _B_in = _B_setup()

    return {
        "A_x": _A_in["x"],
        "A_k_cache": _A_in["k_cache"],
        "A_v_cache": _A_in["v_cache"],
        "A_wq": _A_in["wq"],
        "A_wo": _A_in["wo"],
        "B_x": _B_in["x"],
        "B_k_cache": _B_in["k_cache"],
        "B_v_cache": _B_in["v_cache"],
        "B_wq": _B_in["wq"],
        "B_wo": _B_in["wo"],
    }

def reference(A_x, A_k_cache, A_v_cache, A_wq, A_wo, B_x, B_k_cache, B_v_cache, B_wq, B_wo):
    def _A_ref(x, k_cache, v_cache, wq, wo):
        B, Sq, D = x.shape
        Hq, Dh = 32, 128
        Hkv = k_cache.shape[1]
        rep = Hq // Hkv
        q = (lambda x, *d: x.permute(*d))((x @ wq).reshape(B, Sq, Hq, Dh), 0, 2, 1, 3)
        k = (lambda x, n, axis: torch.repeat_interleave(x, n, dim=axis))(k_cache, rep, axis=1)
        v = (lambda x, n, axis: torch.repeat_interleave(x, n, dim=axis))(v_cache, rep, axis=1)
        scores = torch.einsum("bhqd,bhkd->bhqk", q, k) * (Dh ** -0.5)
        p = _softmax(scores, axis=-1)
        o = torch.einsum("bhqk,bhkd->bhqd", p, v)
        return (lambda x, *d: x.permute(*d))(o, 0, 2, 1, 3).reshape(B, Sq, Hq * Dh) @ wo

    def _B_ref(x, k_cache, v_cache, wq, wo):
        B, Sq, D = x.shape
        H, Dh = 32, 128
        q = (lambda x, *d: x.permute(*d))((x @ wq).reshape(B, Sq, H, Dh), 0, 2, 1, 3)
        scores = torch.einsum("bhqd,bhkd->bhqk", q, k_cache) * (Dh ** -0.5)
        p = _softmax(scores, axis=-1)
        o = torch.einsum("bhqk,bhkd->bhqd", p, v_cache)
        return (lambda x, *d: x.permute(*d))(o, 0, 2, 1, 3).reshape(B, Sq, H * Dh) @ wo

    a = _A_ref(A_x, A_k_cache, A_v_cache, A_wq, A_wo)
    b = _B_ref(B_x, B_k_cache, B_v_cache, B_wq, B_wo)
    return torch.concatenate([a, b], axis=-1)
```

```asm
; @launch grid=(256,1,1) block=(256,1,1) lds=163840
.amdgcn_target "amdgcn-amd-amdhsa--gfx950"
.text
.globl concat_heads__gqa_block_cached__mha_block_cached__near_ridge_kernel
.p2align 8
.type concat_heads__gqa_block_cached__mha_block_cached__near_ridge_kernel,@function
concat_heads__gqa_block_cached__mha_block_cached__near_ridge_kernel:
    s_cmp_ge_u32 s2, 256
    s_cbranch_scc1 L_end
    s_load_dwordx16 s[16:31], s[0:1], 0
    s_load_dwordx8 s[32:39], s[0:1], 64
    s_load_dwordx2 s[40:41], s[0:1], 96
    v_lshrrev_b32 v1, 6, v0
    v_and_b32 v0, 63, v0
    s_nop 0
    v_readfirstlane_b32 s3, v1
    s_and_b32 s42, s2, 7
    s_lshr_b32 s43, s2, 3
    s_and_b32 s44, s43, 1
    s_lshr_b32 s43, s43, 1
    s_mul_i32 s45, s3, 40960
    s_mov_b32 s71, 0x3e0293ee
    s_mov_b32 s46, 0
    s_waitcnt lgkmcnt(0)

    s_mov_b32 s48, s38
    s_mov_b32 s49, s39
    s_mov_b32 s50, 0x100
    s_mov_b32 s51, 0x00020000
    s_add_u32 s96, s40, 0x1400000
    s_addc_u32 s97, s41, 0
    s_mov_b32 s98, 0x10000
    s_mov_b32 s99, 0x00020000
    s_cmp_lg_u32 s3, 0
    s_cbranch_scc1 L_z_1
    v_lshlrev_b32 v1, 2, v0
    v_mov_b32 v2, 0
    s_lshl_b32 s68, s2, 8
    buffer_store_dword v2, v1, s[96:99], s68 offen sc1

L_z_1:
    s_mov_b32 s52, s32
    s_mov_b32 s53, s33
    s_mov_b32 s54, 0x800000
    s_mov_b32 s55, 0x00020000
    s_mov_b32 s56, s26
    s_mov_b32 s57, s27
    s_mov_b32 s58, 0x100000
    s_mov_b32 s59, 0x00020000
    s_lshr_b32 s68, s2, 3
    s_lshl_b32 s68, s68, 2
    s_add_u32 s68, s68, s3
    s_lshl_b32 s69, s68, 16
    s_lshl_b32 s70, s42, 10
    s_add_u32 s69, s69, s70
    s_lshl_b32 s70, s68, 13
    v_lshlrev_b32 v1, 4, v0

    s_add_u32 s68, s69, 0
    buffer_load_dwordx4 v[168:171], v1, s[52:55], s68 offen
    s_add_u32 s68, s69, 8192
    buffer_load_dwordx4 v[172:175], v1, s[52:55], s68 offen
    s_add_u32 s68, s69, 16384
    buffer_load_dwordx4 v[176:179], v1, s[52:55], s68 offen
    s_add_u32 s68, s69, 24576
    buffer_load_dwordx4 v[180:183], v1, s[52:55], s68 offen
    s_add_u32 s68, s69, 32768
    buffer_load_dwordx4 v[184:187], v1, s[52:55], s68 offen
    s_add_u32 s68, s69, 40960
    buffer_load_dwordx4 v[188:191], v1, s[52:55], s68 offen
    s_add_u32 s68, s69, 49152
    buffer_load_dwordx4 v[192:195], v1, s[52:55], s68 offen
    s_add_u32 s68, s69, 57344
    buffer_load_dwordx4 v[196:199], v1, s[52:55], s68 offen
    s_add_u32 s68, s70, 0
    buffer_load_dwordx4 v[200:203], v1, s[56:59], s68 offen offset:0
    s_add_u32 s68, s70, 0
    buffer_load_dwordx4 v[204:207], v1, s[56:59], s68 offen offset:1024
    s_add_u32 s68, s70, 0
    buffer_load_dwordx4 v[208:211], v1, s[56:59], s68 offen offset:2048
    s_add_u32 s68, s70, 0
    buffer_load_dwordx4 v[212:215], v1, s[56:59], s68 offen offset:3072
    s_add_u32 s68, s70, 4096
    buffer_load_dwordx4 v[216:219], v1, s[56:59], s68 offen offset:0
    s_add_u32 s68, s70, 4096
    buffer_load_dwordx4 v[220:223], v1, s[56:59], s68 offen offset:1024
    s_add_u32 s68, s70, 4096
    buffer_load_dwordx4 v[224:227], v1, s[56:59], s68 offen offset:2048
    s_add_u32 s68, s70, 4096
    buffer_load_dwordx4 v[228:231], v1, s[56:59], s68 offen offset:3072
    s_lshl_b32 s5, s42, 2
    s_and_b32 s68, s43, 3
    s_add_u32 s5, s5, s68
    s_lshr_b32 s4, s43, 2
    s_cmp_eq_u32 s44, 1
    s_cbranch_scc1 L_worker

    s_lshl_b32 s6, s4, 2
    s_add_u32 s6, s6, s3
    s_lshl_b32 s7, s6, 5
    s_add_u32 s7, s7, s5
    s_mov_b32 s9, 0

    s_lshl_b32 s68, s7, 17
    s_add_u32 s52, s28, s68
    s_addc_u32 s53, s29, 0
    s_mov_b32 s54, 0x20000
    s_mov_b32 s55, 0x00020000
    s_add_u32 s56, s30, s68
    s_addc_u32 s57, s31, 0
    s_mov_b32 s58, 0x20000
    s_mov_b32 s59, 0x00020000
    s_add_u32 s60, s40, 0x800000
    s_addc_u32 s61, s41, 0
    s_mov_b32 s62, 0x400000
    s_mov_b32 s63, 0x00020000
    s_add_u32 s64, s40, 0x400000
    s_addc_u32 s65, s41, 0
    s_mov_b32 s66, 0x400000
    s_mov_b32 s67, 0x00020000
    s_mov_b32 s88, s45
    s_lshl_b32 s89, s3, 11
    v_lshrrev_b32 v32, 4, v0
    v_and_b32 v33, 15, v0
    v_lshlrev_b32 v36, 2, v32
    v_xor_b32 v36, v36, v33
    v_lshlrev_b32 v36, 4, v36
    v_lshl_add_u32 v8, v32, 8, v36
    v_xor_b32 v36, v33, v32
    v_lshlrev_b32 v36, 4, v36
    v_lshl_add_u32 v4, v32, 8, v36

    v_xor_b32 v5, 64, v4
    v_xor_b32 v6, 0x80, v4
    v_xor_b32 v7, 0xc0, v4

    s_add_u32 s69, s9, 0
    s_and_b32 s69, s69, 15
    s_lshl_b32 s69, s69, 13
    s_add_u32 m0, s88, 0
    s_add_u32 s68, s69, 0
    buffer_load_dwordx4 v4, s[52:55], s68 offen offset:0 nt lds
    buffer_load_dwordx4 v5, s[52:55], s68 offen offset:1024 nt lds
    buffer_load_dwordx4 v6, s[52:55], s68 offen offset:2048 nt lds
    buffer_load_dwordx4 v7, s[52:55], s68 offen offset:3072 nt lds
    s_add_u32 m0, s88, 4096
    s_add_u32 s68, s69, 4096
    buffer_load_dwordx4 v4, s[52:55], s68 offen offset:0 nt lds
    buffer_load_dwordx4 v5, s[52:55], s68 offen offset:1024 nt lds
    buffer_load_dwordx4 v6, s[52:55], s68 offen offset:2048 nt lds
    buffer_load_dwordx4 v7, s[52:55], s68 offen offset:3072 nt lds
    s_add_u32 s69, s9, 1
    s_and_b32 s69, s69, 15
    s_lshl_b32 s69, s69, 13
    s_add_u32 m0, s88, 8192
    s_add_u32 s68, s69, 0
    buffer_load_dwordx4 v4, s[52:55], s68 offen offset:0 nt lds
    buffer_load_dwordx4 v5, s[52:55], s68 offen offset:1024 nt lds
    buffer_load_dwordx4 v6, s[52:55], s68 offen offset:2048 nt lds
    buffer_load_dwordx4 v7, s[52:55], s68 offen offset:3072 nt lds
    s_add_u32 m0, s88, 12288
    s_add_u32 s68, s69, 4096
    buffer_load_dwordx4 v4, s[52:55], s68 offen offset:0 nt lds
    buffer_load_dwordx4 v5, s[52:55], s68 offen offset:1024 nt lds
    buffer_load_dwordx4 v6, s[52:55], s68 offen offset:2048 nt lds
    buffer_load_dwordx4 v7, s[52:55], s68 offen offset:3072 nt lds
    s_add_u32 s69, s9, 2
    s_and_b32 s69, s69, 15
    s_lshl_b32 s69, s69, 13
    s_add_u32 m0, s88, 16384
    s_add_u32 s68, s69, 0
    buffer_load_dwordx4 v4, s[52:55], s68 offen offset:0 nt lds
    buffer_load_dwordx4 v5, s[52:55], s68 offen offset:1024 nt lds
    buffer_load_dwordx4 v6, s[52:55], s68 offen offset:2048 nt lds
    buffer_load_dwordx4 v7, s[52:55], s68 offen offset:3072 nt lds
    s_add_u32 m0, s88, 20480
    s_add_u32 s68, s69, 4096
    buffer_load_dwordx4 v4, s[52:55], s68 offen offset:0 nt lds
    buffer_load_dwordx4 v5, s[52:55], s68 offen offset:1024 nt lds
    buffer_load_dwordx4 v6, s[52:55], s68 offen offset:2048 nt lds
    buffer_load_dwordx4 v7, s[52:55], s68 offen offset:3072 nt lds
    s_add_u32 s69, s9, 3
    s_and_b32 s69, s69, 15
    s_lshl_b32 s69, s69, 13
    s_add_u32 m0, s88, 24576
    s_add_u32 s68, s69, 0
    buffer_load_dwordx4 v4, s[52:55], s68 offen offset:0 nt lds
    buffer_load_dwordx4 v5, s[52:55], s68 offen offset:1024 nt lds
    buffer_load_dwordx4 v6, s[52:55], s68 offen offset:2048 nt lds
    buffer_load_dwordx4 v7, s[52:55], s68 offen offset:3072 nt lds
    s_add_u32 m0, s88, 28672
    s_add_u32 s68, s69, 4096
    buffer_load_dwordx4 v4, s[52:55], s68 offen offset:0 nt lds
    buffer_load_dwordx4 v5, s[52:55], s68 offen offset:1024 nt lds
    buffer_load_dwordx4 v6, s[52:55], s68 offen offset:2048 nt lds
    buffer_load_dwordx4 v7, s[52:55], s68 offen offset:3072 nt lds
    s_add_u32 s69, s9, 4
    s_and_b32 s69, s69, 15
    s_lshl_b32 s69, s69, 13
    s_add_u32 m0, s88, 32768
    s_add_u32 s68, s69, 0
    buffer_load_dwordx4 v4, s[52:55], s68 offen offset:0 nt lds
    buffer_load_dwordx4 v5, s[52:55], s68 offen offset:1024 nt lds
    buffer_load_dwordx4 v6, s[52:55], s68 offen offset:2048 nt lds
    buffer_load_dwordx4 v7, s[52:55], s68 offen offset:3072 nt lds
    s_add_u32 m0, s88, 36864
    s_add_u32 s68, s69, 4096
    buffer_load_dwordx4 v4, s[52:55], s68 offen offset:0 nt lds
    buffer_load_dwordx4 v5, s[52:55], s68 offen offset:1024 nt lds
    buffer_load_dwordx4 v6, s[52:55], s68 offen offset:2048 nt lds
    buffer_load_dwordx4 v7, s[52:55], s68 offen offset:3072 nt lds
    v_and_b32 v32, 31, v0
    v_lshrrev_b32 v33, 5, v0
    v_and_b32 v34, 15, v32
    v_xor_b32 v34, v34, v33
    v_lshlrev_b32 v34, 4, v34
    v_lshl_add_u32 v34, v32, 8, v34

    v_xor_b32 v35, 0, v34
    v_add_u32 v17, s88, v35
    v_xor_b32 v35, 32, v34
    v_add_u32 v18, s88, v35
    v_xor_b32 v35, 64, v34
    v_add_u32 v19, s88, v35
    v_xor_b32 v35, 96, v34
    v_add_u32 v20, s88, v35
    v_xor_b32 v35, 128, v34
    v_add_u32 v21, s88, v35
    v_xor_b32 v35, 160, v34
    v_add_u32 v22, s88, v35
    v_xor_b32 v35, 192, v34
    v_add_u32 v23, s88, v35
    v_xor_b32 v35, 224, v34
    v_add_u32 v24, s88, v35
    v_bfe_u32 v32, v0, 4, 1
    v_bfe_u32 v34, v0, 2, 2
    v_and_b32 v35, 1, v0
    v_bfe_u32 v36, v0, 1, 1
    v_lshl_add_u32 v37, v33, 2, v34
    v_lshlrev_b32 v37, 8, v37
    v_lshl_add_u32 v37, v35, 5, v37
    v_lshl_add_u32 v37, v32, 4, v37
    v_lshl_add_u32 v37, v36, 3, v37
    v_lshl_add_u32 v37, v34, 6, v37
    v_add_u32 v37, s88, v37

    v_xor_b32 v25, 0, v37
    v_xor_b32 v26, 64, v37
    v_xor_b32 v27, 128, v37
    v_xor_b32 v28, 192, v37
    s_lshl_b32 s68, s6, 5
    s_add_u32 s68, s68, s5
    s_lshl_b32 s68, s68, 13
    v_lshlrev_b32 v37, 4, v0
    v_add_u32 v30, s68, v37
    v_and_b32 v32, 31, v0
    v_lshlrev_b32 v32, 13, v32
    v_lshl_add_u32 v32, v33, 5, v32
    s_lshl_b32 s68, s6, 18
    s_lshl_b32 s69, s5, 8
    s_add_u32 s68, s68, s69
    v_add_u32 v31, s68, v32

    s_waitcnt vmcnt(32)
    s_cmp_lg_u32 s3, 0
    s_cbranch_scc1 L_ga_2
    v_mov_b32 v32, 1
    v_mov_b32 v33, 0
    s_mov_b64 exec, 1
    buffer_atomic_add v32, v33, s[48:51], 0 offen sc1
    s_mov_b64 exec, -1

L_ga_2:
    s_barrier
    ds_read_b128 a[0:3], v17 offset:0
    ds_read_b128 a[4:7], v18 offset:0
    ds_read_b128 a[8:11], v19 offset:0
    ds_read_b128 a[12:15], v20 offset:0
    ds_read_b128 a[16:19], v21 offset:0
    ds_read_b128 a[20:23], v22 offset:0
    ds_read_b128 a[24:27], v23 offset:0
    ds_read_b128 a[28:31], v24 offset:0
    s_waitcnt lgkmcnt(0)
    s_add_u32 s69, s9, 5
    s_and_b32 s69, s69, 15
    s_lshl_b32 s69, s69, 13
    s_add_u32 m0, s88, 0
    s_add_u32 s68, s69, 0
    buffer_load_dwordx4 v4, s[52:55], s68 offen offset:0 nt lds
    buffer_load_dwordx4 v5, s[52:55], s68 offen offset:1024 nt lds
    buffer_load_dwordx4 v6, s[52:55], s68 offen offset:2048 nt lds
    buffer_load_dwordx4 v7, s[52:55], s68 offen offset:3072 nt lds
    s_add_u32 m0, s88, 4096
    s_add_u32 s68, s69, 4096
    buffer_load_dwordx4 v4, s[52:55], s68 offen offset:0 nt lds
    buffer_load_dwordx4 v5, s[52:55], s68 offen offset:1024 nt lds
    buffer_load_dwordx4 v6, s[52:55], s68 offen offset:2048 nt lds
    buffer_load_dwordx4 v7, s[52:55], s68 offen offset:3072 nt lds
    s_waitcnt vmcnt(32)
    ds_read_b128 a[32:35], v17 offset:8192
    ds_read_b128 a[36:39], v18 offset:8192
    ds_read_b128 a[40:43], v19 offset:8192
    ds_read_b128 a[44:47], v20 offset:8192
    ds_read_b128 a[48:51], v21 offset:8192
    ds_read_b128 a[52:55], v22 offset:8192
    ds_read_b128 a[56:59], v23 offset:8192
    ds_read_b128 a[60:63], v24 offset:8192
    s_waitcnt lgkmcnt(0)
    s_add_u32 s69, s9, 6
    s_and_b32 s69, s69, 15
    s_lshl_b32 s69, s69, 13
    s_add_u32 m0, s88, 8192
    s_add_u32 s68, s69, 0
    buffer_load_dwordx4 v4, s[52:55], s68 offen offset:0 nt lds
    buffer_load_dwordx4 v5, s[52:55], s68 offen offset:1024 nt lds
    buffer_load_dwordx4 v6, s[52:55], s68 offen offset:2048 nt lds
    buffer_load_dwordx4 v7, s[52:55], s68 offen offset:3072 nt lds
    s_add_u32 m0, s88, 12288
    s_add_u32 s68, s69, 4096
    buffer_load_dwordx4 v4, s[52:55], s68 offen offset:0 nt lds
    buffer_load_dwordx4 v5, s[52:55], s68 offen offset:1024 nt lds
    buffer_load_dwordx4 v6, s[52:55], s68 offen offset:2048 nt lds
    buffer_load_dwordx4 v7, s[52:55], s68 offen offset:3072 nt lds
    s_waitcnt vmcnt(32)
    ds_read_b128 a[64:67], v17 offset:16384
    ds_read_b128 a[68:71], v18 offset:16384
    ds_read_b128 a[72:75], v19 offset:16384
    ds_read_b128 a[76:79], v20 offset:16384
    ds_read_b128 a[80:83], v21 offset:16384
    ds_read_b128 a[84:87], v22 offset:16384
    ds_read_b128 a[88:91], v23 offset:16384
    ds_read_b128 a[92:95], v24 offset:16384
    s_waitcnt lgkmcnt(0)
    s_add_u32 s69, s9, 7
    s_and_b32 s69, s69, 15
    s_lshl_b32 s69, s69, 13
    s_add_u32 m0, s88, 16384
    s_add_u32 s68, s69, 0
    buffer_load_dwordx4 v4, s[52:55], s68 offen offset:0 nt lds
    buffer_load_dwordx4 v5, s[52:55], s68 offen offset:1024 nt lds
    buffer_load_dwordx4 v6, s[52:55], s68 offen offset:2048 nt lds
    buffer_load_dwordx4 v7, s[52:55], s68 offen offset:3072 nt lds
    s_add_u32 m0, s88, 20480
    s_add_u32 s68, s69, 4096
    buffer_load_dwordx4 v4, s[52:55], s68 offen offset:0 nt lds
    buffer_load_dwordx4 v5, s[52:55], s68 offen offset:1024 nt lds
    buffer_load_dwordx4 v6, s[52:55], s68 offen offset:2048 nt lds
    buffer_load_dwordx4 v7, s[52:55], s68 offen offset:3072 nt lds
    s_waitcnt vmcnt(32)
    ds_read_b128 a[96:99], v17 offset:24576
    ds_read_b128 a[100:103], v18 offset:24576
    ds_read_b128 a[104:107], v19 offset:24576
    ds_read_b128 a[108:111], v20 offset:24576
    ds_read_b128 a[112:115], v21 offset:24576
    ds_read_b128 a[116:119], v22 offset:24576
    ds_read_b128 a[120:123], v23 offset:24576
    ds_read_b128 a[124:127], v24 offset:24576
    s_waitcnt lgkmcnt(0)
    s_add_u32 s69, s9, 8
    s_and_b32 s69, s69, 15
    s_lshl_b32 s69, s69, 13
    s_add_u32 m0, s88, 24576
    s_add_u32 s68, s69, 0
    buffer_load_dwordx4 v4, s[52:55], s68 offen offset:0 nt lds
    buffer_load_dwordx4 v5, s[52:55], s68 offen offset:1024 nt lds
    buffer_load_dwordx4 v6, s[52:55], s68 offen offset:2048 nt lds
    buffer_load_dwordx4 v7, s[52:55], s68 offen offset:3072 nt lds
    s_add_u32 m0, s88, 28672
    s_add_u32 s68, s69, 4096
    buffer_load_dwordx4 v4, s[52:55], s68 offen offset:0 nt lds
    buffer_load_dwordx4 v5, s[52:55], s68 offen offset:1024 nt lds
    buffer_load_dwordx4 v6, s[52:55], s68 offen offset:2048 nt lds
    buffer_load_dwordx4 v7, s[52:55], s68 offen offset:3072 nt lds
    s_waitcnt vmcnt(32)
    ds_read_b128 a[128:131], v17 offset:32768
    ds_read_b128 a[132:135], v18 offset:32768
    ds_read_b128 a[136:139], v19 offset:32768
    ds_read_b128 a[140:143], v20 offset:32768
    ds_read_b128 a[144:147], v21 offset:32768
    ds_read_b128 a[148:151], v22 offset:32768
    ds_read_b128 a[152:155], v23 offset:32768
    ds_read_b128 a[156:159], v24 offset:32768
    s_waitcnt lgkmcnt(0)
    s_add_u32 s69, s9, 9
    s_and_b32 s69, s69, 15
    s_lshl_b32 s69, s69, 13
    s_add_u32 m0, s88, 32768
    s_add_u32 s68, s69, 0
    buffer_load_dwordx4 v4, s[52:55], s68 offen offset:0 nt lds
    buffer_load_dwordx4 v5, s[52:55], s68 offen offset:1024 nt lds
    buffer_load_dwordx4 v6, s[52:55], s68 offen offset:2048 nt lds
    buffer_load_dwordx4 v7, s[52:55], s68 offen offset:3072 nt lds
    s_add_u32 m0, s88, 36864
    s_add_u32 s68, s69, 4096
    buffer_load_dwordx4 v4, s[52:55], s68 offen offset:0 nt lds
    buffer_load_dwordx4 v5, s[52:55], s68 offen offset:1024 nt lds
    buffer_load_dwordx4 v6, s[52:55], s68 offen offset:2048 nt lds
    buffer_load_dwordx4 v7, s[52:55], s68 offen offset:3072 nt lds
    s_waitcnt vmcnt(32)
    ds_read_b128 a[160:163], v17 offset:0
    ds_read_b128 a[164:167], v18 offset:0
    ds_read_b128 a[168:171], v19 offset:0
    ds_read_b128 a[172:175], v20 offset:0
    ds_read_b128 a[176:179], v21 offset:0
    ds_read_b128 a[180:183], v22 offset:0
    ds_read_b128 a[184:187], v23 offset:0
    ds_read_b128 a[188:191], v24 offset:0
    s_waitcnt lgkmcnt(0)
    s_add_u32 s69, s9, 10
    s_and_b32 s69, s69, 15
    s_lshl_b32 s69, s69, 13
    s_add_u32 m0, s88, 0
    s_add_u32 s68, s69, 0
    buffer_load_dwordx4 v4, s[52:55], s68 offen offset:0 nt lds
    buffer_load_dwordx4 v5, s[52:55], s68 offen offset:1024 nt lds
    buffer_load_dwordx4 v6, s[52:55], s68 offen offset:2048 nt lds
    buffer_load_dwordx4 v7, s[52:55], s68 offen offset:3072 nt lds
    s_add_u32 m0, s88, 4096
    s_add_u32 s68, s69, 4096
    buffer_load_dwordx4 v4, s[52:55], s68 offen offset:0 nt lds
    buffer_load_dwordx4 v5, s[52:55], s68 offen offset:1024 nt lds
    buffer_load_dwordx4 v6, s[52:55], s68 offen offset:2048 nt lds
    buffer_load_dwordx4 v7, s[52:55], s68 offen offset:3072 nt lds
    s_waitcnt vmcnt(32)
    ds_read_b128 a[192:195], v17 offset:8192
    ds_read_b128 a[196:199], v18 offset:8192
    ds_read_b128 a[200:203], v19 offset:8192
    ds_read_b128 a[204:207], v20 offset:8192
    ds_read_b128 a[208:211], v21 offset:8192
    ds_read_b128 a[212:215], v22 offset:8192
    ds_read_b128 a[216:219], v23 offset:8192
    ds_read_b128 a[220:223], v24 offset:8192
    s_waitcnt lgkmcnt(0)
    s_add_u32 s69, s9, 11
    s_and_b32 s69, s69, 15
    s_lshl_b32 s69, s69, 13
    s_add_u32 m0, s88, 8192
    s_add_u32 s68, s69, 0
    buffer_load_dwordx4 v4, s[52:55], s68 offen offset:0 nt lds
    buffer_load_dwordx4 v5, s[52:55], s68 offen offset:1024 nt lds
    buffer_load_dwordx4 v6, s[52:55], s68 offen offset:2048 nt lds
    buffer_load_dwordx4 v7, s[52:55], s68 offen offset:3072 nt lds
    s_add_u32 m0, s88, 12288
    s_add_u32 s68, s69, 4096
    buffer_load_dwordx4 v4, s[52:55], s68 offen offset:0 nt lds
    buffer_load_dwordx4 v5, s[52:55], s68 offen offset:1024 nt lds
    buffer_load_dwordx4 v6, s[52:55], s68 offen offset:2048 nt lds
    buffer_load_dwordx4 v7, s[52:55], s68 offen offset:3072 nt lds
    s_waitcnt vmcnt(32)
    ds_read_b128 a[224:227], v17 offset:16384
    ds_read_b128 a[228:231], v18 offset:16384
    ds_read_b128 a[232:235], v19 offset:16384
    ds_read_b128 a[236:239], v20 offset:16384
    ds_read_b128 a[240:243], v21 offset:16384
    ds_read_b128 a[244:247], v22 offset:16384
    ds_read_b128 a[248:251], v23 offset:16384
    ds_read_b128 a[252:255], v24 offset:16384
    s_waitcnt lgkmcnt(0)
    s_add_u32 s69, s9, 12
    s_and_b32 s69, s69, 15
    s_lshl_b32 s69, s69, 13
    s_add_u32 m0, s88, 16384
    s_add_u32 s68, s69, 0
    buffer_load_dwordx4 v4, s[52:55], s68 offen offset:0 nt lds
    buffer_load_dwordx4 v5, s[52:55], s68 offen offset:1024 nt lds
    buffer_load_dwordx4 v6, s[52:55], s68 offen offset:2048 nt lds
    buffer_load_dwordx4 v7, s[52:55], s68 offen offset:3072 nt lds
    s_add_u32 m0, s88, 20480
    s_add_u32 s68, s69, 4096
    buffer_load_dwordx4 v4, s[52:55], s68 offen offset:0 nt lds
    buffer_load_dwordx4 v5, s[52:55], s68 offen offset:1024 nt lds
    buffer_load_dwordx4 v6, s[52:55], s68 offen offset:2048 nt lds
    buffer_load_dwordx4 v7, s[52:55], s68 offen offset:3072 nt lds
    s_cmp_lg_u32 s3, 0
    s_cbranch_scc1 L_gc_3
    v_mov_b32 v33, 0
L_gate_4:
    buffer_load_dword v32, v33, s[48:51], 0 offen sc1
    s_waitcnt vmcnt(0)
    v_readfirstlane_b32 s68, v32
    s_cmp_ge_u32 s68, 256
    s_cbranch_scc1 L_gated_5
    s_sleep 32
    s_branch L_gate_4

L_gated_5:
    s_mov_b32 s46, 1
L_gc_3:
    v_mov_b32 v33, 0
    s_lshl_b32 s69, s2, 8
    s_lshl_b32 s68, s3, 2
    s_add_u32 s69, s69, s68

L_poll_6:
    buffer_load_dword v32, v33, s[96:99], s69 offen sc1
    s_waitcnt vmcnt(0)
    v_readfirstlane_b32 s68, v32
    s_cmp_eq_u32 s68, 1
    s_cbranch_scc1 L_polld_7
    s_sleep 8
    s_branch L_poll_6

L_polld_7:
    s_mov_b32 s68, 4096
    buffer_load_dwordx4 v[40:43], v30, s[60:63], 0 offen offset:0 sc1
    buffer_load_dwordx4 v[44:47], v30, s[60:63], 0 offen offset:1024 sc1
    buffer_load_dwordx4 v[48:51], v30, s[60:63], 0 offen offset:2048 sc1
    buffer_load_dwordx4 v[52:55], v30, s[60:63], 0 offen offset:3072 sc1
    buffer_load_dwordx4 v[56:59], v30, s[60:63], s68 offen offset:0 sc1
    buffer_load_dwordx4 v[60:63], v30, s[60:63], s68 offen offset:1024 sc1
    buffer_load_dwordx4 v[64:67], v30, s[60:63], s68 offen offset:2048 sc1
    buffer_load_dwordx4 v[68:71], v30, s[60:63], s68 offen offset:3072 sc1
    s_waitcnt vmcnt(0)
    ds_read_b128 v[168:171], v17 offset:24576
    ds_read_b128 v[172:175], v18 offset:24576
    ds_read_b128 v[176:179], v19 offset:24576
    ds_read_b128 v[180:183], v20 offset:24576
    ds_read_b128 v[184:187], v21 offset:24576
    ds_read_b128 v[188:191], v22 offset:24576
    ds_read_b128 v[192:195], v23 offset:24576
    ds_read_b128 v[196:199], v24 offset:24576
    v_mfma_f32_32x32x16_bf16 v[136:151], a[0:3], v[40:43], 0
    v_mfma_f32_32x32x16_bf16 v[136:151], a[4:7], v[44:47], v[136:151]
    v_mfma_f32_32x32x16_bf16 v[136:151], a[8:11], v[48:51], v[136:151]
    v_mfma_f32_32x32x16_bf16 v[136:151], a[12:15], v[52:55], v[136:151]
    v_mfma_f32_32x32x16_bf16 v[136:151], a[16:19], v[56:59], v[136:151]
    v_mfma_f32_32x32x16_bf16 v[136:151], a[20:23], v[60:63], v[136:151]
    v_mfma_f32_32x32x16_bf16 v[136:151], a[24:27], v[64:67], v[136:151]
    v_mfma_f32_32x32x16_bf16 v[136:151], a[28:31], v[68:71], v[136:151]
    ds_read_b128 v[200:203], v17 offset:32768
    ds_read_b128 v[204:207], v18 offset:32768
    ds_read_b128 v[208:211], v19 offset:32768
    ds_read_b128 v[212:215], v20 offset:32768
    ds_read_b128 v[216:219], v21 offset:32768
    ds_read_b128 v[220:223], v22 offset:32768
    ds_read_b128 v[224:227], v23 offset:32768
    ds_read_b128 v[228:231], v24 offset:32768
    s_waitcnt lgkmcnt(8)
    v_mfma_f32_32x32x16_bf16 v[152:167], v[168:171], v[40:43], 0
    s_add_u32 s69, s9, 13
    s_and_b32 s69, s69, 15
    s_lshl_b32 s69, s69, 13
    s_add_u32 m0, s88, 24576
    s_add_u32 s68, s69, 0
    buffer_load_dwordx4 v4, s[52:55], s68 offen offset:0 nt lds
    v_mfma_f32_32x32x16_bf16 v[152:167], v[172:175], v[44:47], v[152:167]
    buffer_load_dwordx4 v5, s[52:55], s68 offen offset:1024 nt lds
    s_nop 9
    v_max3_f32 v248, v136, v137, v138
    v_max3_f32 v248, v248, v139, v140
    v_max3_f32 v248, v248, v141, v142
    v_max3_f32 v248, v248, v143, v144
    v_mfma_f32_32x32x16_bf16 v[152:167], v[176:179], v[48:51], v[152:167]
    buffer_load_dwordx4 v6, s[52:55], s68 offen offset:2048 nt lds
    v_max3_f32 v248, v248, v145, v146
    v_max3_f32 v248, v248, v147, v148
    v_max3_f32 v248, v248, v149, v150
    v_max_f32 v248, v248, v151
    v_mfma_f32_32x32x16_bf16 v[152:167], v[180:183], v[52:55], v[152:167]
    buffer_load_dwordx4 v7, s[52:55], s68 offen offset:3072 nt lds
    v_accvgpr_write_b32 a0, v136
    v_accvgpr_write_b32 a1, v137
    v_accvgpr_write_b32 a2, v138
    v_accvgpr_write_b32 a3, v139
    v_mfma_f32_32x32x16_bf16 v[152:167], v[184:187], v[56:59], v[152:167]
    s_add_u32 m0, s88, 28672
    s_add_u32 s68, s69, 4096
    buffer_load_dwordx4 v4, s[52:55], s68 offen offset:0 nt lds
    v_accvgpr_write_b32 a4, v140
    v_accvgpr_write_b32 a5, v141
    v_accvgpr_write_b32 a6, v142
    v_accvgpr_write_b32 a7, v143
    v_mfma_f32_32x32x16_bf16 v[152:167], v[188:191], v[60:63], v[152:167]
    buffer_load_dwordx4 v5, s[52:55], s68 offen offset:1024 nt lds
    v_accvgpr_write_b32 a8, v144
    v_accvgpr_write_b32 a9, v145
    v_accvgpr_write_b32 a10, v146
    v_accvgpr_write_b32 a11, v147
    v_mfma_f32_32x32x16_bf16 v[152:167], v[192:195], v[64:67], v[152:167]
    buffer_load_dwordx4 v6, s[52:55], s68 offen offset:2048 nt lds
    v_accvgpr_write_b32 a12, v148
    v_accvgpr_write_b32 a13, v149
    v_accvgpr_write_b32 a14, v150
    v_accvgpr_write_b32 a15, v151
    v_mfma_f32_32x32x16_bf16 v[152:167], v[196:199], v[68:71], v[152:167]
    buffer_load_dwordx4 v7, s[52:55], s68 offen offset:3072 nt lds
    v_mfma_f32_32x32x16_bf16 v[136:151], a[32:35], v[40:43], 0
    v_mfma_f32_32x32x16_bf16 v[136:151], a[36:39], v[44:47], v[136:151]
    s_nop 9
    v_max3_f32 v248, v248, v152, v153
    v_max3_f32 v248, v248, v154, v155
    v_max3_f32 v248, v248, v156, v157
    v_max3_f32 v248, v248, v158, v159
    v_mfma_f32_32x32x16_bf16 v[136:151], a[40:43], v[48:51], v[136:151]
    v_max3_f32 v248, v248, v160, v161
    v_max3_f32 v248, v248, v162, v163
    v_max3_f32 v248, v248, v164, v165
    v_max3_f32 v248, v248, v166, v167
    v_mfma_f32_32x32x16_bf16 v[136:151], a[44:47], v[52:55], v[136:151]
    v_accvgpr_write_b32 a16, v152
    v_accvgpr_write_b32 a17, v153
    v_accvgpr_write_b32 a18, v154
    v_accvgpr_write_b32 a19, v155
    v_mfma_f32_32x32x16_bf16 v[136:151], a[48:51], v[56:59], v[136:151]
    v_accvgpr_write_b32 a20, v156
    v_accvgpr_write_b32 a21, v157
    v_accvgpr_write_b32 a22, v158
    v_accvgpr_write_b32 a23, v159
    v_mfma_f32_32x32x16_bf16 v[136:151], a[52:55], v[60:63], v[136:151]
    v_accvgpr_write_b32 a24, v160
    v_accvgpr_write_b32 a25, v161
    v_accvgpr_write_b32 a26, v162
    v_accvgpr_write_b32 a27, v163
    v_mfma_f32_32x32x16_bf16 v[136:151], a[56:59], v[64:67], v[136:151]
    v_accvgpr_write_b32 a28, v164
    v_accvgpr_write_b32 a29, v165
    v_accvgpr_write_b32 a30, v166
    v_accvgpr_write_b32 a31, v167
    v_mfma_f32_32x32x16_bf16 v[136:151], a[60:63], v[68:71], v[136:151]
    ds_read_b128 v[168:171], v17 offset:0
    ds_read_b128 v[172:175], v18 offset:0
    ds_read_b128 v[176:179], v19 offset:0
    ds_read_b128 v[180:183], v20 offset:0
    ds_read_b128 v[184:187], v21 offset:0
    ds_read_b128 v[188:191], v22 offset:0
    ds_read_b128 v[192:195], v23 offset:0
    ds_read_b128 v[196:199], v24 offset:0
    s_waitcnt lgkmcnt(8)
    v_mfma_f32_32x32x16_bf16 v[152:167], v[200:203], v[40:43], 0
    s_add_u32 s69, s9, 14
    s_and_b32 s69, s69, 15
    s_lshl_b32 s69, s69, 13
    s_add_u32 m0, s88, 32768
    s_add_u32 s68, s69, 0
    buffer_load_dwordx4 v4, s[52:55], s68 offen offset:0 nt lds
    v_mfma_f32_32x32x16_bf16 v[152:167], v[204:207], v[44:47], v[152:167]
    buffer_load_dwordx4 v5, s[52:55], s68 offen offset:1024 nt lds
    s_nop 9
    v_max3_f32 v248, v248, v136, v137
    v_max3_f32 v248, v248, v138, v139
    v_max3_f32 v248, v248, v140, v141
    v_max3_f32 v248, v248, v142, v143
    v_mfma_f32_32x32x16_bf16 v[152:167], v[208:211], v[48:51], v[152:167]
    buffer_load_dwordx4 v6, s[52:55], s68 offen offset:2048 nt lds
    v_max3_f32 v248, v248, v144, v145
    v_max3_f32 v248, v248, v146, v147
    v_max3_f32 v248, v248, v148, v149
    v_max3_f32 v248, v248, v150, v151
    v_mfma_f32_32x32x16_bf16 v[152:167], v[212:215], v[52:55], v[152:167]
    buffer_load_dwordx4 v7, s[52:55], s68 offen offset:3072 nt lds
    v_accvgpr_write_b32 a32, v136
    v_accvgpr_write_b32 a33, v137
    v_accvgpr_write_b32 a34, v138
    v_accvgpr_write_b32 a35, v139
    v_mfma_f32_32x32x16_bf16 v[152:167], v[216:219], v[56:59], v[152:167]
    s_add_u32 m0, s88, 36864
    s_add_u32 s68, s69, 4096
    buffer_load_dwordx4 v4, s[52:55], s68 offen offset:0 nt lds
    v_accvgpr_write_b32 a36, v140
    v_accvgpr_write_b32 a37, v141
    v_accvgpr_write_b32 a38, v142
    v_accvgpr_write_b32 a39, v143
    v_mfma_f32_32x32x16_bf16 v[152:167], v[220:223], v[60:63], v[152:167]
    buffer_load_dwordx4 v5, s[52:55], s68 offen offset:1024 nt lds
    v_accvgpr_write_b32 a40, v144
    v_accvgpr_write_b32 a41, v145
    v_accvgpr_write_b32 a42, v146
    v_accvgpr_write_b32 a43, v147
    v_mfma_f32_32x32x16_bf16 v[152:167], v[224:227], v[64:67], v[152:167]
    buffer_load_dwordx4 v6, s[52:55], s68 offen offset:2048 nt lds
    v_accvgpr_write_b32 a44, v148
    v_accvgpr_write_b32 a45, v149
    v_accvgpr_write_b32 a46, v150
    v_accvgpr_write_b32 a47, v151
    v_mfma_f32_32x32x16_bf16 v[152:167], v[228:231], v[68:71], v[152:167]
    buffer_load_dwordx4 v7, s[52:55], s68 offen offset:3072 nt lds
    v_mfma_f32_32x32x16_bf16 v[136:151], a[64:67], v[40:43], 0
    v_mfma_f32_32x32x16_bf16 v[136:151], a[68:71], v[44:47], v[136:151]
    s_nop 9
    v_max3_f32 v248, v248, v152, v153
    v_max3_f32 v248, v248, v154, v155
    v_max3_f32 v248, v248, v156, v157
    v_max3_f32 v248, v248, v158, v159
    v_mfma_f32_32x32x16_bf16 v[136:151], a[72:75], v[48:51], v[136:151]
    v_max3_f32 v248, v248, v160, v161
    v_max3_f32 v248, v248, v162, v163
    v_max3_f32 v248, v248, v164, v165
    v_max3_f32 v248, v248, v166, v167
    v_mfma_f32_32x32x16_bf16 v[136:151], a[76:79], v[52:55], v[136:151]
    v_accvgpr_write_b32 a48, v152
    v_accvgpr_write_b32 a49, v153
    v_accvgpr_write_b32 a50, v154
    v_accvgpr_write_b32 a51, v155
    v_mfma_f32_32x32x16_bf16 v[136:151], a[80:83], v[56:59], v[136:151]
    v_accvgpr_write_b32 a52, v156
    v_accvgpr_write_b32 a53, v157
    v_accvgpr_write_b32 a54, v158
    v_accvgpr_write_b32 a55, v159
    v_mfma_f32_32x32x16_bf16 v[136:151], a[84:87], v[60:63], v[136:151]
    v_accvgpr_write_b32 a56, v160
    v_accvgpr_write_b32 a57, v161
    v_accvgpr_write_b32 a58, v162
    v_accvgpr_write_b32 a59, v163
    v_mfma_f32_32x32x16_bf16 v[136:151], a[88:91], v[64:67], v[136:151]
    v_accvgpr_write_b32 a60, v164
    v_accvgpr_write_b32 a61, v165
    v_accvgpr_write_b32 a62, v166
    v_accvgpr_write_b32 a63, v167
    v_mfma_f32_32x32x16_bf16 v[136:151], a[92:95], v[68:71], v[136:151]
    ds_read_b128 v[200:203], v17 offset:8192
    ds_read_b128 v[204:207], v18 offset:8192
    ds_read_b128 v[208:211], v19 offset:8192
    ds_read_b128 v[212:215], v20 offset:8192
    ds_read_b128 v[216:219], v21 offset:8192
    ds_read_b128 v[220:223], v22 offset:8192
    ds_read_b128 v[224:227], v23 offset:8192
    ds_read_b128 v[228:231], v24 offset:8192
    s_waitcnt lgkmcnt(8)
    v_mfma_f32_32x32x16_bf16 v[152:167], v[168:171], v[40:43], 0
    s_add_u32 s69, s9, 15
    s_and_b32 s69, s69, 15
    s_lshl_b32 s69, s69, 13
    s_add_u32 m0, s88, 0
    s_add_u32 s68, s69, 0
    buffer_load_dwordx4 v4, s[52:55], s68 offen offset:0 nt lds
    v_mfma_f32_32x32x16_bf16 v[152:167], v[172:175], v[44:47], v[152:167]
    buffer_load_dwordx4 v5, s[52:55], s68 offen offset:1024 nt lds
    s_nop 9
    v_max3_f32 v248, v248, v136, v137
    v_max3_f32 v248, v248, v138, v139
    v_max3_f32 v248, v248, v140, v141
    v_max3_f32 v248, v248, v142, v143
    v_mfma_f32_32x32x16_bf16 v[152:167], v[176:179], v[48:51], v[152:167]
    buffer_load_dwordx4 v6, s[52:55], s68 offen offset:2048 nt lds
    v_max3_f32 v248, v248, v144, v145
    v_max3_f32 v248, v248, v146, v147
    v_max3_f32 v248, v248, v148, v149
    v_max3_f32 v248, v248, v150, v151
    v_mfma_f32_32x32x16_bf16 v[152:167], v[180:183], v[52:55], v[152:167]
    buffer_load_dwordx4 v7, s[52:55], s68 offen offset:3072 nt lds
    v_accvgpr_write_b32 a64, v136
    v_accvgpr_write_b32 a65, v137
    v_accvgpr_write_b32 a66, v138
    v_accvgpr_write_b32 a67, v139
    v_mfma_f32_32x32x16_bf16 v[152:167], v[184:187], v[56:59], v[152:167]
    s_add_u32 m0, s88, 4096
    s_add_u32 s68, s69, 4096
    buffer_load_dwordx4 v4, s[52:55], s68 offen offset:0 nt lds
    v_accvgpr_write_b32 a68, v140
    v_accvgpr_write_b32 a69, v141
    v_accvgpr_write_b32 a70, v142
    v_accvgpr_write_b32 a71, v143
    v_mfma_f32_32x32x16_bf16 v[152:167], v[188:191], v[60:63], v[152:167]
    buffer_load_dwordx4 v5, s[52:55], s68 offen offset:1024 nt lds
    v_accvgpr_write_b32 a72, v144
    v_accvgpr_write_b32 a73, v145
    v_accvgpr_write_b32 a74, v146
    v_accvgpr_write_b32 a75, v147
    v_mfma_f32_32x32x16_bf16 v[152:167], v[192:195], v[64:67], v[152:167]
    buffer_load_dwordx4 v6, s[52:55], s68 offen offset:2048 nt lds
    v_accvgpr_write_b32 a76, v148
    v_accvgpr_write_b32 a77, v149
    v_accvgpr_write_b32 a78, v150
    v_accvgpr_write_b32 a79, v151
    v_mfma_f32_32x32x16_bf16 v[152:167], v[196:199], v[68:71], v[152:167]
    buffer_load_dwordx4 v7, s[52:55], s68 offen offset:3072 nt lds
    v_mfma_f32_32x32x16_bf16 v[136:151], a[96:99], v[40:43], 0
    v_mfma_f32_32x32x16_bf16 v[136:151], a[100:103], v[44:47], v[136:151]
    s_nop 9
    v_max3_f32 v248, v248, v152, v153
    v_max3_f32 v248, v248, v154, v155
    v_max3_f32 v248, v248, v156, v157
    v_max3_f32 v248, v248, v158, v159
    v_mfma_f32_32x32x16_bf16 v[136:151], a[104:107], v[48:51], v[136:151]
    v_max3_f32 v248, v248, v160, v161
    v_max3_f32 v248, v248, v162, v163
    v_max3_f32 v248, v248, v164, v165
    v_max3_f32 v248, v248, v166, v167
    v_mfma_f32_32x32x16_bf16 v[136:151], a[108:111], v[52:55], v[136:151]
    v_accvgpr_write_b32 a80, v152
    v_accvgpr_write_b32 a81, v153
    v_accvgpr_write_b32 a82, v154
    v_accvgpr_write_b32 a83, v155
    v_mfma_f32_32x32x16_bf16 v[136:151], a[112:115], v[56:59], v[136:151]
    v_accvgpr_write_b32 a84, v156
    v_accvgpr_write_b32 a85, v157
    v_accvgpr_write_b32 a86, v158
    v_accvgpr_write_b32 a87, v159
    v_mfma_f32_32x32x16_bf16 v[136:151], a[116:119], v[60:63], v[136:151]
    v_accvgpr_write_b32 a88, v160
    v_accvgpr_write_b32 a89, v161
    v_accvgpr_write_b32 a90, v162
    v_accvgpr_write_b32 a91, v163
    v_mfma_f32_32x32x16_bf16 v[136:151], a[120:123], v[64:67], v[136:151]
    v_accvgpr_write_b32 a92, v164
    v_accvgpr_write_b32 a93, v165
    v_accvgpr_write_b32 a94, v166
    v_accvgpr_write_b32 a95, v167
    v_mfma_f32_32x32x16_bf16 v[136:151], a[124:127], v[68:71], v[136:151]
    ds_read_b128 v[168:171], v17 offset:16384
    ds_read_b128 v[172:175], v18 offset:16384
    ds_read_b128 v[176:179], v19 offset:16384
    ds_read_b128 v[180:183], v20 offset:16384
    ds_read_b128 v[184:187], v21 offset:16384
    ds_read_b128 v[188:191], v22 offset:16384
    ds_read_b128 v[192:195], v23 offset:16384
    ds_read_b128 v[196:199], v24 offset:16384
    s_waitcnt lgkmcnt(8)
    v_mfma_f32_32x32x16_bf16 v[152:167], v[200:203], v[40:43], 0
    s_add_u32 s69, s9, 0
    s_and_b32 s69, s69, 15
    s_lshl_b32 s69, s69, 13
    s_add_u32 m0, s88, 8192
    s_add_u32 s68, s69, 0
    buffer_load_dwordx4 v8, s[56:59], s68 offen offset:0 nt lds
    v_mfma_f32_32x32x16_bf16 v[152:167], v[204:207], v[44:47], v[152:167]
    buffer_load_dwordx4 v8, s[56:59], s68 offen offset:1024 nt lds
    s_nop 9
    v_max3_f32 v248, v248, v136, v137
    v_max3_f32 v248, v248, v138, v139
    v_max3_f32 v248, v248, v140, v141
    v_max3_f32 v248, v248, v142, v143
    v_mfma_f32_32x32x16_bf16 v[152:167], v[208:211], v[48:51], v[152:167]
    buffer_load_dwordx4 v8, s[56:59], s68 offen offset:2048 nt lds
    v_max3_f32 v248, v248, v144, v145
    v_max3_f32 v248, v248, v146, v147
    v_max3_f32 v248, v248, v148, v149
    v_max3_f32 v248, v248, v150, v151
    v_mfma_f32_32x32x16_bf16 v[152:167], v[212:215], v[52:55], v[152:167]
    buffer_load_dwordx4 v8, s[56:59], s68 offen offset:3072 nt lds
    v_accvgpr_write_b32 a96, v136
    v_accvgpr_write_b32 a97, v137
    v_accvgpr_write_b32 a98, v138
    v_accvgpr_write_b32 a99, v139
    v_mfma_f32_32x32x16_bf16 v[152:167], v[216:219], v[56:59], v[152:167]
    s_add_u32 m0, s88, 12288
    s_add_u32 s68, s69, 4096
    buffer_load_dwordx4 v8, s[56:59], s68 offen offset:0 nt lds
    v_accvgpr_write_b32 a100, v140
    v_accvgpr_write_b32 a101, v141
    v_accvgpr_write_b32 a102, v142
    v_accvgpr_write_b32 a103, v143
    v_mfma_f32_32x32x16_bf16 v[152:167], v[220:223], v[60:63], v[152:167]
    buffer_load_dwordx4 v8, s[56:59], s68 offen offset:1024 nt lds
    v_accvgpr_write_b32 a104, v144
    v_accvgpr_write_b32 a105, v145
    v_accvgpr_write_b32 a106, v146
    v_accvgpr_write_b32 a107, v147
    v_mfma_f32_32x32x16_bf16 v[152:167], v[224:227], v[64:67], v[152:167]
    buffer_load_dwordx4 v8, s[56:59], s68 offen offset:2048 nt lds
    v_accvgpr_write_b32 a108, v148
    v_accvgpr_write_b32 a109, v149
    v_accvgpr_write_b32 a110, v150
    v_accvgpr_write_b32 a111, v151
    v_mfma_f32_32x32x16_bf16 v[152:167], v[228:231], v[68:71], v[152:167]
    buffer_load_dwordx4 v8, s[56:59], s68 offen offset:3072 nt lds
    v_mfma_f32_32x32x16_bf16 v[136:151], a[128:131], v[40:43], 0
    v_mfma_f32_32x32x16_bf16 v[136:151], a[132:135], v[44:47], v[136:151]
    s_nop 9
    v_max3_f32 v248, v248, v152, v153
    v_max3_f32 v248, v248, v154, v155
    v_max3_f32 v248, v248, v156, v157
    v_max3_f32 v248, v248, v158, v159
    v_mfma_f32_32x32x16_bf16 v[136:151], a[136:139], v[48:51], v[136:151]
    v_max3_f32 v248, v248, v160, v161
    v_max3_f32 v248, v248, v162, v163
    v_max3_f32 v248, v248, v164, v165
    v_max3_f32 v248, v248, v166, v167
    v_mfma_f32_32x32x16_bf16 v[136:151], a[140:143], v[52:55], v[136:151]
    v_accvgpr_write_b32 a112, v152
    v_accvgpr_write_b32 a113, v153
    v_accvgpr_write_b32 a114, v154
    v_accvgpr_write_b32 a115, v155
    v_mfma_f32_32x32x16_bf16 v[136:151], a[144:147], v[56:59], v[136:151]
    v_accvgpr_write_b32 a116, v156
    v_accvgpr_write_b32 a117, v157
    v_accvgpr_write_b32 a118, v158
    v_accvgpr_write_b32 a119, v159
    v_mfma_f32_32x32x16_bf16 v[136:151], a[148:151], v[60:63], v[136:151]
    v_accvgpr_write_b32 a120, v160
    v_accvgpr_write_b32 a121, v161
    v_accvgpr_write_b32 a122, v162
    v_accvgpr_write_b32 a123, v163
    v_mfma_f32_32x32x16_bf16 v[136:151], a[152:155], v[64:67], v[136:151]
    v_accvgpr_write_b32 a124, v164
    v_accvgpr_write_b32 a125, v165
    v_accvgpr_write_b32 a126, v166
    v_accvgpr_write_b32 a127, v167
    v_mfma_f32_32x32x16_bf16 v[136:151], a[156:159], v[68:71], v[136:151]
    s_waitcnt vmcnt(24)
    ds_read_b128 v[200:203], v17 offset:24576
    ds_read_b128 v[204:207], v18 offset:24576
    ds_read_b128 v[208:211], v19 offset:24576
    ds_read_b128 v[212:215], v20 offset:24576
    ds_read_b128 v[216:219], v21 offset:24576
    ds_read_b128 v[220:223], v22 offset:24576
    ds_read_b128 v[224:227], v23 offset:24576
    ds_read_b128 v[228:231], v24 offset:24576
    s_waitcnt lgkmcnt(8)
    v_mfma_f32_32x32x16_bf16 v[152:167], v[168:171], v[40:43], 0
    s_add_u32 s69, s9, 1
    s_and_b32 s69, s69, 15
    s_lshl_b32 s69, s69, 13
    s_add_u32 m0, s88, 16384
    s_add_u32 s68, s69, 0
    buffer_load_dwordx4 v8, s[56:59], s68 offen offset:0 nt lds
    v_mfma_f32_32x32x16_bf16 v[152:167], v[172:175], v[44:47], v[152:167]
    buffer_load_dwordx4 v8, s[56:59], s68 offen offset:1024 nt lds
    s_nop 9
    v_max3_f32 v248, v248, v136, v137
    v_max3_f32 v248, v248, v138, v139
    v_max3_f32 v248, v248, v140, v141
    v_max3_f32 v248, v248, v142, v143
    v_mfma_f32_32x32x16_bf16 v[152:167], v[176:179], v[48:51], v[152:167]
    buffer_load_dwordx4 v8, s[56:59], s68 offen offset:2048 nt lds
    v_max3_f32 v248, v248, v144, v145
    v_max3_f32 v248, v248, v146, v147
    v_max3_f32 v248, v248, v148, v149
    v_max3_f32 v248, v248, v150, v151
    v_mfma_f32_32x32x16_bf16 v[152:167], v[180:183], v[52:55], v[152:167]
    buffer_load_dwordx4 v8, s[56:59], s68 offen offset:3072 nt lds
    v_accvgpr_write_b32 a128, v136
    v_accvgpr_write_b32 a129, v137
    v_accvgpr_write_b32 a130, v138
    v_accvgpr_write_b32 a131, v139
    v_mfma_f32_32x32x16_bf16 v[152:167], v[184:187], v[56:59], v[152:167]
    s_add_u32 m0, s88, 20480
    s_add_u32 s68, s69, 4096
    buffer_load_dwordx4 v8, s[56:59], s68 offen offset:0 nt lds
    v_accvgpr_write_b32 a132, v140
    v_accvgpr_write_b32 a133, v141
    v_accvgpr_write_b32 a134, v142
    v_accvgpr_write_b32 a135, v143
    v_mfma_f32_32x32x16_bf16 v[152:167], v[188:191], v[60:63], v[152:167]
    buffer_load_dwordx4 v8, s[56:59], s68 offen offset:1024 nt lds
    v_accvgpr_write_b32 a136, v144
    v_accvgpr_write_b32 a137, v145
    v_accvgpr_write_b32 a138, v146
    v_accvgpr_write_b32 a139, v147
    v_mfma_f32_32x32x16_bf16 v[152:167], v[192:195], v[64:67], v[152:167]
    buffer_load_dwordx4 v8, s[56:59], s68 offen offset:2048 nt lds
    v_accvgpr_write_b32 a140, v148
    v_accvgpr_write_b32 a141, v149
    v_accvgpr_write_b32 a142, v150
    v_accvgpr_write_b32 a143, v151
    v_mfma_f32_32x32x16_bf16 v[152:167], v[196:199], v[68:71], v[152:167]
    buffer_load_dwordx4 v8, s[56:59], s68 offen offset:3072 nt lds
    v_mfma_f32_32x32x16_bf16 v[136:151], a[160:163], v[40:43], 0
    v_mfma_f32_32x32x16_bf16 v[136:151], a[164:167], v[44:47], v[136:151]
    s_nop 9
    v_max3_f32 v248, v248, v152, v153
    v_max3_f32 v248, v248, v154, v155
    v_max3_f32 v248, v248, v156, v157
    v_max3_f32 v248, v248, v158, v159
    v_mfma_f32_32x32x16_bf16 v[136:151], a[168:171], v[48:51], v[136:151]
    v_max3_f32 v248, v248, v160, v161
    v_max3_f32 v248, v248, v162, v163
    v_max3_f32 v248, v248, v164, v165
    v_max3_f32 v248, v248, v166, v167
    v_mfma_f32_32x32x16_bf16 v[136:151], a[172:175], v[52:55], v[136:151]
    v_accvgpr_write_b32 a144, v152
    v_accvgpr_write_b32 a145, v153
    v_accvgpr_write_b32 a146, v154
    v_accvgpr_write_b32 a147, v155
    v_mfma_f32_32x32x16_bf16 v[136:151], a[176:179], v[56:59], v[136:151]
    v_accvgpr_write_b32 a148, v156
    v_accvgpr_write_b32 a149, v157
    v_accvgpr_write_b32 a150, v158
    v_accvgpr_write_b32 a151, v159
    v_mfma_f32_32x32x16_bf16 v[136:151], a[180:183], v[60:63], v[136:151]
    v_accvgpr_write_b32 a152, v160
    v_accvgpr_write_b32 a153, v161
    v_accvgpr_write_b32 a154, v162
    v_accvgpr_write_b32 a155, v163
    v_mfma_f32_32x32x16_bf16 v[136:151], a[184:187], v[64:67], v[136:151]
    v_accvgpr_write_b32 a156, v164
    v_accvgpr_write_b32 a157, v165
    v_accvgpr_write_b32 a158, v166
    v_accvgpr_write_b32 a159, v167
    v_mfma_f32_32x32x16_bf16 v[136:151], a[188:191], v[68:71], v[136:151]
    s_waitcnt vmcnt(24)
    ds_read_b128 v[168:171], v17 offset:32768
    ds_read_b128 v[172:175], v18 offset:32768
    ds_read_b128 v[176:179], v19 offset:32768
    ds_read_b128 v[180:183], v20 offset:32768
    ds_read_b128 v[184:187], v21 offset:32768
    ds_read_b128 v[188:191], v22 offset:32768
    ds_read_b128 v[192:195], v23 offset:32768
    ds_read_b128 v[196:199], v24 offset:32768
    s_waitcnt lgkmcnt(8)
    v_mfma_f32_32x32x16_bf16 v[152:167], v[200:203], v[40:43], 0
    s_add_u32 s69, s9, 2
    s_and_b32 s69, s69, 15
    s_lshl_b32 s69, s69, 13
    s_add_u32 m0, s88, 24576
    s_add_u32 s68, s69, 0
    buffer_load_dwordx4 v8, s[56:59], s68 offen offset:0 nt lds
    v_mfma_f32_32x32x16_bf16 v[152:167], v[204:207], v[44:47], v[152:167]
    buffer_load_dwordx4 v8, s[56:59], s68 offen offset:1024 nt lds
    s_nop 9
    v_max3_f32 v248, v248, v136, v137
    v_max3_f32 v248, v248, v138, v139
    v_max3_f32 v248, v248, v140, v141
    v_max3_f32 v248, v248, v142, v143
    v_mfma_f32_32x32x16_bf16 v[152:167], v[208:211], v[48:51], v[152:167]
    buffer_load_dwordx4 v8, s[56:59], s68 offen offset:2048 nt lds
    v_max3_f32 v248, v248, v144, v145
    v_max3_f32 v248, v248, v146, v147
    v_max3_f32 v248, v248, v148, v149
    v_max3_f32 v248, v248, v150, v151
    v_mfma_f32_32x32x16_bf16 v[152:167], v[212:215], v[52:55], v[152:167]
    buffer_load_dwordx4 v8, s[56:59], s68 offen offset:3072 nt lds
    v_accvgpr_write_b32 a160, v136
    v_accvgpr_write_b32 a161, v137
    v_accvgpr_write_b32 a162, v138
    v_accvgpr_write_b32 a163, v139
    v_mfma_f32_32x32x16_bf16 v[152:167], v[216:219], v[56:59], v[152:167]
    s_add_u32 m0, s88, 28672
    s_add_u32 s68, s69, 4096
    buffer_load_dwordx4 v8, s[56:59], s68 offen offset:0 nt lds
    v_accvgpr_write_b32 a164, v140
    v_accvgpr_write_b32 a165, v141
    v_accvgpr_write_b32 a166, v142
    v_accvgpr_write_b32 a167, v143
    v_mfma_f32_32x32x16_bf16 v[152:167], v[220:223], v[60:63], v[152:167]
    buffer_load_dwordx4 v8, s[56:59], s68 offen offset:1024 nt lds
    v_accvgpr_write_b32 a168, v144
    v_accvgpr_write_b32 a169, v145
    v_accvgpr_write_b32 a170, v146
    v_accvgpr_write_b32 a171, v147
    v_mfma_f32_32x32x16_bf16 v[152:167], v[224:227], v[64:67], v[152:167]
    buffer_load_dwordx4 v8, s[56:59], s68 offen offset:2048 nt lds
    v_accvgpr_write_b32 a172, v148
    v_accvgpr_write_b32 a173, v149
    v_accvgpr_write_b32 a174, v150
    v_accvgpr_write_b32 a175, v151
    v_mfma_f32_32x32x16_bf16 v[152:167], v[228:231], v[68:71], v[152:167]
    buffer_load_dwordx4 v8, s[56:59], s68 offen offset:3072 nt lds
    v_mfma_f32_32x32x16_bf16 v[136:151], a[192:195], v[40:43], 0
    v_mfma_f32_32x32x16_bf16 v[136:151], a[196:199], v[44:47], v[136:151]
    s_nop 9
    v_max3_f32 v248, v248, v152, v153
    v_max3_f32 v248, v248, v154, v155
    v_max3_f32 v248, v248, v156, v157
    v_max3_f32 v248, v248, v158, v159
    v_mfma_f32_32x32x16_bf16 v[136:151], a[200:203], v[48:51], v[136:151]
    v_max3_f32 v248, v248, v160, v161
    v_max3_f32 v248, v248, v162, v163
    v_max3_f32 v248, v248, v164, v165
    v_max3_f32 v248, v248, v166, v167
    v_mfma_f32_32x32x16_bf16 v[136:151], a[204:207], v[52:55], v[136:151]
    v_accvgpr_write_b32 a176, v152
    v_accvgpr_write_b32 a177, v153
    v_accvgpr_write_b32 a178, v154
    v_accvgpr_write_b32 a179, v155
    v_mfma_f32_32x32x16_bf16 v[136:151], a[208:211], v[56:59], v[136:151]
    v_accvgpr_write_b32 a180, v156
    v_accvgpr_write_b32 a181, v157
    v_accvgpr_write_b32 a182, v158
    v_accvgpr_write_b32 a183, v159
    v_mfma_f32_32x32x16_bf16 v[136:151], a[212:215], v[60:63], v[136:151]
    v_accvgpr_write_b32 a184, v160
    v_accvgpr_write_b32 a185, v161
    v_accvgpr_write_b32 a186, v162
    v_accvgpr_write_b32 a187, v163
    v_mfma_f32_32x32x16_bf16 v[136:151], a[216:219], v[64:67], v[136:151]
    v_accvgpr_write_b32 a188, v164
    v_accvgpr_write_b32 a189, v165
    v_accvgpr_write_b32 a190, v166
    v_accvgpr_write_b32 a191, v167
    v_mfma_f32_32x32x16_bf16 v[136:151], a[220:223], v[68:71], v[136:151]
    s_waitcnt vmcnt(24)
    ds_read_b128 v[200:203], v17 offset:0
    ds_read_b128 v[204:207], v18 offset:0
    ds_read_b128 v[208:211], v19 offset:0
    ds_read_b128 v[212:215], v20 offset:0
    ds_read_b128 v[216:219], v21 offset:0
    ds_read_b128 v[220:223], v22 offset:0
    ds_read_b128 v[224:227], v23 offset:0
    ds_read_b128 v[228:231], v24 offset:0
    s_waitcnt lgkmcnt(8)
    v_mfma_f32_32x32x16_bf16 v[152:167], v[168:171], v[40:43], 0
    s_add_u32 s69, s9, 3
    s_and_b32 s69, s69, 15
    s_lshl_b32 s69, s69, 13
    s_add_u32 m0, s88, 32768
    s_add_u32 s68, s69, 0
    buffer_load_dwordx4 v8, s[56:59], s68 offen offset:0 nt lds
    v_mfma_f32_32x32x16_bf16 v[152:167], v[172:175], v[44:47], v[152:167]
    buffer_load_dwordx4 v8, s[56:59], s68 offen offset:1024 nt lds
    s_nop 9
    v_max3_f32 v248, v248, v136, v137
    v_max3_f32 v248, v248, v138, v139
    v_max3_f32 v248, v248, v140, v141
    v_max3_f32 v248, v248, v142, v143
    v_mfma_f32_32x32x16_bf16 v[152:167], v[176:179], v[48:51], v[152:167]
    buffer_load_dwordx4 v8, s[56:59], s68 offen offset:2048 nt lds
    v_max3_f32 v248, v248, v144, v145
    v_max3_f32 v248, v248, v146, v147
    v_max3_f32 v248, v248, v148, v149
    v_max3_f32 v248, v248, v150, v151
    v_mfma_f32_32x32x16_bf16 v[152:167], v[180:183], v[52:55], v[152:167]
    buffer_load_dwordx4 v8, s[56:59], s68 offen offset:3072 nt lds
    v_accvgpr_write_b32 a192, v136
    v_accvgpr_write_b32 a193, v137
    v_accvgpr_write_b32 a194, v138
    v_accvgpr_write_b32 a195, v139
    v_mfma_f32_32x32x16_bf16 v[152:167], v[184:187], v[56:59], v[152:167]
    s_add_u32 m0, s88, 36864
    s_add_u32 s68, s69, 4096
    buffer_load_dwordx4 v8, s[56:59], s68 offen offset:0 nt lds
    v_accvgpr_write_b32 a196, v140
    v_accvgpr_write_b32 a197, v141
    v_accvgpr_write_b32 a198, v142
    v_accvgpr_write_b32 a199, v143
    v_mfma_f32_32x32x16_bf16 v[152:167], v[188:191], v[60:63], v[152:167]
    buffer_load_dwordx4 v8, s[56:59], s68 offen offset:1024 nt lds
    v_accvgpr_write_b32 a200, v144
    v_accvgpr_write_b32 a201, v145
    v_accvgpr_write_b32 a202, v146
    v_accvgpr_write_b32 a203, v147
    v_mfma_f32_32x32x16_bf16 v[152:167], v[192:195], v[64:67], v[152:167]
    buffer_load_dwordx4 v8, s[56:59], s68 offen offset:2048 nt lds
    v_accvgpr_write_b32 a204, v148
    v_accvgpr_write_b32 a205, v149
    v_accvgpr_write_b32 a206, v150
    v_accvgpr_write_b32 a207, v151
    v_mfma_f32_32x32x16_bf16 v[152:167], v[196:199], v[68:71], v[152:167]
    buffer_load_dwordx4 v8, s[56:59], s68 offen offset:3072 nt lds
    v_mfma_f32_32x32x16_bf16 v[136:151], a[224:227], v[40:43], 0
    v_mfma_f32_32x32x16_bf16 v[136:151], a[228:231], v[44:47], v[136:151]
    s_nop 9
    v_max3_f32 v248, v248, v152, v153
    v_max3_f32 v248, v248, v154, v155
    v_max3_f32 v248, v248, v156, v157
    v_max3_f32 v248, v248, v158, v159
    v_mfma_f32_32x32x16_bf16 v[136:151], a[232:235], v[48:51], v[136:151]
    v_max3_f32 v248, v248, v160, v161
    v_max3_f32 v248, v248, v162, v163
    v_max3_f32 v248, v248, v164, v165
    v_max3_f32 v248, v248, v166, v167
    v_mfma_f32_32x32x16_bf16 v[136:151], a[236:239], v[52:55], v[136:151]
    v_accvgpr_write_b32 a208, v152
    v_accvgpr_write_b32 a209, v153
    v_accvgpr_write_b32 a210, v154
    v_accvgpr_write_b32 a211, v155
    v_mfma_f32_32x32x16_bf16 v[136:151], a[240:243], v[56:59], v[136:151]
    v_accvgpr_write_b32 a212, v156
    v_accvgpr_write_b32 a213, v157
    v_accvgpr_write_b32 a214, v158
    v_accvgpr_write_b32 a215, v159
    v_mfma_f32_32x32x16_bf16 v[136:151], a[244:247], v[60:63], v[136:151]
    v_accvgpr_write_b32 a216, v160
    v_accvgpr_write_b32 a217, v161
    v_accvgpr_write_b32 a218, v162
    v_accvgpr_write_b32 a219, v163
    v_mfma_f32_32x32x16_bf16 v[136:151], a[248:251], v[64:67], v[136:151]
    v_accvgpr_write_b32 a220, v164
    v_accvgpr_write_b32 a221, v165
    v_accvgpr_write_b32 a222, v166
    v_accvgpr_write_b32 a223, v167
    v_mfma_f32_32x32x16_bf16 v[136:151], a[252:255], v[68:71], v[136:151]
    s_waitcnt lgkmcnt(0)
    v_mfma_f32_32x32x16_bf16 v[152:167], v[200:203], v[40:43], 0
    s_add_u32 s69, s9, 4
    s_and_b32 s69, s69, 15
    s_lshl_b32 s69, s69, 13
    s_add_u32 m0, s88, 0
    s_add_u32 s68, s69, 0
    buffer_load_dwordx4 v8, s[56:59], s68 offen offset:0 nt lds
    v_mfma_f32_32x32x16_bf16 v[152:167], v[204:207], v[44:47], v[152:167]
    buffer_load_dwordx4 v8, s[56:59], s68 offen offset:1024 nt lds
    s_nop 9
    v_max3_f32 v248, v248, v136, v137
    v_max3_f32 v248, v248, v138, v139
    v_max3_f32 v248, v248, v140, v141
    v_max3_f32 v248, v248, v142, v143
    v_mfma_f32_32x32x16_bf16 v[152:167], v[208:211], v[48:51], v[152:167]
    buffer_load_dwordx4 v8, s[56:59], s68 offen offset:2048 nt lds
    v_max3_f32 v248, v248, v144, v145
    v_max3_f32 v248, v248, v146, v147
    v_max3_f32 v248, v248, v148, v149
    v_max3_f32 v248, v248, v150, v151
    v_mfma_f32_32x32x16_bf16 v[152:167], v[212:215], v[52:55], v[152:167]
    buffer_load_dwordx4 v8, s[56:59], s68 offen offset:3072 nt lds
    v_accvgpr_write_b32 a224, v136
    v_accvgpr_write_b32 a225, v137
    v_accvgpr_write_b32 a226, v138
    v_accvgpr_write_b32 a227, v139
    v_mfma_f32_32x32x16_bf16 v[152:167], v[216:219], v[56:59], v[152:167]
    s_add_u32 m0, s88, 4096
    s_add_u32 s68, s69, 4096
    buffer_load_dwordx4 v8, s[56:59], s68 offen offset:0 nt lds
    v_accvgpr_write_b32 a228, v140
    v_accvgpr_write_b32 a229, v141
    v_accvgpr_write_b32 a230, v142
    v_accvgpr_write_b32 a231, v143
    v_mfma_f32_32x32x16_bf16 v[152:167], v[220:223], v[60:63], v[152:167]
    buffer_load_dwordx4 v8, s[56:59], s68 offen offset:1024 nt lds
    v_accvgpr_write_b32 a232, v144
    v_accvgpr_write_b32 a233, v145
    v_accvgpr_write_b32 a234, v146
    v_accvgpr_write_b32 a235, v147
    v_mfma_f32_32x32x16_bf16 v[152:167], v[224:227], v[64:67], v[152:167]
    buffer_load_dwordx4 v8, s[56:59], s68 offen offset:2048 nt lds
    v_accvgpr_write_b32 a236, v148
    v_accvgpr_write_b32 a237, v149
    v_accvgpr_write_b32 a238, v150
    v_accvgpr_write_b32 a239, v151
    v_mfma_f32_32x32x16_bf16 v[152:167], v[228:231], v[68:71], v[152:167]
    buffer_load_dwordx4 v8, s[56:59], s68 offen offset:3072 nt lds
    s_waitcnt vmcnt(32)
    ds_read_b64_tr_b16 v[168:169], v25 offset:8192
    ds_read_b64_tr_b16 v[170:171], v25 offset:10240
    ds_read_b64_tr_b16 v[172:173], v26 offset:8192
    ds_read_b64_tr_b16 v[174:175], v26 offset:10240
    ds_read_b64_tr_b16 v[176:177], v27 offset:8192
    ds_read_b64_tr_b16 v[178:179], v27 offset:10240
    ds_read_b64_tr_b16 v[180:181], v28 offset:8192
    ds_read_b64_tr_b16 v[182:183], v28 offset:10240
    ds_read_b64_tr_b16 v[184:185], v25 offset:12288
    ds_read_b64_tr_b16 v[186:187], v25 offset:14336
    ds_read_b64_tr_b16 v[188:189], v26 offset:12288
    ds_read_b64_tr_b16 v[190:191], v26 offset:14336
    ds_read_b64_tr_b16 v[192:193], v27 offset:12288
    ds_read_b64_tr_b16 v[194:195], v27 offset:14336
    ds_read_b64_tr_b16 v[196:197], v28 offset:12288
    ds_read_b64_tr_b16 v[198:199], v28 offset:14336
    s_nop 15
    v_max3_f32 v248, v248, v152, v153
    v_max3_f32 v248, v248, v154, v155
    v_max3_f32 v248, v248, v156, v157
    v_max3_f32 v248, v248, v158, v159
    v_max3_f32 v248, v248, v160, v161
    v_max3_f32 v248, v248, v162, v163
    v_max3_f32 v248, v248, v164, v165
    v_max3_f32 v248, v248, v166, v167
    v_accvgpr_write_b32 a240, v152
    v_accvgpr_write_b32 a241, v153
    v_accvgpr_write_b32 a242, v154
    v_accvgpr_write_b32 a243, v155
    v_accvgpr_write_b32 a244, v156
    v_accvgpr_write_b32 a245, v157
    v_accvgpr_write_b32 a246, v158
    v_accvgpr_write_b32 a247, v159
    v_accvgpr_write_b32 a248, v160
    v_accvgpr_write_b32 a249, v161
    v_accvgpr_write_b32 a250, v162
    v_accvgpr_write_b32 a251, v163
    v_accvgpr_write_b32 a252, v164
    v_accvgpr_write_b32 a253, v165
    v_accvgpr_write_b32 a254, v166
    v_accvgpr_write_b32 a255, v167
    v_mov_b32 v32, v248
    v_mov_b32 v33, v248
    s_nop 1
    v_permlane32_swap_b32 v32, v33
    s_nop 1
    v_max_f32 v248, v32, v33
    v_mul_f32 v250, s71, v248
    v_mov_b32 v249, 0

    v_accvgpr_read_b32 v136, a0
    v_accvgpr_read_b32 v137, a1
    v_accvgpr_read_b32 v138, a2
    v_accvgpr_read_b32 v139, a3
    v_accvgpr_read_b32 v140, a4
    v_accvgpr_read_b32 v141, a5
    v_accvgpr_read_b32 v142, a6
    v_accvgpr_read_b32 v143, a7
    v_accvgpr_read_b32 v144, a8
    v_accvgpr_read_b32 v145, a9
    v_accvgpr_read_b32 v146, a10
    v_accvgpr_read_b32 v147, a11
    v_accvgpr_read_b32 v148, a12
    v_accvgpr_read_b32 v149, a13
    v_accvgpr_read_b32 v150, a14
    v_accvgpr_read_b32 v151, a15
    v_fma_f32 v136, v136, s71, -v250
    v_fma_f32 v137, v137, s71, -v250
    v_fma_f32 v138, v138, s71, -v250
    v_fma_f32 v139, v139, s71, -v250
    v_fma_f32 v140, v140, s71, -v250
    v_fma_f32 v141, v141, s71, -v250
    v_fma_f32 v142, v142, s71, -v250
    v_fma_f32 v143, v143, s71, -v250
    v_fma_f32 v144, v144, s71, -v250
    v_fma_f32 v145, v145, s71, -v250
    v_fma_f32 v146, v146, s71, -v250
    v_fma_f32 v147, v147, s71, -v250
    v_fma_f32 v148, v148, s71, -v250
    v_fma_f32 v149, v149, s71, -v250
    v_fma_f32 v150, v150, s71, -v250
    v_fma_f32 v151, v151, s71, -v250
    v_exp_f32 v136, v136
    v_exp_f32 v137, v137
    v_exp_f32 v138, v138
    v_exp_f32 v139, v139
    v_exp_f32 v140, v140
    v_exp_f32 v141, v141
    v_exp_f32 v142, v142
    v_exp_f32 v143, v143
    v_exp_f32 v144, v144
    v_exp_f32 v145, v145
    v_exp_f32 v146, v146
    v_exp_f32 v147, v147
    v_exp_f32 v148, v148
    v_exp_f32 v149, v149
    v_exp_f32 v150, v150
    v_exp_f32 v151, v151
    s_nop 0
    v_cvt_pk_bf16_f32 v232, v136, v137
    v_cvt_pk_bf16_f32 v233, v138, v139
    v_cvt_pk_bf16_f32 v234, v140, v141
    v_cvt_pk_bf16_f32 v235, v142, v143
    v_cvt_pk_bf16_f32 v236, v144, v145
    v_cvt_pk_bf16_f32 v237, v146, v147
    v_cvt_pk_bf16_f32 v238, v148, v149
    v_cvt_pk_bf16_f32 v239, v150, v151
    v_add_f32 v136, v136, v137
    v_add_f32 v138, v138, v139
    v_add_f32 v140, v140, v141
    v_add_f32 v142, v142, v143
    v_add_f32 v144, v144, v145
    v_add_f32 v146, v146, v147
    v_add_f32 v148, v148, v149
    v_add_f32 v150, v150, v151
    v_add_f32 v136, v136, v138
    v_add_f32 v140, v140, v142
    v_add_f32 v144, v144, v146
    v_add_f32 v148, v148, v150
    v_add_f32 v136, v136, v140
    v_add_f32 v144, v144, v148
    v_add_f32 v136, v136, v144
    v_add_f32 v249, v249, v136
    s_waitcnt vmcnt(24)
    ds_read_b64_tr_b16 v[200:201], v25 offset:16384
    ds_read_b64_tr_b16 v[202:203], v25 offset:18432
    ds_read_b64_tr_b16 v[204:205], v26 offset:16384
    ds_read_b64_tr_b16 v[206:207], v26 offset:18432
    ds_read_b64_tr_b16 v[208:209], v27 offset:16384
    ds_read_b64_tr_b16 v[210:211], v27 offset:18432
    ds_read_b64_tr_b16 v[212:213], v28 offset:16384
    ds_read_b64_tr_b16 v[214:215], v28 offset:18432
    ds_read_b64_tr_b16 v[216:217], v25 offset:20480
    ds_read_b64_tr_b16 v[218:219], v25 offset:22528
    ds_read_b64_tr_b16 v[220:221], v26 offset:20480
    ds_read_b64_tr_b16 v[222:223], v26 offset:22528
    ds_read_b64_tr_b16 v[224:225], v27 offset:20480
    ds_read_b64_tr_b16 v[226:227], v27 offset:22528
    ds_read_b64_tr_b16 v[228:229], v28 offset:20480
    ds_read_b64_tr_b16 v[230:231], v28 offset:22528
    s_waitcnt lgkmcnt(15)
    v_mfma_f32_32x32x16_bf16 v[72:87], v[168:171], v[232:235], 0
    s_add_u32 s69, s9, 5
    s_and_b32 s69, s69, 15
    s_lshl_b32 s69, s69, 13
    s_add_u32 m0, s88, 8192
    s_add_u32 s68, s69, 0
    buffer_load_dwordx4 v8, s[56:59], s68 offen offset:0 nt lds
    v_accvgpr_read_b32 v152, a32
    v_accvgpr_read_b32 v153, a33
    v_accvgpr_read_b32 v154, a34
    v_accvgpr_read_b32 v155, a35
    v_accvgpr_read_b32 v156, a36
    v_accvgpr_read_b32 v157, a37
    v_accvgpr_read_b32 v158, a38
    v_accvgpr_read_b32 v159, a39
    v_accvgpr_read_b32 v160, a40
    v_accvgpr_read_b32 v161, a41
    v_mfma_f32_32x32x16_bf16 v[88:103], v[172:175], v[232:235], 0
    buffer_load_dwordx4 v8, s[56:59], s68 offen offset:1024 nt lds
    v_accvgpr_read_b32 v162, a42
    v_accvgpr_read_b32 v163, a43
    v_accvgpr_read_b32 v164, a44
    v_accvgpr_read_b32 v165, a45
    v_accvgpr_read_b32 v166, a46
    v_accvgpr_read_b32 v167, a47
    v_fma_f32 v152, v152, s71, -v250
    v_fma_f32 v153, v153, s71, -v250
    v_fma_f32 v154, v154, s71, -v250
    v_fma_f32 v155, v155, s71, -v250
    v_mfma_f32_32x32x16_bf16 v[104:119], v[176:179], v[232:235], 0
    buffer_load_dwordx4 v8, s[56:59], s68 offen offset:2048 nt lds
    v_fma_f32 v156, v156, s71, -v250
    v_fma_f32 v157, v157, s71, -v250
    v_fma_f32 v158, v158, s71, -v250
    v_fma_f32 v159, v159, s71, -v250
    v_fma_f32 v160, v160, s71, -v250
    v_fma_f32 v161, v161, s71, -v250
    v_fma_f32 v162, v162, s71, -v250
    v_fma_f32 v163, v163, s71, -v250
    v_fma_f32 v164, v164, s71, -v250
    v_fma_f32 v165, v165, s71, -v250
    v_mfma_f32_32x32x16_bf16 v[120:135], v[180:183], v[232:235], 0
    buffer_load_dwordx4 v8, s[56:59], s68 offen offset:3072 nt lds
    v_fma_f32 v166, v166, s71, -v250
    v_fma_f32 v167, v167, s71, -v250
    v_exp_f32 v152, v152
    v_exp_f32 v153, v153
    v_exp_f32 v154, v154
    v_exp_f32 v155, v155
    v_exp_f32 v156, v156
    v_exp_f32 v157, v157
    v_exp_f32 v158, v158
    v_exp_f32 v159, v159
    v_mfma_f32_32x32x16_bf16 v[72:87], v[184:187], v[236:239], v[72:87]
    s_add_u32 m0, s88, 12288
    s_add_u32 s68, s69, 4096
    buffer_load_dwordx4 v8, s[56:59], s68 offen offset:0 nt lds
    v_exp_f32 v160, v160
    v_exp_f32 v161, v161
    v_exp_f32 v162, v162
    v_exp_f32 v163, v163
    v_exp_f32 v164, v164
    v_exp_f32 v165, v165
    v_exp_f32 v166, v166
    v_exp_f32 v167, v167
    s_nop 0
    v_cvt_pk_bf16_f32 v240, v152, v153
    v_mfma_f32_32x32x16_bf16 v[88:103], v[188:191], v[236:239], v[88:103]
    buffer_load_dwordx4 v8, s[56:59], s68 offen offset:1024 nt lds
    v_cvt_pk_bf16_f32 v241, v154, v155
    v_cvt_pk_bf16_f32 v242, v156, v157
    v_cvt_pk_bf16_f32 v243, v158, v159
    v_cvt_pk_bf16_f32 v244, v160, v161
    v_cvt_pk_bf16_f32 v245, v162, v163
    v_cvt_pk_bf16_f32 v246, v164, v165
    v_cvt_pk_bf16_f32 v247, v166, v167
    v_add_f32 v152, v152, v153
    v_add_f32 v154, v154, v155
    v_add_f32 v156, v156, v157
    v_mfma_f32_32x32x16_bf16 v[104:119], v[192:195], v[236:239], v[104:119]
    buffer_load_dwordx4 v8, s[56:59], s68 offen offset:2048 nt lds
    v_add_f32 v158, v158, v159
    v_add_f32 v160, v160, v161
    v_add_f32 v162, v162, v163
    v_add_f32 v164, v164, v165
    v_add_f32 v166, v166, v167
    v_add_f32 v152, v152, v154
    v_add_f32 v156, v156, v158
    v_add_f32 v160, v160, v162
    v_add_f32 v164, v164, v166
    v_add_f32 v152, v152, v156
    v_mfma_f32_32x32x16_bf16 v[120:135], v[196:199], v[236:239], v[120:135]
    buffer_load_dwordx4 v8, s[56:59], s68 offen offset:3072 nt lds
    v_add_f32 v160, v160, v164
    v_add_f32 v152, v152, v160
    v_add_f32 v249, v249, v152
    s_waitcnt vmcnt(24)
    ds_read_b64_tr_b16 v[168:169], v25 offset:24576
    ds_read_b64_tr_b16 v[170:171], v25 offset:26624
    ds_read_b64_tr_b16 v[172:173], v26 offset:24576
    ds_read_b64_tr_b16 v[174:175], v26 offset:26624
    ds_read_b64_tr_b16 v[176:177], v27 offset:24576
    ds_read_b64_tr_b16 v[178:179], v27 offset:26624
    ds_read_b64_tr_b16 v[180:181], v28 offset:24576
    ds_read_b64_tr_b16 v[182:183], v28 offset:26624
    ds_read_b64_tr_b16 v[184:185], v25 offset:28672
    ds_read_b64_tr_b16 v[186:187], v25 offset:30720
    ds_read_b64_tr_b16 v[188:189], v26 offset:28672
    ds_read_b64_tr_b16 v[190:191], v26 offset:30720
    ds_read_b64_tr_b16 v[192:193], v27 offset:28672
    ds_read_b64_tr_b16 v[194:195], v27 offset:30720
    ds_read_b64_tr_b16 v[196:197], v28 offset:28672
    ds_read_b64_tr_b16 v[198:199], v28 offset:30720
    s_waitcnt lgkmcnt(15)
    v_mfma_f32_32x32x16_bf16 v[72:87], v[200:203], v[240:243], v[72:87]
    s_add_u32 s69, s9, 6
    s_and_b32 s69, s69, 15
    s_lshl_b32 s69, s69, 13
    s_add_u32 m0, s88, 16384
    s_add_u32 s68, s69, 0
    buffer_load_dwordx4 v8, s[56:59], s68 offen offset:0 nt lds
    v_accvgpr_read_b32 v136, a64
    v_accvgpr_read_b32 v137, a65
    v_accvgpr_read_b32 v138, a66
    v_accvgpr_read_b32 v139, a67
    v_accvgpr_read_b32 v140, a68
    v_accvgpr_read_b32 v141, a69
    v_accvgpr_read_b32 v142, a70
    v_accvgpr_read_b32 v143, a71
    v_accvgpr_read_b32 v144, a72
    v_accvgpr_read_b32 v145, a73
    v_mfma_f32_32x32x16_bf16 v[88:103], v[204:207], v[240:243], v[88:103]
    buffer_load_dwordx4 v8, s[56:59], s68 offen offset:1024 nt lds
    v_accvgpr_read_b32 v146, a74
    v_accvgpr_read_b32 v147, a75
    v_accvgpr_read_b32 v148, a76
    v_accvgpr_read_b32 v149, a77
    v_accvgpr_read_b32 v150, a78
    v_accvgpr_read_b32 v151, a79
    v_fma_f32 v136, v136, s71, -v250
    v_fma_f32 v137, v137, s71, -v250
    v_fma_f32 v138, v138, s71, -v250
    v_fma_f32 v139, v139, s71, -v250
    v_mfma_f32_32x32x16_bf16 v[104:119], v[208:211], v[240:243], v[104:119]
    buffer_load_dwordx4 v8, s[56:59], s68 offen offset:2048 nt lds
    v_fma_f32 v140, v140, s71, -v250
    v_fma_f32 v141, v141, s71, -v250
    v_fma_f32 v142, v142, s71, -v250
    v_fma_f32 v143, v143, s71, -v250
    v_fma_f32 v144, v144, s71, -v250
    v_fma_f32 v145, v145, s71, -v250
    v_fma_f32 v146, v146, s71, -v250
    v_fma_f32 v147, v147, s71, -v250
    v_fma_f32 v148, v148, s71, -v250
    v_fma_f32 v149, v149, s71, -v250
    v_mfma_f32_32x32x16_bf16 v[120:135], v[212:215], v[240:243], v[120:135]
    buffer_load_dwordx4 v8, s[56:59], s68 offen offset:3072 nt lds
    v_fma_f32 v150, v150, s71, -v250
    v_fma_f32 v151, v151, s71, -v250
    v_exp_f32 v136, v136
    v_exp_f32 v137, v137
    v_exp_f32 v138, v138
    v_exp_f32 v139, v139
    v_exp_f32 v140, v140
    v_exp_f32 v141, v141
    v_exp_f32 v142, v142
    v_exp_f32 v143, v143
    v_mfma_f32_32x32x16_bf16 v[72:87], v[216:219], v[244:247], v[72:87]
    s_add_u32 m0, s88, 20480
    s_add_u32 s68, s69, 4096
    buffer_load_dwordx4 v8, s[56:59], s68 offen offset:0 nt lds
    v_exp_f32 v144, v144
    v_exp_f32 v145, v145
    v_exp_f32 v146, v146
    v_exp_f32 v147, v147
    v_exp_f32 v148, v148
    v_exp_f32 v149, v149
    v_exp_f32 v150, v150
    v_exp_f32 v151, v151
    s_nop 0
    v_cvt_pk_bf16_f32 v232, v136, v137
    v_mfma_f32_32x32x16_bf16 v[88:103], v[220:223], v[244:247], v[88:103]
    buffer_load_dwordx4 v8, s[56:59], s68 offen offset:1024 nt lds
    v_cvt_pk_bf16_f32 v233, v138, v139
    v_cvt_pk_bf16_f32 v234, v140, v141
    v_cvt_pk_bf16_f32 v235, v142, v143
    v_cvt_pk_bf16_f32 v236, v144, v145
    v_cvt_pk_bf16_f32 v237, v146, v147
    v_cvt_pk_bf16_f32 v238, v148, v149
    v_cvt_pk_bf16_f32 v239, v150, v151
    v_add_f32 v136, v136, v137
    v_add_f32 v138, v138, v139
    v_add_f32 v140, v140, v141
    v_mfma_f32_32x32x16_bf16 v[104:119], v[224:227], v[244:247], v[104:119]
    buffer_load_dwordx4 v8, s[56:59], s68 offen offset:2048 nt lds
    v_add_f32 v142, v142, v143
    v_add_f32 v144, v144, v145
    v_add_f32 v146, v146, v147
    v_add_f32 v148, v148, v149
    v_add_f32 v150, v150, v151
    v_add_f32 v136, v136, v138
    v_add_f32 v140, v140, v142
    v_add_f32 v144, v144, v146
    v_add_f32 v148, v148, v150
    v_add_f32 v136, v136, v140
    v_mfma_f32_32x32x16_bf16 v[120:135], v[228:231], v[244:247], v[120:135]
    buffer_load_dwordx4 v8, s[56:59], s68 offen offset:3072 nt lds
    v_add_f32 v144, v144, v148
    v_add_f32 v136, v136, v144
    v_add_f32 v249, v249, v136
    s_waitcnt vmcnt(24)
    ds_read_b64_tr_b16 v[200:201], v25 offset:32768
    ds_read_b64_tr_b16 v[202:203], v25 offset:34816
    ds_read_b64_tr_b16 v[204:205], v26 offset:32768
    ds_read_b64_tr_b16 v[206:207], v26 offset:34816
    ds_read_b64_tr_b16 v[208:209], v27 offset:32768
    ds_read_b64_tr_b16 v[210:211], v27 offset:34816
    ds_read_b64_tr_b16 v[212:213], v28 offset:32768
    ds_read_b64_tr_b16 v[214:215], v28 offset:34816
    ds_read_b64_tr_b16 v[216:217], v25 offset:36864
    ds_read_b64_tr_b16 v[218:219], v25 offset:38912
    ds_read_b64_tr_b16 v[220:221], v26 offset:36864
    ds_read_b64_tr_b16 v[222:223], v26 offset:38912
    ds_read_b64_tr_b16 v[224:225], v27 offset:36864
    ds_read_b64_tr_b16 v[226:227], v27 offset:38912
    ds_read_b64_tr_b16 v[228:229], v28 offset:36864
    ds_read_b64_tr_b16 v[230:231], v28 offset:38912
    s_waitcnt lgkmcnt(15)
    v_mfma_f32_32x32x16_bf16 v[72:87], v[168:171], v[232:235], v[72:87]
    s_add_u32 s69, s9, 7
    s_and_b32 s69, s69, 15
    s_lshl_b32 s69, s69, 13
    s_add_u32 m0, s88, 24576
    s_add_u32 s68, s69, 0
    buffer_load_dwordx4 v8, s[56:59], s68 offen offset:0 nt lds
    v_accvgpr_read_b32 v152, a96
    v_accvgpr_read_b32 v153, a97
    v_accvgpr_read_b32 v154, a98
    v_accvgpr_read_b32 v155, a99
    v_accvgpr_read_b32 v156, a100
    v_accvgpr_read_b32 v157, a101
    v_accvgpr_read_b32 v158, a102
    v_accvgpr_read_b32 v159, a103
    v_accvgpr_read_b32 v160, a104
    v_accvgpr_read_b32 v161, a105
    v_mfma_f32_32x32x16_bf16 v[88:103], v[172:175], v[232:235], v[88:103]
    buffer_load_dwordx4 v8, s[56:59], s68 offen offset:1024 nt lds
    v_accvgpr_read_b32 v162, a106
    v_accvgpr_read_b32 v163, a107
    v_accvgpr_read_b32 v164, a108
    v_accvgpr_read_b32 v165, a109
    v_accvgpr_read_b32 v166, a110
    v_accvgpr_read_b32 v167, a111
    v_fma_f32 v152, v152, s71, -v250
    v_fma_f32 v153, v153, s71, -v250
    v_fma_f32 v154, v154, s71, -v250
    v_fma_f32 v155, v155, s71, -v250
    v_mfma_f32_32x32x16_bf16 v[104:119], v[176:179], v[232:235], v[104:119]
    buffer_load_dwordx4 v8, s[56:59], s68 offen offset:2048 nt lds
    v_fma_f32 v156, v156, s71, -v250
    v_fma_f32 v157, v157, s71, -v250
    v_fma_f32 v158, v158, s71, -v250
    v_fma_f32 v159, v159, s71, -v250
    v_fma_f32 v160, v160, s71, -v250
    v_fma_f32 v161, v161, s71, -v250
    v_fma_f32 v162, v162, s71, -v250
    v_fma_f32 v163, v163, s71, -v250
    v_fma_f32 v164, v164, s71, -v250
    v_fma_f32 v165, v165, s71, -v250
    v_mfma_f32_32x32x16_bf16 v[120:135], v[180:183], v[232:235], v[120:135]
    buffer_load_dwordx4 v8, s[56:59], s68 offen offset:3072 nt lds
    v_fma_f32 v166, v166, s71, -v250
    v_fma_f32 v167, v167, s71, -v250
    v_exp_f32 v152, v152
    v_exp_f32 v153, v153
    v_exp_f32 v154, v154
    v_exp_f32 v155, v155
    v_exp_f32 v156, v156
    v_exp_f32 v157, v157
    v_exp_f32 v158, v158
    v_exp_f32 v159, v159
    v_mfma_f32_32x32x16_bf16 v[72:87], v[184:187], v[236:239], v[72:87]
    s_add_u32 m0, s88, 28672
    s_add_u32 s68, s69, 4096
    buffer_load_dwordx4 v8, s[56:59], s68 offen offset:0 nt lds
    v_exp_f32 v160, v160
    v_exp_f32 v161, v161
    v_exp_f32 v162, v162
    v_exp_f32 v163, v163
    v_exp_f32 v164, v164
    v_exp_f32 v165, v165
    v_exp_f32 v166, v166
    v_exp_f32 v167, v167
    s_nop 0
    v_cvt_pk_bf16_f32 v240, v152, v153
    v_mfma_f32_32x32x16_bf16 v[88:103], v[188:191], v[236:239], v[88:103]
    buffer_load_dwordx4 v8, s[56:59], s68 offen offset:1024 nt lds
    v_cvt_pk_bf16_f32 v241, v154, v155
    v_cvt_pk_bf16_f32 v242, v156, v157
    v_cvt_pk_bf16_f32 v243, v158, v159
    v_cvt_pk_bf16_f32 v244, v160, v161
    v_cvt_pk_bf16_f32 v245, v162, v163
    v_cvt_pk_bf16_f32 v246, v164, v165
    v_cvt_pk_bf16_f32 v247, v166, v167
    v_add_f32 v152, v152, v153
    v_add_f32 v154, v154, v155
    v_add_f32 v156, v156, v157
    v_mfma_f32_32x32x16_bf16 v[104:119], v[192:195], v[236:239], v[104:119]
    buffer_load_dwordx4 v8, s[56:59], s68 offen offset:2048 nt lds
    v_add_f32 v158, v158, v159
    v_add_f32 v160, v160, v161
    v_add_f32 v162, v162, v163
    v_add_f32 v164, v164, v165
    v_add_f32 v166, v166, v167
    v_add_f32 v152, v152, v154
    v_add_f32 v156, v156, v158
    v_add_f32 v160, v160, v162
    v_add_f32 v164, v164, v166
    v_add_f32 v152, v152, v156
    v_mfma_f32_32x32x16_bf16 v[120:135], v[196:199], v[236:239], v[120:135]
    buffer_load_dwordx4 v8, s[56:59], s68 offen offset:3072 nt lds
    v_add_f32 v160, v160, v164
    v_add_f32 v152, v152, v160
    v_add_f32 v249, v249, v152
    s_waitcnt vmcnt(24)
    ds_read_b64_tr_b16 v[168:169], v25 offset:0
    ds_read_b64_tr_b16 v[170:171], v25 offset:2048
    ds_read_b64_tr_b16 v[172:173], v26 offset:0
    ds_read_b64_tr_b16 v[174:175], v26 offset:2048
    ds_read_b64_tr_b16 v[176:177], v27 offset:0
    ds_read_b64_tr_b16 v[178:179], v27 offset:2048
    ds_read_b64_tr_b16 v[180:181], v28 offset:0
    ds_read_b64_tr_b16 v[182:183], v28 offset:2048
    ds_read_b64_tr_b16 v[184:185], v25 offset:4096
    ds_read_b64_tr_b16 v[186:187], v25 offset:6144
    ds_read_b64_tr_b16 v[188:189], v26 offset:4096
    ds_read_b64_tr_b16 v[190:191], v26 offset:6144
    ds_read_b64_tr_b16 v[192:193], v27 offset:4096
    ds_read_b64_tr_b16 v[194:195], v27 offset:6144
    ds_read_b64_tr_b16 v[196:197], v28 offset:4096
    ds_read_b64_tr_b16 v[198:199], v28 offset:6144
    s_waitcnt lgkmcnt(15)
    v_mfma_f32_32x32x16_bf16 v[72:87], v[200:203], v[240:243], v[72:87]
    s_add_u32 s69, s9, 8
    s_and_b32 s69, s69, 15
    s_lshl_b32 s69, s69, 13
    s_add_u32 m0, s88, 32768
    s_add_u32 s68, s69, 0
    buffer_load_dwordx4 v8, s[56:59], s68 offen offset:0 nt lds
    v_accvgpr_read_b32 v136, a128
    v_accvgpr_read_b32 v137, a129
    v_accvgpr_read_b32 v138, a130
    v_accvgpr_read_b32 v139, a131
    v_accvgpr_read_b32 v140, a132
    v_accvgpr_read_b32 v141, a133
    v_accvgpr_read_b32 v142, a134
    v_accvgpr_read_b32 v143, a135
    v_accvgpr_read_b32 v144, a136
    v_accvgpr_read_b32 v145, a137
    v_mfma_f32_32x32x16_bf16 v[88:103], v[204:207], v[240:243], v[88:103]
    buffer_load_dwordx4 v8, s[56:59], s68 offen offset:1024 nt lds
    v_accvgpr_read_b32 v146, a138
    v_accvgpr_read_b32 v147, a139
    v_accvgpr_read_b32 v148, a140
    v_accvgpr_read_b32 v149, a141
    v_accvgpr_read_b32 v150, a142
    v_accvgpr_read_b32 v151, a143
    v_fma_f32 v136, v136, s71, -v250
    v_fma_f32 v137, v137, s71, -v250
    v_fma_f32 v138, v138, s71, -v250
    v_fma_f32 v139, v139, s71, -v250
    v_mfma_f32_32x32x16_bf16 v[104:119], v[208:211], v[240:243], v[104:119]
    buffer_load_dwordx4 v8, s[56:59], s68 offen offset:2048 nt lds
    v_fma_f32 v140, v140, s71, -v250
    v_fma_f32 v141, v141, s71, -v250
    v_fma_f32 v142, v142, s71, -v250
    v_fma_f32 v143, v143, s71, -v250
    v_fma_f32 v144, v144, s71, -v250
    v_fma_f32 v145, v145, s71, -v250
    v_fma_f32 v146, v146, s71, -v250
    v_fma_f32 v147, v147, s71, -v250
    v_fma_f32 v148, v148, s71, -v250
    v_fma_f32 v149, v149, s71, -v250
    v_mfma_f32_32x32x16_bf16 v[120:135], v[212:215], v[240:243], v[120:135]
    buffer_load_dwordx4 v8, s[56:59], s68 offen offset:3072 nt lds
    v_fma_f32 v150, v150, s71, -v250
    v_fma_f32 v151, v151, s71, -v250
    v_exp_f32 v136, v136
    v_exp_f32 v137, v137
    v_exp_f32 v138, v138
    v_exp_f32 v139, v139
    v_exp_f32 v140, v140
    v_exp_f32 v141, v141
    v_exp_f32 v142, v142
    v_exp_f32 v143, v143
    v_mfma_f32_32x32x16_bf16 v[72:87], v[216:219], v[244:247], v[72:87]
    s_add_u32 m0, s88, 36864
    s_add_u32 s68, s69, 4096
    buffer_load_dwordx4 v8, s[56:59], s68 offen offset:0 nt lds
    v_exp_f32 v144, v144
    v_exp_f32 v145, v145
    v_exp_f32 v146, v146
    v_exp_f32 v147, v147
    v_exp_f32 v148, v148
    v_exp_f32 v149, v149
    v_exp_f32 v150, v150
    v_exp_f32 v151, v151
    s_nop 0
    v_cvt_pk_bf16_f32 v232, v136, v137
    v_mfma_f32_32x32x16_bf16 v[88:103], v[220:223], v[244:247], v[88:103]
    buffer_load_dwordx4 v8, s[56:59], s68 offen offset:1024 nt lds
    v_cvt_pk_bf16_f32 v233, v138, v139
    v_cvt_pk_bf16_f32 v234, v140, v141
    v_cvt_pk_bf16_f32 v235, v142, v143
    v_cvt_pk_bf16_f32 v236, v144, v145
    v_cvt_pk_bf16_f32 v237, v146, v147
    v_cvt_pk_bf16_f32 v238, v148, v149
    v_cvt_pk_bf16_f32 v239, v150, v151
    v_add_f32 v136, v136, v137
    v_add_f32 v138, v138, v139
    v_add_f32 v140, v140, v141
    v_mfma_f32_32x32x16_bf16 v[104:119], v[224:227], v[244:247], v[104:119]
    buffer_load_dwordx4 v8, s[56:59], s68 offen offset:2048 nt lds
    v_add_f32 v142, v142, v143
    v_add_f32 v144, v144, v145
    v_add_f32 v146, v146, v147
    v_add_f32 v148, v148, v149
    v_add_f32 v150, v150, v151
    v_add_f32 v136, v136, v138
    v_add_f32 v140, v140, v142
    v_add_f32 v144, v144, v146
    v_add_f32 v148, v148, v150
    v_add_f32 v136, v136, v140
    v_mfma_f32_32x32x16_bf16 v[120:135], v[228:231], v[244:247], v[120:135]
    buffer_load_dwordx4 v8, s[56:59], s68 offen offset:3072 nt lds
    v_add_f32 v144, v144, v148
    v_add_f32 v136, v136, v144
    v_add_f32 v249, v249, v136
    s_waitcnt vmcnt(24)
    ds_read_b64_tr_b16 v[200:201], v25 offset:8192
    ds_read_b64_tr_b16 v[202:203], v25 offset:10240
    ds_read_b64_tr_b16 v[204:205], v26 offset:8192
    ds_read_b64_tr_b16 v[206:207], v26 offset:10240
    ds_read_b64_tr_b16 v[208:209], v27 offset:8192
    ds_read_b64_tr_b16 v[210:211], v27 offset:10240
    ds_read_b64_tr_b16 v[212:213], v28 offset:8192
    ds_read_b64_tr_b16 v[214:215], v28 offset:10240
    ds_read_b64_tr_b16 v[216:217], v25 offset:12288
    ds_read_b64_tr_b16 v[218:219], v25 offset:14336
    ds_read_b64_tr_b16 v[220:221], v26 offset:12288
    ds_read_b64_tr_b16 v[222:223], v26 offset:14336
    ds_read_b64_tr_b16 v[224:225], v27 offset:12288
    ds_read_b64_tr_b16 v[226:227], v27 offset:14336
    ds_read_b64_tr_b16 v[228:229], v28 offset:12288
    ds_read_b64_tr_b16 v[230:231], v28 offset:14336
    s_waitcnt lgkmcnt(15)
    v_mfma_f32_32x32x16_bf16 v[72:87], v[168:171], v[232:235], v[72:87]
    s_add_u32 s69, s9, 9
    s_and_b32 s69, s69, 15
    s_lshl_b32 s69, s69, 13
    s_add_u32 m0, s88, 0
    s_add_u32 s68, s69, 0
    buffer_load_dwordx4 v8, s[56:59], s68 offen offset:0 nt lds
    v_accvgpr_read_b32 v152, a160
    v_accvgpr_read_b32 v153, a161
    v_accvgpr_read_b32 v154, a162
    v_accvgpr_read_b32 v155, a163
    v_accvgpr_read_b32 v156, a164
    v_accvgpr_read_b32 v157, a165
    v_accvgpr_read_b32 v158, a166
    v_accvgpr_read_b32 v159, a167
    v_accvgpr_read_b32 v160, a168
    v_accvgpr_read_b32 v161, a169
    v_mfma_f32_32x32x16_bf16 v[88:103], v[172:175], v[232:235], v[88:103]
    buffer_load_dwordx4 v8, s[56:59], s68 offen offset:1024 nt lds
    v_accvgpr_read_b32 v162, a170
    v_accvgpr_read_b32 v163, a171
    v_accvgpr_read_b32 v164, a172
    v_accvgpr_read_b32 v165, a173
    v_accvgpr_read_b32 v166, a174
    v_accvgpr_read_b32 v167, a175
    v_fma_f32 v152, v152, s71, -v250
    v_fma_f32 v153, v153, s71, -v250
    v_fma_f32 v154, v154, s71, -v250
    v_fma_f32 v155, v155, s71, -v250
    v_mfma_f32_32x32x16_bf16 v[104:119], v[176:179], v[232:235], v[104:119]
    buffer_load_dwordx4 v8, s[56:59], s68 offen offset:2048 nt lds
    v_fma_f32 v156, v156, s71, -v250
    v_fma_f32 v157, v157, s71, -v250
    v_fma_f32 v158, v158, s71, -v250
    v_fma_f32 v159, v159, s71, -v250
    v_fma_f32 v160, v160, s71, -v250
    v_fma_f32 v161, v161, s71, -v250
    v_fma_f32 v162, v162, s71, -v250
    v_fma_f32 v163, v163, s71, -v250
    v_fma_f32 v164, v164, s71, -v250
    v_fma_f32 v165, v165, s71, -v250
    v_mfma_f32_32x32x16_bf16 v[120:135], v[180:183], v[232:235], v[120:135]
    buffer_load_dwordx4 v8, s[56:59], s68 offen offset:3072 nt lds
    v_fma_f32 v166, v166, s71, -v250
    v_fma_f32 v167, v167, s71, -v250
    v_exp_f32 v152, v152
    v_exp_f32 v153, v153
    v_exp_f32 v154, v154
    v_exp_f32 v155, v155
    v_exp_f32 v156, v156
    v_exp_f32 v157, v157
    v_exp_f32 v158, v158
    v_exp_f32 v159, v159
    v_mfma_f32_32x32x16_bf16 v[72:87], v[184:187], v[236:239], v[72:87]
    s_add_u32 m0, s88, 4096
    s_add_u32 s68, s69, 4096
    buffer_load_dwordx4 v8, s[56:59], s68 offen offset:0 nt lds
    v_exp_f32 v160, v160
    v_exp_f32 v161, v161
    v_exp_f32 v162, v162
    v_exp_f32 v163, v163
    v_exp_f32 v164, v164
    v_exp_f32 v165, v165
    v_exp_f32 v166, v166
    v_exp_f32 v167, v167
    s_nop 0
    v_cvt_pk_bf16_f32 v240, v152, v153
    v_mfma_f32_32x32x16_bf16 v[88:103], v[188:191], v[236:239], v[88:103]
    buffer_load_dwordx4 v8, s[56:59], s68 offen offset:1024 nt lds
    v_cvt_pk_bf16_f32 v241, v154, v155
    v_cvt_pk_bf16_f32 v242, v156, v157
    v_cvt_pk_bf16_f32 v243, v158, v159
    v_cvt_pk_bf16_f32 v244, v160, v161
    v_cvt_pk_bf16_f32 v245, v162, v163
    v_cvt_pk_bf16_f32 v246, v164, v165
    v_cvt_pk_bf16_f32 v247, v166, v167
    v_add_f32 v152, v152, v153
    v_add_f32 v154, v154, v155
    v_add_f32 v156, v156, v157
    v_mfma_f32_32x32x16_bf16 v[104:119], v[192:195], v[236:239], v[104:119]
    buffer_load_dwordx4 v8, s[56:59], s68 offen offset:2048 nt lds
    v_add_f32 v158, v158, v159
    v_add_f32 v160, v160, v161
    v_add_f32 v162, v162, v163
    v_add_f32 v164, v164, v165
    v_add_f32 v166, v166, v167
    v_add_f32 v152, v152, v154
    v_add_f32 v156, v156, v158
    v_add_f32 v160, v160, v162
    v_add_f32 v164, v164, v166
    v_add_f32 v152, v152, v156
    v_mfma_f32_32x32x16_bf16 v[120:135], v[196:199], v[236:239], v[120:135]
    buffer_load_dwordx4 v8, s[56:59], s68 offen offset:3072 nt lds
    v_add_f32 v160, v160, v164
    v_add_f32 v152, v152, v160
    v_add_f32 v249, v249, v152
    s_waitcnt vmcnt(24)
    ds_read_b64_tr_b16 v[168:169], v25 offset:16384
    ds_read_b64_tr_b16 v[170:171], v25 offset:18432
    ds_read_b64_tr_b16 v[172:173], v26 offset:16384
    ds_read_b64_tr_b16 v[174:175], v26 offset:18432
    ds_read_b64_tr_b16 v[176:177], v27 offset:16384
    ds_read_b64_tr_b16 v[178:179], v27 offset:18432
    ds_read_b64_tr_b16 v[180:181], v28 offset:16384
    ds_read_b64_tr_b16 v[182:183], v28 offset:18432
    ds_read_b64_tr_b16 v[184:185], v25 offset:20480
    ds_read_b64_tr_b16 v[186:187], v25 offset:22528
    ds_read_b64_tr_b16 v[188:189], v26 offset:20480
    ds_read_b64_tr_b16 v[190:191], v26 offset:22528
    ds_read_b64_tr_b16 v[192:193], v27 offset:20480
    ds_read_b64_tr_b16 v[194:195], v27 offset:22528
    ds_read_b64_tr_b16 v[196:197], v28 offset:20480
    ds_read_b64_tr_b16 v[198:199], v28 offset:22528
    s_waitcnt lgkmcnt(15)
    v_mfma_f32_32x32x16_bf16 v[72:87], v[200:203], v[240:243], v[72:87]
    s_add_u32 s69, s9, 10
    s_and_b32 s69, s69, 15
    s_lshl_b32 s69, s69, 13
    s_add_u32 m0, s88, 8192
    s_add_u32 s68, s69, 0
    buffer_load_dwordx4 v8, s[56:59], s68 offen offset:0 nt lds
    v_accvgpr_read_b32 v136, a192
    v_accvgpr_read_b32 v137, a193
    v_accvgpr_read_b32 v138, a194
    v_accvgpr_read_b32 v139, a195
    v_accvgpr_read_b32 v140, a196
    v_accvgpr_read_b32 v141, a197
    v_accvgpr_read_b32 v142, a198
    v_accvgpr_read_b32 v143, a199
    v_accvgpr_read_b32 v144, a200
    v_accvgpr_read_b32 v145, a201
    v_mfma_f32_32x32x16_bf16 v[88:103], v[204:207], v[240:243], v[88:103]
    buffer_load_dwordx4 v8, s[56:59], s68 offen offset:1024 nt lds
    v_accvgpr_read_b32 v146, a202
    v_accvgpr_read_b32 v147, a203
    v_accvgpr_read_b32 v148, a204
    v_accvgpr_read_b32 v149, a205
    v_accvgpr_read_b32 v150, a206
    v_accvgpr_read_b32 v151, a207
    v_fma_f32 v136, v136, s71, -v250
    v_fma_f32 v137, v137, s71, -v250
    v_fma_f32 v138, v138, s71, -v250
    v_fma_f32 v139, v139, s71, -v250
    v_mfma_f32_32x32x16_bf16 v[104:119], v[208:211], v[240:243], v[104:119]
    buffer_load_dwordx4 v8, s[56:59], s68 offen offset:2048 nt lds
    v_fma_f32 v140, v140, s71, -v250
    v_fma_f32 v141, v141, s71, -v250
    v_fma_f32 v142, v142, s71, -v250
    v_fma_f32 v143, v143, s71, -v250
    v_fma_f32 v144, v144, s71, -v250
    v_fma_f32 v145, v145, s71, -v250
    v_fma_f32 v146, v146, s71, -v250
    v_fma_f32 v147, v147, s71, -v250
    v_fma_f32 v148, v148, s71, -v250
    v_fma_f32 v149, v149, s71, -v250
    v_mfma_f32_32x32x16_bf16 v[120:135], v[212:215], v[240:243], v[120:135]
    buffer_load_dwordx4 v8, s[56:59], s68 offen offset:3072 nt lds
    v_fma_f32 v150, v150, s71, -v250
    v_fma_f32 v151, v151, s71, -v250
    v_exp_f32 v136, v136
    v_exp_f32 v137, v137
    v_exp_f32 v138, v138
    v_exp_f32 v139, v139
    v_exp_f32 v140, v140
    v_exp_f32 v141, v141
    v_exp_f32 v142, v142
    v_exp_f32 v143, v143
    v_mfma_f32_32x32x16_bf16 v[72:87], v[216:219], v[244:247], v[72:87]
    s_add_u32 m0, s88, 12288
    s_add_u32 s68, s69, 4096
    buffer_load_dwordx4 v8, s[56:59], s68 offen offset:0 nt lds
    v_exp_f32 v144, v144
    v_exp_f32 v145, v145
    v_exp_f32 v146, v146
    v_exp_f32 v147, v147
    v_exp_f32 v148, v148
    v_exp_f32 v149, v149
    v_exp_f32 v150, v150
    v_exp_f32 v151, v151
    s_nop 0
    v_cvt_pk_bf16_f32 v232, v136, v137
    v_mfma_f32_32x32x16_bf16 v[88:103], v[220:223], v[244:247], v[88:103]
    buffer_load_dwordx4 v8, s[56:59], s68 offen offset:1024 nt lds
    v_cvt_pk_bf16_f32 v233, v138, v139
    v_cvt_pk_bf16_f32 v234, v140, v141
    v_cvt_pk_bf16_f32 v235, v142, v143
    v_cvt_pk_bf16_f32 v236, v144, v145
    v_cvt_pk_bf16_f32 v237, v146, v147
    v_cvt_pk_bf16_f32 v238, v148, v149
    v_cvt_pk_bf16_f32 v239, v150, v151
    v_add_f32 v136, v136, v137
    v_add_f32 v138, v138, v139
    v_add_f32 v140, v140, v141
    v_mfma_f32_32x32x16_bf16 v[104:119], v[224:227], v[244:247], v[104:119]
    buffer_load_dwordx4 v8, s[56:59], s68 offen offset:2048 nt lds
    v_add_f32 v142, v142, v143
    v_add_f32 v144, v144, v145
    v_add_f32 v146, v146, v147
    v_add_f32 v148, v148, v149
    v_add_f32 v150, v150, v151
    v_add_f32 v136, v136, v138
    v_add_f32 v140, v140, v142
    v_add_f32 v144, v144, v146
    v_add_f32 v148, v148, v150
    v_add_f32 v136, v136, v140
    v_mfma_f32_32x32x16_bf16 v[120:135], v[228:231], v[244:247], v[120:135]
    buffer_load_dwordx4 v8, s[56:59], s68 offen offset:3072 nt lds
    v_add_f32 v144, v144, v148
    v_add_f32 v136, v136, v144
    v_add_f32 v249, v249, v136
    s_waitcnt vmcnt(24)
    ds_read_b64_tr_b16 v[200:201], v25 offset:24576
    ds_read_b64_tr_b16 v[202:203], v25 offset:26624
    ds_read_b64_tr_b16 v[204:205], v26 offset:24576
    ds_read_b64_tr_b16 v[206:207], v26 offset:26624
    ds_read_b64_tr_b16 v[208:209], v27 offset:24576
    ds_read_b64_tr_b16 v[210:211], v27 offset:26624
    ds_read_b64_tr_b16 v[212:213], v28 offset:24576
    ds_read_b64_tr_b16 v[214:215], v28 offset:26624
    ds_read_b64_tr_b16 v[216:217], v25 offset:28672
    ds_read_b64_tr_b16 v[218:219], v25 offset:30720
    ds_read_b64_tr_b16 v[220:221], v26 offset:28672
    ds_read_b64_tr_b16 v[222:223], v26 offset:30720
    ds_read_b64_tr_b16 v[224:225], v27 offset:28672
    ds_read_b64_tr_b16 v[226:227], v27 offset:30720
    ds_read_b64_tr_b16 v[228:229], v28 offset:28672
    ds_read_b64_tr_b16 v[230:231], v28 offset:30720
    s_waitcnt lgkmcnt(15)
    v_mfma_f32_32x32x16_bf16 v[72:87], v[168:171], v[232:235], v[72:87]
    s_add_u32 s69, s9, 11
    s_and_b32 s69, s69, 15
    s_lshl_b32 s69, s69, 13
    s_add_u32 m0, s88, 16384
    s_add_u32 s68, s69, 0
    buffer_load_dwordx4 v8, s[56:59], s68 offen offset:0 nt lds
    v_accvgpr_read_b32 v152, a224
    v_accvgpr_read_b32 v153, a225
    v_accvgpr_read_b32 v154, a226
    v_accvgpr_read_b32 v155, a227
    v_accvgpr_read_b32 v156, a228
    v_accvgpr_read_b32 v157, a229
    v_accvgpr_read_b32 v158, a230
    v_accvgpr_read_b32 v159, a231
    v_accvgpr_read_b32 v160, a232
    v_accvgpr_read_b32 v161, a233
    v_mfma_f32_32x32x16_bf16 v[88:103], v[172:175], v[232:235], v[88:103]
    buffer_load_dwordx4 v8, s[56:59], s68 offen offset:1024 nt lds
    v_accvgpr_read_b32 v162, a234
    v_accvgpr_read_b32 v163, a235
    v_accvgpr_read_b32 v164, a236
    v_accvgpr_read_b32 v165, a237
    v_accvgpr_read_b32 v166, a238
    v_accvgpr_read_b32 v167, a239
    v_fma_f32 v152, v152, s71, -v250
    v_fma_f32 v153, v153, s71, -v250
    v_fma_f32 v154, v154, s71, -v250
    v_fma_f32 v155, v155, s71, -v250
    v_mfma_f32_32x32x16_bf16 v[104:119], v[176:179], v[232:235], v[104:119]
    buffer_load_dwordx4 v8, s[56:59], s68 offen offset:2048 nt lds
    v_fma_f32 v156, v156, s71, -v250
    v_fma_f32 v157, v157, s71, -v250
    v_fma_f32 v158, v158, s71, -v250
    v_fma_f32 v159, v159, s71, -v250
    v_fma_f32 v160, v160, s71, -v250
    v_fma_f32 v161, v161, s71, -v250
    v_fma_f32 v162, v162, s71, -v250
    v_fma_f32 v163, v163, s71, -v250
    v_fma_f32 v164, v164, s71, -v250
    v_fma_f32 v165, v165, s71, -v250
    v_mfma_f32_32x32x16_bf16 v[120:135], v[180:183], v[232:235], v[120:135]
    buffer_load_dwordx4 v8, s[56:59], s68 offen offset:3072 nt lds
    v_fma_f32 v166, v166, s71, -v250
    v_fma_f32 v167, v167, s71, -v250
    v_exp_f32 v152, v152
    v_exp_f32 v153, v153
    v_exp_f32 v154, v154
    v_exp_f32 v155, v155
    v_exp_f32 v156, v156
    v_exp_f32 v157, v157
    v_exp_f32 v158, v158
    v_exp_f32 v159, v159
    v_mfma_f32_32x32x16_bf16 v[72:87], v[184:187], v[236:239], v[72:87]
    s_add_u32 m0, s88, 20480
    s_add_u32 s68, s69, 4096
    buffer_load_dwordx4 v8, s[56:59], s68 offen offset:0 nt lds
    v_exp_f32 v160, v160
    v_exp_f32 v161, v161
    v_exp_f32 v162, v162
    v_exp_f32 v163, v163
    v_exp_f32 v164, v164
    v_exp_f32 v165, v165
    v_exp_f32 v166, v166
    v_exp_f32 v167, v167
    s_nop 0
    v_cvt_pk_bf16_f32 v240, v152, v153
    v_mfma_f32_32x32x16_bf16 v[88:103], v[188:191], v[236:239], v[88:103]
    buffer_load_dwordx4 v8, s[56:59], s68 offen offset:1024 nt lds
    v_cvt_pk_bf16_f32 v241, v154, v155
    v_cvt_pk_bf16_f32 v242, v156, v157
    v_cvt_pk_bf16_f32 v243, v158, v159
    v_cvt_pk_bf16_f32 v244, v160, v161
    v_cvt_pk_bf16_f32 v245, v162, v163
    v_cvt_pk_bf16_f32 v246, v164, v165
    v_cvt_pk_bf16_f32 v247, v166, v167
    v_add_f32 v152, v152, v153
    v_add_f32 v154, v154, v155
    v_add_f32 v156, v156, v157
    v_mfma_f32_32x32x16_bf16 v[104:119], v[192:195], v[236:239], v[104:119]
    buffer_load_dwordx4 v8, s[56:59], s68 offen offset:2048 nt lds
    v_add_f32 v158, v158, v159
    v_add_f32 v160, v160, v161
    v_add_f32 v162, v162, v163
    v_add_f32 v164, v164, v165
    v_add_f32 v166, v166, v167
    v_add_f32 v152, v152, v154
    v_add_f32 v156, v156, v158
    v_add_f32 v160, v160, v162
    v_add_f32 v164, v164, v166
    v_add_f32 v152, v152, v156
    v_mfma_f32_32x32x16_bf16 v[120:135], v[196:199], v[236:239], v[120:135]
    buffer_load_dwordx4 v8, s[56:59], s68 offen offset:3072 nt lds
    v_add_f32 v160, v160, v164
    v_add_f32 v152, v152, v160
    v_add_f32 v249, v249, v152
    s_waitcnt vmcnt(24)
    ds_read_b64_tr_b16 v[168:169], v25 offset:32768
    ds_read_b64_tr_b16 v[170:171], v25 offset:34816
    ds_read_b64_tr_b16 v[172:173], v26 offset:32768
    ds_read_b64_tr_b16 v[174:175], v26 offset:34816
    ds_read_b64_tr_b16 v[176:177], v27 offset:32768
    ds_read_b64_tr_b16 v[178:179], v27 offset:34816
    ds_read_b64_tr_b16 v[180:181], v28 offset:32768
    ds_read_b64_tr_b16 v[182:183], v28 offset:34816
    ds_read_b64_tr_b16 v[184:185], v25 offset:36864
    ds_read_b64_tr_b16 v[186:187], v25 offset:38912
    ds_read_b64_tr_b16 v[188:189], v26 offset:36864
    ds_read_b64_tr_b16 v[190:191], v26 offset:38912
    ds_read_b64_tr_b16 v[192:193], v27 offset:36864
    ds_read_b64_tr_b16 v[194:195], v27 offset:38912
    ds_read_b64_tr_b16 v[196:197], v28 offset:36864
    ds_read_b64_tr_b16 v[198:199], v28 offset:38912
    s_waitcnt lgkmcnt(15)
    v_mfma_f32_32x32x16_bf16 v[72:87], v[200:203], v[240:243], v[72:87]
    s_add_u32 s69, s9, 12
    s_and_b32 s69, s69, 15
    s_lshl_b32 s69, s69, 13
    s_add_u32 m0, s88, 24576
    s_add_u32 s68, s69, 0
    buffer_load_dwordx4 v8, s[56:59], s68 offen offset:0 nt lds
    v_accvgpr_read_b32 v136, a16
    v_accvgpr_read_b32 v137, a17
    v_accvgpr_read_b32 v138, a18
    v_accvgpr_read_b32 v139, a19
    v_accvgpr_read_b32 v140, a20
    v_accvgpr_read_b32 v141, a21
    v_accvgpr_read_b32 v142, a22
    v_accvgpr_read_b32 v143, a23
    v_accvgpr_read_b32 v144, a24
    v_accvgpr_read_b32 v145, a25
    v_mfma_f32_32x32x16_bf16 v[88:103], v[204:207], v[240:243], v[88:103]
    buffer_load_dwordx4 v8, s[56:59], s68 offen offset:1024 nt lds
    v_accvgpr_read_b32 v146, a26
    v_accvgpr_read_b32 v147, a27
    v_accvgpr_read_b32 v148, a28
    v_accvgpr_read_b32 v149, a29
    v_accvgpr_read_b32 v150, a30
    v_accvgpr_read_b32 v151, a31
    v_fma_f32 v136, v136, s71, -v250
    v_fma_f32 v137, v137, s71, -v250
    v_fma_f32 v138, v138, s71, -v250
    v_fma_f32 v139, v139, s71, -v250
    v_mfma_f32_32x32x16_bf16 v[104:119], v[208:211], v[240:243], v[104:119]
    buffer_load_dwordx4 v8, s[56:59], s68 offen offset:2048 nt lds
    v_fma_f32 v140, v140, s71, -v250
    v_fma_f32 v141, v141, s71, -v250
    v_fma_f32 v142, v142, s71, -v250
    v_fma_f32 v143, v143, s71, -v250
    v_fma_f32 v144, v144, s71, -v250
    v_fma_f32 v145, v145, s71, -v250
    v_fma_f32 v146, v146, s71, -v250
    v_fma_f32 v147, v147, s71, -v250
    v_fma_f32 v148, v148, s71, -v250
    v_fma_f32 v149, v149, s71, -v250
    v_mfma_f32_32x32x16_bf16 v[120:135], v[212:215], v[240:243], v[120:135]
    buffer_load_dwordx4 v8, s[56:59], s68 offen offset:3072 nt lds
    v_fma_f32 v150, v150, s71, -v250
    v_fma_f32 v151, v151, s71, -v250
    v_exp_f32 v136, v136
    v_exp_f32 v137, v137
    v_exp_f32 v138, v138
    v_exp_f32 v139, v139
    v_exp_f32 v140, v140
    v_exp_f32 v141, v141
    v_exp_f32 v142, v142
    v_exp_f32 v143, v143
    v_mfma_f32_32x32x16_bf16 v[72:87], v[216:219], v[244:247], v[72:87]
    s_add_u32 m0, s88, 28672
    s_add_u32 s68, s69, 4096
    buffer_load_dwordx4 v8, s[56:59], s68 offen offset:0 nt lds
    v_exp_f32 v144, v144
    v_exp_f32 v145, v145
    v_exp_f32 v146, v146
    v_exp_f32 v147, v147
    v_exp_f32 v148, v148
    v_exp_f32 v149, v149
    v_exp_f32 v150, v150
    v_exp_f32 v151, v151
    s_nop 0
    v_cvt_pk_bf16_f32 v232, v136, v137
    v_mfma_f32_32x32x16_bf16 v[88:103], v[220:223], v[244:247], v[88:103]
    buffer_load_dwordx4 v8, s[56:59], s68 offen offset:1024 nt lds
    v_cvt_pk_bf16_f32 v233, v138, v139
    v_cvt_pk_bf16_f32 v234, v140, v141
    v_cvt_pk_bf16_f32 v235, v142, v143
    v_cvt_pk_bf16_f32 v236, v144, v145
    v_cvt_pk_bf16_f32 v237, v146, v147
    v_cvt_pk_bf16_f32 v238, v148, v149
    v_cvt_pk_bf16_f32 v239, v150, v151
    v_add_f32 v136, v136, v137
    v_add_f32 v138, v138, v139
    v_add_f32 v140, v140, v141
    v_mfma_f32_32x32x16_bf16 v[104:119], v[224:227], v[244:247], v[104:119]
    buffer_load_dwordx4 v8, s[56:59], s68 offen offset:2048 nt lds
    v_add_f32 v142, v142, v143
    v_add_f32 v144, v144, v145
    v_add_f32 v146, v146, v147
    v_add_f32 v148, v148, v149
    v_add_f32 v150, v150, v151
    v_add_f32 v136, v136, v138
    v_add_f32 v140, v140, v142
    v_add_f32 v144, v144, v146
    v_add_f32 v148, v148, v150
    v_add_f32 v136, v136, v140
    v_mfma_f32_32x32x16_bf16 v[120:135], v[228:231], v[244:247], v[120:135]
    buffer_load_dwordx4 v8, s[56:59], s68 offen offset:3072 nt lds
    v_add_f32 v144, v144, v148
    v_add_f32 v136, v136, v144
    v_add_f32 v249, v249, v136
    s_waitcnt vmcnt(24)
    ds_read_b64_tr_b16 v[200:201], v25 offset:0
    ds_read_b64_tr_b16 v[202:203], v25 offset:2048
    ds_read_b64_tr_b16 v[204:205], v26 offset:0
    ds_read_b64_tr_b16 v[206:207], v26 offset:2048
    ds_read_b64_tr_b16 v[208:209], v27 offset:0
    ds_read_b64_tr_b16 v[210:211], v27 offset:2048
    ds_read_b64_tr_b16 v[212:213], v28 offset:0
    ds_read_b64_tr_b16 v[214:215], v28 offset:2048
    ds_read_b64_tr_b16 v[216:217], v25 offset:4096
    ds_read_b64_tr_b16 v[218:219], v25 offset:6144
    ds_read_b64_tr_b16 v[220:221], v26 offset:4096
    ds_read_b64_tr_b16 v[222:223], v26 offset:6144
    ds_read_b64_tr_b16 v[224:225], v27 offset:4096
    ds_read_b64_tr_b16 v[226:227], v27 offset:6144
    ds_read_b64_tr_b16 v[228:229], v28 offset:4096
    ds_read_b64_tr_b16 v[230:231], v28 offset:6144
    s_waitcnt lgkmcnt(15)
    v_mfma_f32_32x32x16_bf16 v[72:87], v[168:171], v[232:235], v[72:87]
    s_add_u32 s69, s9, 13
    s_and_b32 s69, s69, 15
    s_lshl_b32 s69, s69, 13
    s_add_u32 m0, s88, 32768
    s_add_u32 s68, s69, 0
    buffer_load_dwordx4 v8, s[56:59], s68 offen offset:0 nt lds
    v_accvgpr_read_b32 v152, a48
    v_accvgpr_read_b32 v153, a49
    v_accvgpr_read_b32 v154, a50
    v_accvgpr_read_b32 v155, a51
    v_accvgpr_read_b32 v156, a52
    v_accvgpr_read_b32 v157, a53
    v_accvgpr_read_b32 v158, a54
    v_accvgpr_read_b32 v159, a55
    v_accvgpr_read_b32 v160, a56
    v_accvgpr_read_b32 v161, a57
    v_mfma_f32_32x32x16_bf16 v[88:103], v[172:175], v[232:235], v[88:103]
    buffer_load_dwordx4 v8, s[56:59], s68 offen offset:1024 nt lds
    v_accvgpr_read_b32 v162, a58
    v_accvgpr_read_b32 v163, a59
    v_accvgpr_read_b32 v164, a60
    v_accvgpr_read_b32 v165, a61
    v_accvgpr_read_b32 v166, a62
    v_accvgpr_read_b32 v167, a63
    v_fma_f32 v152, v152, s71, -v250
    v_fma_f32 v153, v153, s71, -v250
    v_fma_f32 v154, v154, s71, -v250
    v_fma_f32 v155, v155, s71, -v250
    v_mfma_f32_32x32x16_bf16 v[104:119], v[176:179], v[232:235], v[104:119]
    buffer_load_dwordx4 v8, s[56:59], s68 offen offset:2048 nt lds
    v_fma_f32 v156, v156, s71, -v250
    v_fma_f32 v157, v157, s71, -v250
    v_fma_f32 v158, v158, s71, -v250
    v_fma_f32 v159, v159, s71, -v250
    v_fma_f32 v160, v160, s71, -v250
    v_fma_f32 v161, v161, s71, -v250
    v_fma_f32 v162, v162, s71, -v250
    v_fma_f32 v163, v163, s71, -v250
    v_fma_f32 v164, v164, s71, -v250
    v_fma_f32 v165, v165, s71, -v250
    v_mfma_f32_32x32x16_bf16 v[120:135], v[180:183], v[232:235], v[120:135]
    buffer_load_dwordx4 v8, s[56:59], s68 offen offset:3072 nt lds
    v_fma_f32 v166, v166, s71, -v250
    v_fma_f32 v167, v167, s71, -v250
    v_exp_f32 v152, v152
    v_exp_f32 v153, v153
    v_exp_f32 v154, v154
    v_exp_f32 v155, v155
    v_exp_f32 v156, v156
    v_exp_f32 v157, v157
    v_exp_f32 v158, v158
    v_exp_f32 v159, v159
    v_mfma_f32_32x32x16_bf16 v[72:87], v[184:187], v[236:239], v[72:87]
    s_add_u32 m0, s88, 36864
    s_add_u32 s68, s69, 4096
    buffer_load_dwordx4 v8, s[56:59], s68 offen offset:0 nt lds
    v_exp_f32 v160, v160
    v_exp_f32 v161, v161
    v_exp_f32 v162, v162
    v_exp_f32 v163, v163
    v_exp_f32 v164, v164
    v_exp_f32 v165, v165
    v_exp_f32 v166, v166
    v_exp_f32 v167, v167
    s_nop 0
    v_cvt_pk_bf16_f32 v240, v152, v153
    v_mfma_f32_32x32x16_bf16 v[88:103], v[188:191], v[236:239], v[88:103]
    buffer_load_dwordx4 v8, s[56:59], s68 offen offset:1024 nt lds
    v_cvt_pk_bf16_f32 v241, v154, v155
    v_cvt_pk_bf16_f32 v242, v156, v157
    v_cvt_pk_bf16_f32 v243, v158, v159
    v_cvt_pk_bf16_f32 v244, v160, v161
    v_cvt_pk_bf16_f32 v245, v162, v163
    v_cvt_pk_bf16_f32 v246, v164, v165
    v_cvt_pk_bf16_f32 v247, v166, v167
    v_add_f32 v152, v152, v153
    v_add_f32 v154, v154, v155
    v_add_f32 v156, v156, v157
    v_mfma_f32_32x32x16_bf16 v[104:119], v[192:195], v[236:239], v[104:119]
    buffer_load_dwordx4 v8, s[56:59], s68 offen offset:2048 nt lds
    v_add_f32 v158, v158, v159
    v_add_f32 v160, v160, v161
    v_add_f32 v162, v162, v163
    v_add_f32 v164, v164, v165
    v_add_f32 v166, v166, v167
    v_add_f32 v152, v152, v154
    v_add_f32 v156, v156, v158
    v_add_f32 v160, v160, v162
    v_add_f32 v164, v164, v166
    v_add_f32 v152, v152, v156
    v_mfma_f32_32x32x16_bf16 v[120:135], v[196:199], v[236:239], v[120:135]
    buffer_load_dwordx4 v8, s[56:59], s68 offen offset:3072 nt lds
    v_add_f32 v160, v160, v164
    v_add_f32 v152, v152, v160
    v_add_f32 v249, v249, v152
    s_waitcnt vmcnt(24)
    ds_read_b64_tr_b16 v[168:169], v25 offset:8192
    ds_read_b64_tr_b16 v[170:171], v25 offset:10240
    ds_read_b64_tr_b16 v[172:173], v26 offset:8192
    ds_read_b64_tr_b16 v[174:175], v26 offset:10240
    ds_read_b64_tr_b16 v[176:177], v27 offset:8192
    ds_read_b64_tr_b16 v[178:179], v27 offset:10240
    ds_read_b64_tr_b16 v[180:181], v28 offset:8192
    ds_read_b64_tr_b16 v[182:183], v28 offset:10240
    ds_read_b64_tr_b16 v[184:185], v25 offset:12288
    ds_read_b64_tr_b16 v[186:187], v25 offset:14336
    ds_read_b64_tr_b16 v[188:189], v26 offset:12288
    ds_read_b64_tr_b16 v[190:191], v26 offset:14336
    ds_read_b64_tr_b16 v[192:193], v27 offset:12288
    ds_read_b64_tr_b16 v[194:195], v27 offset:14336
    ds_read_b64_tr_b16 v[196:197], v28 offset:12288
    ds_read_b64_tr_b16 v[198:199], v28 offset:14336
    s_waitcnt lgkmcnt(15)
    v_mfma_f32_32x32x16_bf16 v[72:87], v[200:203], v[240:243], v[72:87]
    s_add_u32 s69, s9, 14
    s_and_b32 s69, s69, 15
    s_lshl_b32 s69, s69, 13
    s_add_u32 m0, s88, 0
    s_add_u32 s68, s69, 0
    buffer_load_dwordx4 v8, s[56:59], s68 offen offset:0 nt lds
    v_accvgpr_read_b32 v136, a80
    v_accvgpr_read_b32 v137, a81
    v_accvgpr_read_b32 v138, a82
    v_accvgpr_read_b32 v139, a83
    v_accvgpr_read_b32 v140, a84
    v_accvgpr_read_b32 v141, a85
    v_accvgpr_read_b32 v142, a86
    v_accvgpr_read_b32 v143, a87
    v_accvgpr_read_b32 v144, a88
    v_accvgpr_read_b32 v145, a89
    v_mfma_f32_32x32x16_bf16 v[88:103], v[204:207], v[240:243], v[88:103]
    buffer_load_dwordx4 v8, s[56:59], s68 offen offset:1024 nt lds
    v_accvgpr_read_b32 v146, a90
    v_accvgpr_read_b32 v147, a91
    v_accvgpr_read_b32 v148, a92
    v_accvgpr_read_b32 v149, a93
    v_accvgpr_read_b32 v150, a94
    v_accvgpr_read_b32 v151, a95
    v_fma_f32 v136, v136, s71, -v250
    v_fma_f32 v137, v137, s71, -v250
    v_fma_f32 v138, v138, s71, -v250
    v_fma_f32 v139, v139, s71, -v250
    v_mfma_f32_32x32x16_bf16 v[104:119], v[208:211], v[240:243], v[104:119]
    buffer_load_dwordx4 v8, s[56:59], s68 offen offset:2048 nt lds
    v_fma_f32 v140, v140, s71, -v250
    v_fma_f32 v141, v141, s71, -v250
    v_fma_f32 v142, v142, s71, -v250
    v_fma_f32 v143, v143, s71, -v250
    v_fma_f32 v144, v144, s71, -v250
    v_fma_f32 v145, v145, s71, -v250
    v_fma_f32 v146, v146, s71, -v250
    v_fma_f32 v147, v147, s71, -v250
    v_fma_f32 v148, v148, s71, -v250
    v_fma_f32 v149, v149, s71, -v250
    v_mfma_f32_32x32x16_bf16 v[120:135], v[212:215], v[240:243], v[120:135]
    buffer_load_dwordx4 v8, s[56:59], s68 offen offset:3072 nt lds
    v_fma_f32 v150, v150, s71, -v250
    v_fma_f32 v151, v151, s71, -v250
    v_exp_f32 v136, v136
    v_exp_f32 v137, v137
    v_exp_f32 v138, v138
    v_exp_f32 v139, v139
    v_exp_f32 v140, v140
    v_exp_f32 v141, v141
    v_exp_f32 v142, v142
    v_exp_f32 v143, v143
    v_mfma_f32_32x32x16_bf16 v[72:87], v[216:219], v[244:247], v[72:87]
    s_add_u32 m0, s88, 4096
    s_add_u32 s68, s69, 4096
    buffer_load_dwordx4 v8, s[56:59], s68 offen offset:0 nt lds
    v_exp_f32 v144, v144
    v_exp_f32 v145, v145
    v_exp_f32 v146, v146
    v_exp_f32 v147, v147
    v_exp_f32 v148, v148
    v_exp_f32 v149, v149
    v_exp_f32 v150, v150
    v_exp_f32 v151, v151
    s_nop 0
    v_cvt_pk_bf16_f32 v232, v136, v137
    v_mfma_f32_32x32x16_bf16 v[88:103], v[220:223], v[244:247], v[88:103]
    buffer_load_dwordx4 v8, s[56:59], s68 offen offset:1024 nt lds
    v_cvt_pk_bf16_f32 v233, v138, v139
    v_cvt_pk_bf16_f32 v234, v140, v141
    v_cvt_pk_bf16_f32 v235, v142, v143
    v_cvt_pk_bf16_f32 v236, v144, v145
    v_cvt_pk_bf16_f32 v237, v146, v147
    v_cvt_pk_bf16_f32 v238, v148, v149
    v_cvt_pk_bf16_f32 v239, v150, v151
    v_add_f32 v136, v136, v137
    v_add_f32 v138, v138, v139
    v_add_f32 v140, v140, v141
    v_mfma_f32_32x32x16_bf16 v[104:119], v[224:227], v[244:247], v[104:119]
    buffer_load_dwordx4 v8, s[56:59], s68 offen offset:2048 nt lds
    v_add_f32 v142, v142, v143
    v_add_f32 v144, v144, v145
    v_add_f32 v146, v146, v147
    v_add_f32 v148, v148, v149
    v_add_f32 v150, v150, v151
    v_add_f32 v136, v136, v138
    v_add_f32 v140, v140, v142
    v_add_f32 v144, v144, v146
    v_add_f32 v148, v148, v150
    v_add_f32 v136, v136, v140
    v_mfma_f32_32x32x16_bf16 v[120:135], v[228:231], v[244:247], v[120:135]
    buffer_load_dwordx4 v8, s[56:59], s68 offen offset:3072 nt lds
    v_add_f32 v144, v144, v148
    v_add_f32 v136, v136, v144
    v_add_f32 v249, v249, v136
    s_waitcnt vmcnt(24)
    ds_read_b64_tr_b16 v[200:201], v25 offset:16384
    ds_read_b64_tr_b16 v[202:203], v25 offset:18432
    ds_read_b64_tr_b16 v[204:205], v26 offset:16384
    ds_read_b64_tr_b16 v[206:207], v26 offset:18432
    ds_read_b64_tr_b16 v[208:209], v27 offset:16384
    ds_read_b64_tr_b16 v[210:211], v27 offset:18432
    ds_read_b64_tr_b16 v[212:213], v28 offset:16384
    ds_read_b64_tr_b16 v[214:215], v28 offset:18432
    ds_read_b64_tr_b16 v[216:217], v25 offset:20480
    ds_read_b64_tr_b16 v[218:219], v25 offset:22528
    ds_read_b64_tr_b16 v[220:221], v26 offset:20480
    ds_read_b64_tr_b16 v[222:223], v26 offset:22528
    ds_read_b64_tr_b16 v[224:225], v27 offset:20480
    ds_read_b64_tr_b16 v[226:227], v27 offset:22528
    ds_read_b64_tr_b16 v[228:229], v28 offset:20480
    ds_read_b64_tr_b16 v[230:231], v28 offset:22528
    s_waitcnt lgkmcnt(15)
    v_mfma_f32_32x32x16_bf16 v[72:87], v[168:171], v[232:235], v[72:87]
    s_add_u32 s69, s9, 15
    s_and_b32 s69, s69, 15
    s_lshl_b32 s69, s69, 13
    s_add_u32 m0, s88, 8192
    s_add_u32 s68, s69, 0
    buffer_load_dwordx4 v8, s[56:59], s68 offen offset:0 nt lds
    v_accvgpr_read_b32 v152, a112
    v_accvgpr_read_b32 v153, a113
    v_accvgpr_read_b32 v154, a114
    v_accvgpr_read_b32 v155, a115
    v_accvgpr_read_b32 v156, a116
    v_accvgpr_read_b32 v157, a117
    v_accvgpr_read_b32 v158, a118
    v_accvgpr_read_b32 v159, a119
    v_accvgpr_read_b32 v160, a120
    v_accvgpr_read_b32 v161, a121
    v_mfma_f32_32x32x16_bf16 v[88:103], v[172:175], v[232:235], v[88:103]
    buffer_load_dwordx4 v8, s[56:59], s68 offen offset:1024 nt lds
    v_accvgpr_read_b32 v162, a122
    v_accvgpr_read_b32 v163, a123
    v_accvgpr_read_b32 v164, a124
    v_accvgpr_read_b32 v165, a125
    v_accvgpr_read_b32 v166, a126
    v_accvgpr_read_b32 v167, a127
    v_fma_f32 v152, v152, s71, -v250
    v_fma_f32 v153, v153, s71, -v250
    v_fma_f32 v154, v154, s71, -v250
    v_fma_f32 v155, v155, s71, -v250
    v_mfma_f32_32x32x16_bf16 v[104:119], v[176:179], v[232:235], v[104:119]
    buffer_load_dwordx4 v8, s[56:59], s68 offen offset:2048 nt lds
    v_fma_f32 v156, v156, s71, -v250
    v_fma_f32 v157, v157, s71, -v250
    v_fma_f32 v158, v158, s71, -v250
    v_fma_f32 v159, v159, s71, -v250
    v_fma_f32 v160, v160, s71, -v250
    v_fma_f32 v161, v161, s71, -v250
    v_fma_f32 v162, v162, s71, -v250
    v_fma_f32 v163, v163, s71, -v250
    v_fma_f32 v164, v164, s71, -v250
    v_fma_f32 v165, v165, s71, -v250
    v_mfma_f32_32x32x16_bf16 v[120:135], v[180:183], v[232:235], v[120:135]
    buffer_load_dwordx4 v8, s[56:59], s68 offen offset:3072 nt lds
    v_fma_f32 v166, v166, s71, -v250
    v_fma_f32 v167, v167, s71, -v250
    v_exp_f32 v152, v152
    v_exp_f32 v153, v153
    v_exp_f32 v154, v154
    v_exp_f32 v155, v155
    v_exp_f32 v156, v156
    v_exp_f32 v157, v157
    v_exp_f32 v158, v158
    v_exp_f32 v159, v159
    v_mfma_f32_32x32x16_bf16 v[72:87], v[184:187], v[236:239], v[72:87]
    s_add_u32 m0, s88, 12288
    s_add_u32 s68, s69, 4096
    buffer_load_dwordx4 v8, s[56:59], s68 offen offset:0 nt lds
    v_exp_f32 v160, v160
    v_exp_f32 v161, v161
    v_exp_f32 v162, v162
    v_exp_f32 v163, v163
    v_exp_f32 v164, v164
    v_exp_f32 v165, v165
    v_exp_f32 v166, v166
    v_exp_f32 v167, v167
    s_nop 0
    v_cvt_pk_bf16_f32 v240, v152, v153
    v_mfma_f32_32x32x16_bf16 v[88:103], v[188:191], v[236:239], v[88:103]
    buffer_load_dwordx4 v8, s[56:59], s68 offen offset:1024 nt lds
    v_cvt_pk_bf16_f32 v241, v154, v155
    v_cvt_pk_bf16_f32 v242, v156, v157
    v_cvt_pk_bf16_f32 v243, v158, v159
    v_cvt_pk_bf16_f32 v244, v160, v161
    v_cvt_pk_bf16_f32 v245, v162, v163
    v_cvt_pk_bf16_f32 v246, v164, v165
    v_cvt_pk_bf16_f32 v247, v166, v167
    v_add_f32 v152, v152, v153
    v_add_f32 v154, v154, v155
    v_add_f32 v156, v156, v157
    v_mfma_f32_32x32x16_bf16 v[104:119], v[192:195], v[236:239], v[104:119]
    buffer_load_dwordx4 v8, s[56:59], s68 offen offset:2048 nt lds
    v_add_f32 v158, v158, v159
    v_add_f32 v160, v160, v161
    v_add_f32 v162, v162, v163
    v_add_f32 v164, v164, v165
    v_add_f32 v166, v166, v167
    v_add_f32 v152, v152, v154
    v_add_f32 v156, v156, v158
    v_add_f32 v160, v160, v162
    v_add_f32 v164, v164, v166
    v_add_f32 v152, v152, v156
    v_mfma_f32_32x32x16_bf16 v[120:135], v[196:199], v[236:239], v[120:135]
    buffer_load_dwordx4 v8, s[56:59], s68 offen offset:3072 nt lds
    v_add_f32 v160, v160, v164
    v_add_f32 v152, v152, v160
    v_add_f32 v249, v249, v152
    s_waitcnt vmcnt(24)
    ds_read_b64_tr_b16 v[168:169], v25 offset:24576
    ds_read_b64_tr_b16 v[170:171], v25 offset:26624
    ds_read_b64_tr_b16 v[172:173], v26 offset:24576
    ds_read_b64_tr_b16 v[174:175], v26 offset:26624
    ds_read_b64_tr_b16 v[176:177], v27 offset:24576
    ds_read_b64_tr_b16 v[178:179], v27 offset:26624
    ds_read_b64_tr_b16 v[180:181], v28 offset:24576
    ds_read_b64_tr_b16 v[182:183], v28 offset:26624
    ds_read_b64_tr_b16 v[184:185], v25 offset:28672
    ds_read_b64_tr_b16 v[186:187], v25 offset:30720
    ds_read_b64_tr_b16 v[188:189], v26 offset:28672
    ds_read_b64_tr_b16 v[190:191], v26 offset:30720
    ds_read_b64_tr_b16 v[192:193], v27 offset:28672
    ds_read_b64_tr_b16 v[194:195], v27 offset:30720
    ds_read_b64_tr_b16 v[196:197], v28 offset:28672
    ds_read_b64_tr_b16 v[198:199], v28 offset:30720
    s_waitcnt lgkmcnt(15)
    v_mfma_f32_32x32x16_bf16 v[72:87], v[200:203], v[240:243], v[72:87]
    v_accvgpr_read_b32 v136, a144
    v_accvgpr_read_b32 v137, a145
    v_accvgpr_read_b32 v138, a146
    v_accvgpr_read_b32 v139, a147
    v_accvgpr_read_b32 v140, a148
    v_accvgpr_read_b32 v141, a149
    v_accvgpr_read_b32 v142, a150
    v_accvgpr_read_b32 v143, a151
    v_accvgpr_read_b32 v144, a152
    v_accvgpr_read_b32 v145, a153
    v_mfma_f32_32x32x16_bf16 v[88:103], v[204:207], v[240:243], v[88:103]
    v_accvgpr_read_b32 v146, a154
    v_accvgpr_read_b32 v147, a155
    v_accvgpr_read_b32 v148, a156
    v_accvgpr_read_b32 v149, a157
    v_accvgpr_read_b32 v150, a158
    v_accvgpr_read_b32 v151, a159
    v_fma_f32 v136, v136, s71, -v250
    v_fma_f32 v137, v137, s71, -v250
    v_fma_f32 v138, v138, s71, -v250
    v_fma_f32 v139, v139, s71, -v250
    v_mfma_f32_32x32x16_bf16 v[104:119], v[208:211], v[240:243], v[104:119]
    v_fma_f32 v140, v140, s71, -v250
    v_fma_f32 v141, v141, s71, -v250
    v_fma_f32 v142, v142, s71, -v250
    v_fma_f32 v143, v143, s71, -v250
    v_fma_f32 v144, v144, s71, -v250
    v_fma_f32 v145, v145, s71, -v250
    v_fma_f32 v146, v146, s71, -v250
    v_fma_f32 v147, v147, s71, -v250
    v_fma_f32 v148, v148, s71, -v250
    v_fma_f32 v149, v149, s71, -v250
    v_mfma_f32_32x32x16_bf16 v[120:135], v[212:215], v[240:243], v[120:135]
    v_fma_f32 v150, v150, s71, -v250
    v_fma_f32 v151, v151, s71, -v250
    v_exp_f32 v136, v136
    v_exp_f32 v137, v137
    v_exp_f32 v138, v138
    v_exp_f32 v139, v139
    v_exp_f32 v140, v140
    v_exp_f32 v141, v141
    v_exp_f32 v142, v142
    v_exp_f32 v143, v143
    v_mfma_f32_32x32x16_bf16 v[72:87], v[216:219], v[244:247], v[72:87]
    v_exp_f32 v144, v144
    v_exp_f32 v145, v145
    v_exp_f32 v146, v146
    v_exp_f32 v147, v147
    v_exp_f32 v148, v148
    v_exp_f32 v149, v149
    v_exp_f32 v150, v150
    v_exp_f32 v151, v151
    s_nop 0
    v_cvt_pk_bf16_f32 v232, v136, v137
    v_mfma_f32_32x32x16_bf16 v[88:103], v[220:223], v[244:247], v[88:103]
    v_cvt_pk_bf16_f32 v233, v138, v139
    v_cvt_pk_bf16_f32 v234, v140, v141
    v_cvt_pk_bf16_f32 v235, v142, v143
    v_cvt_pk_bf16_f32 v236, v144, v145
    v_cvt_pk_bf16_f32 v237, v146, v147
    v_cvt_pk_bf16_f32 v238, v148, v149
    v_cvt_pk_bf16_f32 v239, v150, v151
    v_add_f32 v136, v136, v137
    v_add_f32 v138, v138, v139
    v_add_f32 v140, v140, v141
    v_mfma_f32_32x32x16_bf16 v[104:119], v[224:227], v[244:247], v[104:119]
    v_add_f32 v142, v142, v143
    v_add_f32 v144, v144, v145
    v_add_f32 v146, v146, v147
    v_add_f32 v148, v148, v149
    v_add_f32 v150, v150, v151
    v_add_f32 v136, v136, v138
    v_add_f32 v140, v140, v142
    v_add_f32 v144, v144, v146
    v_add_f32 v148, v148, v150
    v_add_f32 v136, v136, v140
    v_mfma_f32_32x32x16_bf16 v[120:135], v[228:231], v[244:247], v[120:135]
    v_add_f32 v144, v144, v148
    v_add_f32 v136, v136, v144
    v_add_f32 v249, v249, v136
    s_waitcnt vmcnt(16)
    ds_read_b64_tr_b16 v[200:201], v25 offset:32768
    ds_read_b64_tr_b16 v[202:203], v25 offset:34816
    ds_read_b64_tr_b16 v[204:205], v26 offset:32768
    ds_read_b64_tr_b16 v[206:207], v26 offset:34816
    ds_read_b64_tr_b16 v[208:209], v27 offset:32768
    ds_read_b64_tr_b16 v[210:211], v27 offset:34816
    ds_read_b64_tr_b16 v[212:213], v28 offset:32768
    ds_read_b64_tr_b16 v[214:215], v28 offset:34816
    ds_read_b64_tr_b16 v[216:217], v25 offset:36864
    ds_read_b64_tr_b16 v[218:219], v25 offset:38912
    ds_read_b64_tr_b16 v[220:221], v26 offset:36864
    ds_read_b64_tr_b16 v[222:223], v26 offset:38912
    ds_read_b64_tr_b16 v[224:225], v27 offset:36864
    ds_read_b64_tr_b16 v[226:227], v27 offset:38912
    ds_read_b64_tr_b16 v[228:229], v28 offset:36864
    ds_read_b64_tr_b16 v[230:231], v28 offset:38912
    s_waitcnt lgkmcnt(15)
    v_mfma_f32_32x32x16_bf16 v[72:87], v[168:171], v[232:235], v[72:87]
    v_accvgpr_read_b32 v152, a176
    v_accvgpr_read_b32 v153, a177
    v_accvgpr_read_b32 v154, a178
    v_accvgpr_read_b32 v155, a179
    v_accvgpr_read_b32 v156, a180
    v_accvgpr_read_b32 v157, a181
    v_accvgpr_read_b32 v158, a182
    v_accvgpr_read_b32 v159, a183
    v_accvgpr_read_b32 v160, a184
    v_accvgpr_read_b32 v161, a185
    v_mfma_f32_32x32x16_bf16 v[88:103], v[172:175], v[232:235], v[88:103]
    v_accvgpr_read_b32 v162, a186
    v_accvgpr_read_b32 v163, a187
    v_accvgpr_read_b32 v164, a188
    v_accvgpr_read_b32 v165, a189
    v_accvgpr_read_b32 v166, a190
    v_accvgpr_read_b32 v167, a191
    v_fma_f32 v152, v152, s71, -v250
    v_fma_f32 v153, v153, s71, -v250
    v_fma_f32 v154, v154, s71, -v250
    v_fma_f32 v155, v155, s71, -v250
    v_mfma_f32_32x32x16_bf16 v[104:119], v[176:179], v[232:235], v[104:119]
    v_fma_f32 v156, v156, s71, -v250
    v_fma_f32 v157, v157, s71, -v250
    v_fma_f32 v158, v158, s71, -v250
    v_fma_f32 v159, v159, s71, -v250
    v_fma_f32 v160, v160, s71, -v250
    v_fma_f32 v161, v161, s71, -v250
    v_fma_f32 v162, v162, s71, -v250
    v_fma_f32 v163, v163, s71, -v250
    v_fma_f32 v164, v164, s71, -v250
    v_fma_f32 v165, v165, s71, -v250
    v_mfma_f32_32x32x16_bf16 v[120:135], v[180:183], v[232:235], v[120:135]
    v_fma_f32 v166, v166, s71, -v250
    v_fma_f32 v167, v167, s71, -v250
    v_exp_f32 v152, v152
    v_exp_f32 v153, v153
    v_exp_f32 v154, v154
    v_exp_f32 v155, v155
    v_exp_f32 v156, v156
    v_exp_f32 v157, v157
    v_exp_f32 v158, v158
    v_exp_f32 v159, v159
    v_mfma_f32_32x32x16_bf16 v[72:87], v[184:187], v[236:239], v[72:87]
    v_exp_f32 v160, v160
    v_exp_f32 v161, v161
    v_exp_f32 v162, v162
    v_exp_f32 v163, v163
    v_exp_f32 v164, v164
    v_exp_f32 v165, v165
    v_exp_f32 v166, v166
    v_exp_f32 v167, v167
    s_nop 0
    v_cvt_pk_bf16_f32 v240, v152, v153
    v_mfma_f32_32x32x16_bf16 v[88:103], v[188:191], v[236:239], v[88:103]
    v_cvt_pk_bf16_f32 v241, v154, v155
    v_cvt_pk_bf16_f32 v242, v156, v157
    v_cvt_pk_bf16_f32 v243, v158, v159
    v_cvt_pk_bf16_f32 v244, v160, v161
    v_cvt_pk_bf16_f32 v245, v162, v163
    v_cvt_pk_bf16_f32 v246, v164, v165
    v_cvt_pk_bf16_f32 v247, v166, v167
    v_add_f32 v152, v152, v153
    v_add_f32 v154, v154, v155
    v_add_f32 v156, v156, v157
    v_mfma_f32_32x32x16_bf16 v[104:119], v[192:195], v[236:239], v[104:119]
    v_add_f32 v158, v158, v159
    v_add_f32 v160, v160, v161
    v_add_f32 v162, v162, v163
    v_add_f32 v164, v164, v165
    v_add_f32 v166, v166, v167
    v_add_f32 v152, v152, v154
    v_add_f32 v156, v156, v158
    v_add_f32 v160, v160, v162
    v_add_f32 v164, v164, v166
    v_add_f32 v152, v152, v156
    v_mfma_f32_32x32x16_bf16 v[120:135], v[196:199], v[236:239], v[120:135]
    v_add_f32 v160, v160, v164
    v_add_f32 v152, v152, v160
    v_add_f32 v249, v249, v152
    s_waitcnt vmcnt(8)
    ds_read_b64_tr_b16 v[168:169], v25 offset:0
    ds_read_b64_tr_b16 v[170:171], v25 offset:2048
    ds_read_b64_tr_b16 v[172:173], v26 offset:0
    ds_read_b64_tr_b16 v[174:175], v26 offset:2048
    ds_read_b64_tr_b16 v[176:177], v27 offset:0
    ds_read_b64_tr_b16 v[178:179], v27 offset:2048
    ds_read_b64_tr_b16 v[180:181], v28 offset:0
    ds_read_b64_tr_b16 v[182:183], v28 offset:2048
    ds_read_b64_tr_b16 v[184:185], v25 offset:4096
    ds_read_b64_tr_b16 v[186:187], v25 offset:6144
    ds_read_b64_tr_b16 v[188:189], v26 offset:4096
    ds_read_b64_tr_b16 v[190:191], v26 offset:6144
    ds_read_b64_tr_b16 v[192:193], v27 offset:4096
    ds_read_b64_tr_b16 v[194:195], v27 offset:6144
    ds_read_b64_tr_b16 v[196:197], v28 offset:4096
    ds_read_b64_tr_b16 v[198:199], v28 offset:6144
    s_waitcnt lgkmcnt(15)
    v_mfma_f32_32x32x16_bf16 v[72:87], v[200:203], v[240:243], v[72:87]
    v_accvgpr_read_b32 v136, a208
    v_accvgpr_read_b32 v137, a209
    v_accvgpr_read_b32 v138, a210
    v_accvgpr_read_b32 v139, a211
    v_accvgpr_read_b32 v140, a212
    v_accvgpr_read_b32 v141, a213
    v_accvgpr_read_b32 v142, a214
    v_accvgpr_read_b32 v143, a215
    v_accvgpr_read_b32 v144, a216
    v_accvgpr_read_b32 v145, a217
    v_mfma_f32_32x32x16_bf16 v[88:103], v[204:207], v[240:243], v[88:103]
    v_accvgpr_read_b32 v146, a218
    v_accvgpr_read_b32 v147, a219
    v_accvgpr_read_b32 v148, a220
    v_accvgpr_read_b32 v149, a221
    v_accvgpr_read_b32 v150, a222
    v_accvgpr_read_b32 v151, a223
    v_fma_f32 v136, v136, s71, -v250
    v_fma_f32 v137, v137, s71, -v250
    v_fma_f32 v138, v138, s71, -v250
    v_fma_f32 v139, v139, s71, -v250
    v_mfma_f32_32x32x16_bf16 v[104:119], v[208:211], v[240:243], v[104:119]
    v_fma_f32 v140, v140, s71, -v250
    v_fma_f32 v141, v141, s71, -v250
    v_fma_f32 v142, v142, s71, -v250
    v_fma_f32 v143, v143, s71, -v250
    v_fma_f32 v144, v144, s71, -v250
    v_fma_f32 v145, v145, s71, -v250
    v_fma_f32 v146, v146, s71, -v250
    v_fma_f32 v147, v147, s71, -v250
    v_fma_f32 v148, v148, s71, -v250
    v_fma_f32 v149, v149, s71, -v250
    v_mfma_f32_32x32x16_bf16 v[120:135], v[212:215], v[240:243], v[120:135]
    v_fma_f32 v150, v150, s71, -v250
    v_fma_f32 v151, v151, s71, -v250
    v_exp_f32 v136, v136
    v_exp_f32 v137, v137
    v_exp_f32 v138, v138
    v_exp_f32 v139, v139
    v_exp_f32 v140, v140
    v_exp_f32 v141, v141
    v_exp_f32 v142, v142
    v_exp_f32 v143, v143
    v_mfma_f32_32x32x16_bf16 v[72:87], v[216:219], v[244:247], v[72:87]
    v_exp_f32 v144, v144
    v_exp_f32 v145, v145
    v_exp_f32 v146, v146
    v_exp_f32 v147, v147
    v_exp_f32 v148, v148
    v_exp_f32 v149, v149
    v_exp_f32 v150, v150
    v_exp_f32 v151, v151
    s_nop 0
    v_cvt_pk_bf16_f32 v232, v136, v137
    v_mfma_f32_32x32x16_bf16 v[88:103], v[220:223], v[244:247], v[88:103]
    v_cvt_pk_bf16_f32 v233, v138, v139
    v_cvt_pk_bf16_f32 v234, v140, v141
    v_cvt_pk_bf16_f32 v235, v142, v143
    v_cvt_pk_bf16_f32 v236, v144, v145
    v_cvt_pk_bf16_f32 v237, v146, v147
    v_cvt_pk_bf16_f32 v238, v148, v149
    v_cvt_pk_bf16_f32 v239, v150, v151
    v_add_f32 v136, v136, v137
    v_add_f32 v138, v138, v139
    v_add_f32 v140, v140, v141
    v_mfma_f32_32x32x16_bf16 v[104:119], v[224:227], v[244:247], v[104:119]
    v_add_f32 v142, v142, v143
    v_add_f32 v144, v144, v145
    v_add_f32 v146, v146, v147
    v_add_f32 v148, v148, v149
    v_add_f32 v150, v150, v151
    v_add_f32 v136, v136, v138
    v_add_f32 v140, v140, v142
    v_add_f32 v144, v144, v146
    v_add_f32 v148, v148, v150
    v_add_f32 v136, v136, v140
    v_mfma_f32_32x32x16_bf16 v[120:135], v[228:231], v[244:247], v[120:135]
    v_add_f32 v144, v144, v148
    v_add_f32 v136, v136, v144
    v_add_f32 v249, v249, v136
    s_waitcnt vmcnt(0)
    ds_read_b64_tr_b16 v[200:201], v25 offset:8192
    ds_read_b64_tr_b16 v[202:203], v25 offset:10240
    ds_read_b64_tr_b16 v[204:205], v26 offset:8192
    ds_read_b64_tr_b16 v[206:207], v26 offset:10240
    ds_read_b64_tr_b16 v[208:209], v27 offset:8192
    ds_read_b64_tr_b16 v[210:211], v27 offset:10240
    ds_read_b64_tr_b16 v[212:213], v28 offset:8192
    ds_read_b64_tr_b16 v[214:215], v28 offset:10240
    ds_read_b64_tr_b16 v[216:217], v25 offset:12288
    ds_read_b64_tr_b16 v[218:219], v25 offset:14336
    ds_read_b64_tr_b16 v[220:221], v26 offset:12288
    ds_read_b64_tr_b16 v[222:223], v26 offset:14336
    ds_read_b64_tr_b16 v[224:225], v27 offset:12288
    ds_read_b64_tr_b16 v[226:227], v27 offset:14336
    ds_read_b64_tr_b16 v[228:229], v28 offset:12288
    ds_read_b64_tr_b16 v[230:231], v28 offset:14336
    s_waitcnt lgkmcnt(15)
    v_mfma_f32_32x32x16_bf16 v[72:87], v[168:171], v[232:235], v[72:87]
    v_accvgpr_read_b32 v152, a240
    v_accvgpr_read_b32 v153, a241
    v_accvgpr_read_b32 v154, a242
    v_accvgpr_read_b32 v155, a243
    v_accvgpr_read_b32 v156, a244
    v_accvgpr_read_b32 v157, a245
    v_accvgpr_read_b32 v158, a246
    v_accvgpr_read_b32 v159, a247
    v_accvgpr_read_b32 v160, a248
    v_accvgpr_read_b32 v161, a249
    v_mfma_f32_32x32x16_bf16 v[88:103], v[172:175], v[232:235], v[88:103]
    v_accvgpr_read_b32 v162, a250
    v_accvgpr_read_b32 v163, a251
    v_accvgpr_read_b32 v164, a252
    v_accvgpr_read_b32 v165, a253
    v_accvgpr_read_b32 v166, a254
    v_accvgpr_read_b32 v167, a255
    v_fma_f32 v152, v152, s71, -v250
    v_fma_f32 v153, v153, s71, -v250
    v_fma_f32 v154, v154, s71, -v250
    v_fma_f32 v155, v155, s71, -v250
    v_mfma_f32_32x32x16_bf16 v[104:119], v[176:179], v[232:235], v[104:119]
    v_fma_f32 v156, v156, s71, -v250
    v_fma_f32 v157, v157, s71, -v250
    v_fma_f32 v158, v158, s71, -v250
    v_fma_f32 v159, v159, s71, -v250
    v_fma_f32 v160, v160, s71, -v250
    v_fma_f32 v161, v161, s71, -v250
    v_fma_f32 v162, v162, s71, -v250
    v_fma_f32 v163, v163, s71, -v250
    v_fma_f32 v164, v164, s71, -v250
    v_fma_f32 v165, v165, s71, -v250
    v_mfma_f32_32x32x16_bf16 v[120:135], v[180:183], v[232:235], v[120:135]
    v_fma_f32 v166, v166, s71, -v250
    v_fma_f32 v167, v167, s71, -v250
    v_exp_f32 v152, v152
    v_exp_f32 v153, v153
    v_exp_f32 v154, v154
    v_exp_f32 v155, v155
    v_exp_f32 v156, v156
    v_exp_f32 v157, v157
    v_exp_f32 v158, v158
    v_exp_f32 v159, v159
    v_mfma_f32_32x32x16_bf16 v[72:87], v[184:187], v[236:239], v[72:87]
    v_exp_f32 v160, v160
    v_exp_f32 v161, v161
    v_exp_f32 v162, v162
    v_exp_f32 v163, v163
    v_exp_f32 v164, v164
    v_exp_f32 v165, v165
    v_exp_f32 v166, v166
    v_exp_f32 v167, v167
    s_nop 0
    v_cvt_pk_bf16_f32 v240, v152, v153
    v_mfma_f32_32x32x16_bf16 v[88:103], v[188:191], v[236:239], v[88:103]
    v_cvt_pk_bf16_f32 v241, v154, v155
    v_cvt_pk_bf16_f32 v242, v156, v157
    v_cvt_pk_bf16_f32 v243, v158, v159
    v_cvt_pk_bf16_f32 v244, v160, v161
    v_cvt_pk_bf16_f32 v245, v162, v163
    v_cvt_pk_bf16_f32 v246, v164, v165
    v_cvt_pk_bf16_f32 v247, v166, v167
    v_add_f32 v152, v152, v153
    v_add_f32 v154, v154, v155
    v_add_f32 v156, v156, v157
    v_mfma_f32_32x32x16_bf16 v[104:119], v[192:195], v[236:239], v[104:119]
    v_add_f32 v158, v158, v159
    v_add_f32 v160, v160, v161
    v_add_f32 v162, v162, v163
    v_add_f32 v164, v164, v165
    v_add_f32 v166, v166, v167
    v_add_f32 v152, v152, v154
    v_add_f32 v156, v156, v158
    v_add_f32 v160, v160, v162
    v_add_f32 v164, v164, v166
    v_add_f32 v152, v152, v156
    v_mfma_f32_32x32x16_bf16 v[120:135], v[196:199], v[236:239], v[120:135]
    v_add_f32 v160, v160, v164
    v_add_f32 v152, v152, v160
    v_add_f32 v249, v249, v152
    s_waitcnt lgkmcnt(0)
    v_mfma_f32_32x32x16_bf16 v[72:87], v[200:203], v[240:243], v[72:87]
    v_mfma_f32_32x32x16_bf16 v[88:103], v[204:207], v[240:243], v[88:103]
    v_mfma_f32_32x32x16_bf16 v[104:119], v[208:211], v[240:243], v[104:119]
    v_mfma_f32_32x32x16_bf16 v[120:135], v[212:215], v[240:243], v[120:135]
    v_mfma_f32_32x32x16_bf16 v[72:87], v[216:219], v[244:247], v[72:87]
    v_mfma_f32_32x32x16_bf16 v[88:103], v[220:223], v[244:247], v[88:103]
    v_mfma_f32_32x32x16_bf16 v[104:119], v[224:227], v[244:247], v[104:119]
    v_mfma_f32_32x32x16_bf16 v[120:135], v[228:231], v[244:247], v[120:135]
    v_mov_b32 v32, v249
    v_mov_b32 v33, v249
    s_nop 1
    v_permlane32_swap_b32 v32, v33
    s_nop 1
    v_add_f32 v249, v32, v33
    v_rcp_f32 v249, v249
    s_nop 15

    v_and_b32 v32, 31, v0
    v_lshrrev_b32 v33, 5, v0
    v_lshlrev_b32 v33, 1, v33
    v_and_b32 v34, 15, v0
    v_xor_b32 v33, v33, v34
    v_lshlrev_b32 v33, 4, v33
    v_lshl_add_u32 v32, v32, 8, v33
    v_add_u32 v32, s45, v32

    v_mul_f32 v72, v72, v249
    v_mul_f32 v73, v73, v249
    v_mul_f32 v74, v74, v249
    v_mul_f32 v75, v75, v249
    v_mul_f32 v76, v76, v249
    v_mul_f32 v77, v77, v249
    v_mul_f32 v78, v78, v249
    v_mul_f32 v79, v79, v249
    v_mul_f32 v80, v80, v249
    v_mul_f32 v81, v81, v249
    v_mul_f32 v82, v82, v249
    v_mul_f32 v83, v83, v249
    v_mul_f32 v84, v84, v249
    v_mul_f32 v85, v85, v249
    v_mul_f32 v86, v86, v249
    v_mul_f32 v87, v87, v249
    v_cvt_pk_bf16_f32 v168, v72, v73
    v_cvt_pk_bf16_f32 v169, v74, v75
    v_cvt_pk_bf16_f32 v170, v76, v77
    v_cvt_pk_bf16_f32 v171, v78, v79
    v_cvt_pk_bf16_f32 v172, v80, v81
    v_cvt_pk_bf16_f32 v173, v82, v83
    v_cvt_pk_bf16_f32 v174, v84, v85
    v_cvt_pk_bf16_f32 v175, v86, v87
    v_xor_b32 v33, 0, v32
    ds_write_b128 v33, v[168:171]
    v_xor_b32 v33, 16, v32
    ds_write_b128 v33, v[172:175]
    v_mul_f32 v88, v88, v249
    v_mul_f32 v89, v89, v249
    v_mul_f32 v90, v90, v249
    v_mul_f32 v91, v91, v249
    v_mul_f32 v92, v92, v249
    v_mul_f32 v93, v93, v249
    v_mul_f32 v94, v94, v249
    v_mul_f32 v95, v95, v249
    v_mul_f32 v96, v96, v249
    v_mul_f32 v97, v97, v249
    v_mul_f32 v98, v98, v249
    v_mul_f32 v99, v99, v249
    v_mul_f32 v100, v100, v249
    v_mul_f32 v101, v101, v249
    v_mul_f32 v102, v102, v249
    v_mul_f32 v103, v103, v249
    v_cvt_pk_bf16_f32 v176, v88, v89
    v_cvt_pk_bf16_f32 v177, v90, v91
    v_cvt_pk_bf16_f32 v178, v92, v93
    v_cvt_pk_bf16_f32 v179, v94, v95
    v_cvt_pk_bf16_f32 v180, v96, v97
    v_cvt_pk_bf16_f32 v181, v98, v99
    v_cvt_pk_bf16_f32 v182, v100, v101
    v_cvt_pk_bf16_f32 v183, v102, v103
    v_xor_b32 v33, 64, v32
    ds_write_b128 v33, v[176:179]
    v_xor_b32 v33, 80, v32
    ds_write_b128 v33, v[180:183]
    v_mul_f32 v104, v104, v249
    v_mul_f32 v105, v105, v249
    v_mul_f32 v106, v106, v249
    v_mul_f32 v107, v107, v249
    v_mul_f32 v108, v108, v249
    v_mul_f32 v109, v109, v249
    v_mul_f32 v110, v110, v249
    v_mul_f32 v111, v111, v249
    v_mul_f32 v112, v112, v249
    v_mul_f32 v113, v113, v249
    v_mul_f32 v114, v114, v249
    v_mul_f32 v115, v115, v249
    v_mul_f32 v116, v116, v249
    v_mul_f32 v117, v117, v249
    v_mul_f32 v118, v118, v249
    v_mul_f32 v119, v119, v249
    v_cvt_pk_bf16_f32 v184, v104, v105
    v_cvt_pk_bf16_f32 v185, v106, v107
    v_cvt_pk_bf16_f32 v186, v108, v109
    v_cvt_pk_bf16_f32 v187, v110, v111
    v_cvt_pk_bf16_f32 v188, v112, v113
    v_cvt_pk_bf16_f32 v189, v114, v115
    v_cvt_pk_bf16_f32 v190, v116, v117
    v_cvt_pk_bf16_f32 v191, v118, v119
    v_xor_b32 v33, 128, v32
    ds_write_b128 v33, v[184:187]
    v_xor_b32 v33, 144, v32
    ds_write_b128 v33, v[188:191]
    v_mul_f32 v120, v120, v249
    v_mul_f32 v121, v121, v249
    v_mul_f32 v122, v122, v249
    v_mul_f32 v123, v123, v249
    v_mul_f32 v124, v124, v249
    v_mul_f32 v125, v125, v249
    v_mul_f32 v126, v126, v249
    v_mul_f32 v127, v127, v249
    v_mul_f32 v128, v128, v249
    v_mul_f32 v129, v129, v249
    v_mul_f32 v130, v130, v249
    v_mul_f32 v131, v131, v249
    v_mul_f32 v132, v132, v249
    v_mul_f32 v133, v133, v249
    v_mul_f32 v134, v134, v249
    v_mul_f32 v135, v135, v249
    v_cvt_pk_bf16_f32 v192, v120, v121
    v_cvt_pk_bf16_f32 v193, v122, v123
    v_cvt_pk_bf16_f32 v194, v124, v125
    v_cvt_pk_bf16_f32 v195, v126, v127
    v_cvt_pk_bf16_f32 v196, v128, v129
    v_cvt_pk_bf16_f32 v197, v130, v131
    v_cvt_pk_bf16_f32 v198, v132, v133
    v_cvt_pk_bf16_f32 v199, v134, v135
    v_xor_b32 v33, 192, v32
    ds_write_b128 v33, v[192:195]
    v_xor_b32 v33, 208, v32
    ds_write_b128 v33, v[196:199]
    v_lshrrev_b32 v33, 4, v0
    v_xor_b32 v35, v34, v33
    v_lshlrev_b32 v35, 4, v35
    v_lshl_add_u32 v35, v33, 8, v35
    v_add_u32 v35, s45, v35
    v_lshlrev_b32 v34, 4, v34
    v_lshl_add_u32 v34, v33, 13, v34
    s_lshl_b32 s68, s6, 18
    s_lshl_b32 s69, s5, 8
    s_add_u32 s69, s68, s69
    s_waitcnt lgkmcnt(0)

    v_xor_b32 v33, 0, v35
    ds_read_b128 v[72:75], v33 offset:0
    v_xor_b32 v33, 64, v35
    ds_read_b128 v[76:79], v33 offset:1024
    v_xor_b32 v33, 128, v35
    ds_read_b128 v[80:83], v33 offset:2048
    v_xor_b32 v33, 192, v35
    ds_read_b128 v[84:87], v33 offset:3072
    v_xor_b32 v33, 0, v35
    ds_read_b128 v[88:91], v33 offset:4096
    v_xor_b32 v33, 64, v35
    ds_read_b128 v[92:95], v33 offset:5120
    v_xor_b32 v33, 128, v35
    ds_read_b128 v[96:99], v33 offset:6144
    v_xor_b32 v33, 192, v35
    ds_read_b128 v[100:103], v33 offset:7168
    s_waitcnt lgkmcnt(7)
    s_add_u32 s68, s69, 0
    buffer_store_dwordx4 v[72:75], v34, s[64:67], s68 offen sc1
    s_waitcnt lgkmcnt(6)
    s_add_u32 s68, s69, 32768
    buffer_store_dwordx4 v[76:79], v34, s[64:67], s68 offen sc1
    s_waitcnt lgkmcnt(5)
    s_add_u32 s68, s69, 65536
    buffer_store_dwordx4 v[80:83], v34, s[64:67], s68 offen sc1
    s_waitcnt lgkmcnt(4)
    s_add_u32 s68, s69, 98304
    buffer_store_dwordx4 v[84:87], v34, s[64:67], s68 offen sc1
    s_waitcnt lgkmcnt(3)
    s_add_u32 s68, s69, 131072
    buffer_store_dwordx4 v[88:91], v34, s[64:67], s68 offen sc1
    s_waitcnt lgkmcnt(2)
    s_add_u32 s68, s69, 163840
    buffer_store_dwordx4 v[92:95], v34, s[64:67], s68 offen sc1
    s_waitcnt lgkmcnt(1)
    s_add_u32 s68, s69, 196608
    buffer_store_dwordx4 v[96:99], v34, s[64:67], s68 offen sc1
    s_waitcnt lgkmcnt(0)
    s_add_u32 s68, s69, 229376
    buffer_store_dwordx4 v[100:103], v34, s[64:67], s68 offen sc1
    s_lshr_b32 s75, s42, 2
    s_lshr_b32 s77, s2, 3
    s_cmp_eq_u32 s75, 0
    s_cselect_b32 s56, s24, s34
    s_cselect_b32 s57, s25, s35
    s_cselect_b32 s68, 0x0, 0x400000
    s_cselect_b32 s76, 0xffff, -1
    s_mov_b32 s58, 0x800000
    s_mov_b32 s59, 0x00020000

    s_add_u32 s52, s40, s68
    s_addc_u32 s53, s41, 0
    s_mov_b32 s54, 0x400000
    s_mov_b32 s55, 0x00020000
    s_mov_b32 s60, s36
    s_mov_b32 s61, s37
    s_mov_b32 s62, 0x200000
    s_mov_b32 s63, 0x00020000
    s_and_b32 s11, s42, 1
    s_lshl_b32 s11, s11, 2
    s_and_b32 s68, s77, 3
    s_add_u32 s11, s11, s68
    s_bfe_u32 s12, s42, 0x10001
    s_lshl_b32 s12, s12, 3
    s_lshr_b32 s68, s77, 2
    s_add_u32 s12, s12, s68

    s_lshl_b32 s68, s11, 19
    s_lshl_b32 s69, s3, 11
    s_add_u32 s72, s68, s69
    s_lshl_b32 s68, s3, 21
    s_lshl_b32 s69, s12, 7
    s_add_u32 s73, s68, s69
    s_and_b32 s68, s77, 3
    s_lshl_b32 s68, s68, 1
    s_lshr_b32 s69, s77, 2
    s_add_u32 s68, s68, s69
    s_and_b32 s74, s68, 7

    v_lshrrev_b32 v12, 4, v0
    v_lshrrev_b32 v14, 3, v0
    v_and_b32 v15, 7, v0
    v_xor_b32 v16, v15, v12
    v_lshlrev_b32 v16, 4, v16
    v_lshl_add_u32 v1, v14, 13, v16
    v_xor_b32 v2, 64, v1
    v_and_b32 v16, 1, v12
    v_lshlrev_b32 v16, 2, v16
    v_xor_b32 v16, v16, v15
    v_lshlrev_b32 v16, 4, v16
    v_lshl_add_u32 v3, v14, 11, v16

    s_add_u32 s69, s74, 0
    s_and_b32 s69, s69, 7
    s_add_u32 s69, s69, 0
    s_lshl_b32 s69, s69, 17
    s_add_u32 s69, s69, s73
    s_add_u32 m0, s45, 0
    s_add_u32 s68, s69, 0
    buffer_load_dwordx4 v3, s[56:59], s68 offen lds
    s_add_u32 m0, s45, 1024
    s_add_u32 s68, s69, 16384
    buffer_load_dwordx4 v3, s[56:59], s68 offen lds
    s_add_u32 m0, s45, 2048
    s_add_u32 s68, s69, 32768
    buffer_load_dwordx4 v3, s[56:59], s68 offen lds
    s_add_u32 m0, s45, 3072
    s_add_u32 s68, s69, 49152
    buffer_load_dwordx4 v3, s[56:59], s68 offen lds
    s_add_u32 m0, s45, 4096
    s_add_u32 s68, s69, 65536
    buffer_load_dwordx4 v3, s[56:59], s68 offen lds
    s_add_u32 m0, s45, 5120
    s_add_u32 s68, s69, 81920
    buffer_load_dwordx4 v3, s[56:59], s68 offen lds
    s_add_u32 m0, s45, 6144
    s_add_u32 s68, s69, 98304
    buffer_load_dwordx4 v3, s[56:59], s68 offen lds
    s_add_u32 m0, s45, 7168
    s_add_u32 s68, s69, 114688
    buffer_load_dwordx4 v3, s[56:59], s68 offen lds
    s_add_u32 s69, s74, 1
    s_and_b32 s69, s69, 7
    s_add_u32 s69, s69, 0
    s_lshl_b32 s69, s69, 17
    s_add_u32 s69, s69, s73
    s_add_u32 m0, s45, 8192
    s_add_u32 s68, s69, 0
    buffer_load_dwordx4 v3, s[56:59], s68 offen lds
    s_add_u32 m0, s45, 9216
    s_add_u32 s68, s69, 16384
    buffer_load_dwordx4 v3, s[56:59], s68 offen lds
    s_add_u32 m0, s45, 10240
    s_add_u32 s68, s69, 32768
    buffer_load_dwordx4 v3, s[56:59], s68 offen lds
    s_add_u32 m0, s45, 11264
    s_add_u32 s68, s69, 49152
    buffer_load_dwordx4 v3, s[56:59], s68 offen lds
    s_add_u32 m0, s45, 12288
    s_add_u32 s68, s69, 65536
    buffer_load_dwordx4 v3, s[56:59], s68 offen lds
    s_add_u32 m0, s45, 13312
    s_add_u32 s68, s69, 81920
    buffer_load_dwordx4 v3, s[56:59], s68 offen lds
    s_add_u32 m0, s45, 14336
    s_add_u32 s68, s69, 98304
    buffer_load_dwordx4 v3, s[56:59], s68 offen lds
    s_add_u32 m0, s45, 15360
    s_add_u32 s68, s69, 114688
    buffer_load_dwordx4 v3, s[56:59], s68 offen lds
    s_waitcnt vmcnt(16)
    s_barrier
    s_cmp_lg_u32 s3, 0
    s_cbranch_scc1 L_pub_8
    s_cmp_eq_u32 s46, 1
    s_cbranch_scc1 L_gated_10
    v_mov_b32 v13, 0

L_gate_9:
    buffer_load_dword v12, v13, s[48:51], 0 offen sc1
    s_waitcnt vmcnt(0)
    v_readfirstlane_b32 s68, v12
    s_cmp_ge_u32 s68, 256
    s_cbranch_scc1 L_gated_10
    s_sleep 32
    s_branch L_gate_9

L_gated_10:
    s_mov_b32 s46, 1
    v_bfe_u32 v14, v0, 4, 1
    s_lshl_b32 s68, s4, 1
    v_add_u32 v14, s68, v14
    v_lshrrev_b32 v12, 2, v14
    v_bfe_u32 v15, v0, 3, 1
    v_lshl_add_u32 v12, v15, 1, v12
    v_and_b32 v14, 3, v14
    v_and_b32 v15, 7, v0
    v_lshl_add_u32 v14, v15, 2, v14
    v_lshl_add_u32 v12, v14, 3, v12
    v_add_u32 v12, 4, v12

    v_lshlrev_b32 v12, 8, v12
    s_lshl_b32 s68, s5, 2
    s_add_u32 s68, s68, 128
    v_add_u32 v12, s68, v12

    v_mov_b32 v13, 1
    s_mov_b32 exec_lo, 0xffffffff
    s_mov_b32 exec_hi, 0
    buffer_store_dword v13, v12, s[96:99], 0 offen sc1
    s_mov_b64 exec, -1

L_pub_8:
    s_branch L_oproj
L_worker:
    s_mov_b32 s52, s26
    s_mov_b32 s53, s27
    s_mov_b32 s54, 0x100000
    s_mov_b32 s55, 0x00020000
    s_mov_b32 s56, s32
    s_mov_b32 s57, s33
    s_mov_b32 s58, 0x800000
    s_mov_b32 s59, 0x00020000
    s_mov_b32 s60, s16
    s_mov_b32 s61, s17
    s_mov_b32 s62, 0x100000
    s_mov_b32 s63, 0x00020000
    s_mov_b32 s64, s22
    s_mov_b32 s65, s23
    s_mov_b32 s66, 0x800000
    s_mov_b32 s67, 0x00020000
    s_lshl_b32 s68, s4, 2
    s_add_u32 s68, s68, s3
    s_lshl_b32 s72, s68, 16
    s_lshl_b32 s68, s3, 16
    s_lshl_b32 s69, s5, 8
    s_add_u32 s73, s68, s69
    s_add_u32 s74, s4, s5
    s_and_b32 s74, s74, 3
    s_lshl_b32 s74, s74, 2
    s_lshl_b32 s75, s3, 14
    s_add_u32 s75, s75, 65536
    s_lshl_b32 s76, s3, 11

    v_lshrrev_b32 v16, 4, v0
    v_and_b32 v17, 15, v0
    v_lshrrev_b32 v18, 3, v0
    v_and_b32 v19, 7, v0
    v_xor_b32 v20, v19, v16
    v_lshlrev_b32 v20, 4, v20
    v_lshl_add_u32 v1, v18, 11, v20
    v_xor_b32 v2, 64, v1
    v_lshlrev_b32 v20, 2, v16
    v_xor_b32 v20, v20, v17
    v_lshlrev_b32 v20, 4, v20
    v_lshl_add_u32 v3, v16, 13, v20

    s_add_u32 s69, s74, 0
    s_and_b32 s69, s69, 15
    s_lshl_b32 s69, s69, 19
    s_add_u32 s69, s69, s73
    s_add_u32 m0, s76, 0
    s_add_u32 s68, s69, 0
    buffer_load_dwordx4 v3, s[56:59], s68 offen lds
    s_add_u32 m0, s76, 1024
    s_add_u32 s68, s69, 32768
    buffer_load_dwordx4 v3, s[56:59], s68 offen lds
    s_add_u32 s69, s74, 0
    s_and_b32 s69, s69, 15
    s_lshl_b32 s69, s69, 19
    s_add_u32 s69, s69, s73
    s_add_u32 m0, s76, 8192
    s_add_u32 s68, s69, 262144
    buffer_load_dwordx4 v3, s[56:59], s68 offen lds
    s_add_u32 m0, s76, 9216
    s_add_u32 s68, s69, 294912
    buffer_load_dwordx4 v3, s[56:59], s68 offen lds
    s_add_u32 s69, s74, 0
    s_and_b32 s69, s69, 15
    s_lshl_b32 s69, s69, 7
    s_add_u32 s69, s69, s72
    s_add_u32 m0, s75, 0
    s_add_u32 s68, s69, 0
    buffer_load_dwordx4 v1, s[52:55], s68 offen lds
    s_add_u32 m0, s75, 1024
    s_add_u32 s68, s69, 16384
    buffer_load_dwordx4 v2, s[52:55], s68 offen lds
    s_add_u32 m0, s75, 2048
    s_add_u32 s68, s69, 32768
    buffer_load_dwordx4 v1, s[52:55], s68 offen lds
    s_add_u32 m0, s75, 3072
    s_add_u32 s68, s69, 49152
    buffer_load_dwordx4 v2, s[52:55], s68 offen lds
    s_add_u32 s69, s74, 1
    s_and_b32 s69, s69, 15
    s_lshl_b32 s69, s69, 19
    s_add_u32 s69, s69, s73
    s_add_u32 m0, s76, 16384
    s_add_u32 s68, s69, 0
    buffer_load_dwordx4 v3, s[56:59], s68 offen lds
    s_add_u32 m0, s76, 17408
    s_add_u32 s68, s69, 32768
    buffer_load_dwordx4 v3, s[56:59], s68 offen lds
    s_add_u32 s69, s74, 1
    s_and_b32 s69, s69, 15
    s_lshl_b32 s69, s69, 19
    s_add_u32 s69, s69, s73
    s_add_u32 m0, s76, 24576
    s_add_u32 s68, s69, 262144
    buffer_load_dwordx4 v3, s[56:59], s68 offen lds
    s_add_u32 m0, s76, 25600
    s_add_u32 s68, s69, 294912
    buffer_load_dwordx4 v3, s[56:59], s68 offen lds
    s_add_u32 s69, s74, 1
    s_and_b32 s69, s69, 15
    s_lshl_b32 s69, s69, 7
    s_add_u32 s69, s69, s72
    s_add_u32 m0, s75, 4096
    s_add_u32 s68, s69, 0
    buffer_load_dwordx4 v1, s[52:55], s68 offen lds
    s_add_u32 m0, s75, 5120
    s_add_u32 s68, s69, 16384
    buffer_load_dwordx4 v2, s[52:55], s68 offen lds
    s_add_u32 m0, s75, 6144
    s_add_u32 s68, s69, 32768
    buffer_load_dwordx4 v1, s[52:55], s68 offen lds
    s_add_u32 m0, s75, 7168
    s_add_u32 s68, s69, 49152
    buffer_load_dwordx4 v2, s[52:55], s68 offen lds
    s_add_u32 s69, s74, 2
    s_and_b32 s69, s69, 15
    s_lshl_b32 s69, s69, 19
    s_add_u32 s69, s69, s73
    s_add_u32 m0, s76, 32768
    s_add_u32 s68, s69, 0
    buffer_load_dwordx4 v3, s[56:59], s68 offen lds
    s_add_u32 m0, s76, 33792
    s_add_u32 s68, s69, 32768
    buffer_load_dwordx4 v3, s[56:59], s68 offen lds
    s_add_u32 s69, s74, 2
    s_and_b32 s69, s69, 15
    s_lshl_b32 s69, s69, 19
    s_add_u32 s69, s69, s73
    s_add_u32 m0, s76, 40960
    s_add_u32 s68, s69, 262144
    buffer_load_dwordx4 v3, s[56:59], s68 offen lds
    s_add_u32 m0, s76, 41984
    s_add_u32 s68, s69, 294912
    buffer_load_dwordx4 v3, s[56:59], s68 offen lds
    s_add_u32 s69, s74, 2
    s_and_b32 s69, s69, 15
    s_lshl_b32 s69, s69, 7
    s_add_u32 s69, s69, s72
    s_add_u32 m0, s75, 8192
    s_add_u32 s68, s69, 0
    buffer_load_dwordx4 v1, s[52:55], s68 offen lds
    s_add_u32 m0, s75, 9216
    s_add_u32 s68, s69, 16384
    buffer_load_dwordx4 v2, s[52:55], s68 offen lds
    s_add_u32 m0, s75, 10240
    s_add_u32 s68, s69, 32768
    buffer_load_dwordx4 v1, s[52:55], s68 offen lds
    s_add_u32 m0, s75, 11264
    s_add_u32 s68, s69, 49152
    buffer_load_dwordx4 v2, s[52:55], s68 offen lds
    s_add_u32 s69, s74, 3
    s_and_b32 s69, s69, 15
    s_lshl_b32 s69, s69, 19
    s_add_u32 s69, s69, s73
    s_add_u32 m0, s76, 49152
    s_add_u32 s68, s69, 0
    buffer_load_dwordx4 v3, s[56:59], s68 offen lds
    s_add_u32 m0, s76, 50176
    s_add_u32 s68, s69, 32768
    buffer_load_dwordx4 v3, s[56:59], s68 offen lds
    s_add_u32 s69, s74, 3
    s_and_b32 s69, s69, 15
    s_lshl_b32 s69, s69, 19
    s_add_u32 s69, s69, s73
    s_add_u32 m0, s76, 57344
    s_add_u32 s68, s69, 262144
    buffer_load_dwordx4 v3, s[56:59], s68 offen lds
    s_add_u32 m0, s76, 58368
    s_add_u32 s68, s69, 294912
    buffer_load_dwordx4 v3, s[56:59], s68 offen lds
    s_add_u32 s69, s74, 3
    s_and_b32 s69, s69, 15
    s_lshl_b32 s69, s69, 7
    s_add_u32 s69, s69, s72
    s_add_u32 m0, s75, 12288
    s_add_u32 s68, s69, 0
    buffer_load_dwordx4 v1, s[52:55], s68 offen lds
    s_add_u32 m0, s75, 13312
    s_add_u32 s68, s69, 16384
    buffer_load_dwordx4 v2, s[52:55], s68 offen lds
    s_add_u32 m0, s75, 14336
    s_add_u32 s68, s69, 32768
    buffer_load_dwordx4 v1, s[52:55], s68 offen lds
    s_add_u32 m0, s75, 15360
    s_add_u32 s68, s69, 49152
    buffer_load_dwordx4 v2, s[52:55], s68 offen lds
    v_and_b32 v16, 31, v0
    v_lshrrev_b32 v17, 5, v0
    v_lshrrev_b32 v18, 1, v16
    v_and_b32 v18, 7, v18
    v_xor_b32 v18, v18, v17
    v_lshlrev_b32 v18, 4, v18
    v_lshl_add_u32 v18, v16, 7, v18

    v_xor_b32 v19, 0, v18
    v_add_u32 v4, s75, v19
    v_xor_b32 v19, 32, v18
    v_add_u32 v5, s75, v19
    v_xor_b32 v19, 64, v18
    v_add_u32 v6, s75, v19
    v_xor_b32 v19, 96, v18
    v_add_u32 v7, s75, v19
    v_bfe_u32 v16, v0, 4, 1
    v_bfe_u32 v18, v0, 2, 2
    v_and_b32 v19, 1, v0
    v_bfe_u32 v20, v0, 1, 1
    v_lshl_add_u32 v21, v17, 3, v18
    v_lshlrev_b32 v21, 8, v21
    v_lshl_add_u32 v21, v16, 5, v21
    v_lshl_add_u32 v21, v19, 4, v21
    v_lshl_add_u32 v21, v20, 3, v21
    v_lshl_add_u32 v21, v18, 6, v21

    v_xor_b32 v8, 0, v21
    v_xor_b32 v9, 64, v21
    v_xor_b32 v10, 128, v21
    v_xor_b32 v11, 192, v21
    v_lshlrev_b32 v21, 4, v0
    s_lshl_b32 s68, s4, 2
    s_add_u32 s68, s68, s3
    s_lshl_b32 s68, s68, 5
    s_add_u32 s68, s68, s5
    s_lshl_b32 s68, s68, 13
    v_add_u32 v12, s68, v21

    s_add_u32 s88, s40, 0x800000
    s_addc_u32 s89, s41, 0
    s_mov_b32 s90, 0x400000
    s_mov_b32 s91, 0x00020000
    s_add_u32 s92, s40, 0xc00000
    s_addc_u32 s93, s41, 0
    s_mov_b32 s94, 0x400000
    s_mov_b32 s95, 0x00020000
    s_sub_u32 s14, s2, 8
    s_lshl_b32 s14, s14, 8
    s_lshl_b32 s68, s3, 2
    s_add_u32 s14, s14, s68
    s_lshl_b32 s68, s4, 2
    s_add_u32 s68, s68, s3
    s_lshr_b32 s15, s68, 3
    s_lshl_b32 s15, s15, 2
    s_and_b32 s68, s68, 7
    s_lshl_b32 s68, s68, 5
    s_add_u32 s15, s15, s68
    s_lshr_b32 s68, s42, 1
    s_add_u32 s15, s15, s68
    s_and_b32 s68, s42, 1
    s_lshl_b32 s68, s68, 4
    s_add_u32 s15, s15, s68
    s_add_u32 s15, s15, 8
    s_lshl_b32 s15, s15, 8
    s_and_b32 s68, s43, 3
    s_lshl_b32 s68, s68, 2
    s_add_u32 s15, s15, s68

    s_waitcnt vmcnt(24)
    s_cmp_lg_u32 s3, 0
    s_cbranch_scc1 L_ga_11
    v_mov_b32 v16, 1
    v_mov_b32 v17, 0
    s_mov_b64 exec, 1
    buffer_atomic_add v16, v17, s[48:51], 0 offen sc1
    s_mov_b64 exec, -1

L_ga_11:
    s_barrier
    ds_read_b128 v[24:27], v4 offset:0
    ds_read_b64_tr_b16 v[40:41], v8 offset:0
    ds_read_b64_tr_b16 v[42:43], v8 offset:1024
    ds_read_b64_tr_b16 v[44:45], v9 offset:0
    ds_read_b64_tr_b16 v[46:47], v9 offset:1024
    ds_read_b64_tr_b16 v[48:49], v10 offset:0
    ds_read_b64_tr_b16 v[50:51], v10 offset:1024
    ds_read_b64_tr_b16 v[52:53], v11 offset:0
    ds_read_b64_tr_b16 v[54:55], v11 offset:1024
    ds_read_b128 v[28:31], v5 offset:0
    ds_read_b64_tr_b16 v[56:57], v8 offset:4096
    ds_read_b64_tr_b16 v[58:59], v8 offset:5120
    ds_read_b64_tr_b16 v[60:61], v9 offset:4096
    ds_read_b64_tr_b16 v[62:63], v9 offset:5120
    ds_read_b64_tr_b16 v[64:65], v10 offset:4096
    ds_read_b64_tr_b16 v[66:67], v10 offset:5120
    ds_read_b64_tr_b16 v[68:69], v11 offset:4096
    ds_read_b64_tr_b16 v[70:71], v11 offset:5120
    ds_read_b128 v[32:35], v6 offset:0
    ds_read_b64_tr_b16 v[72:73], v8 offset:8192
    ds_read_b64_tr_b16 v[74:75], v8 offset:9216
    ds_read_b64_tr_b16 v[76:77], v9 offset:8192
    ds_read_b64_tr_b16 v[78:79], v9 offset:9216
    ds_read_b64_tr_b16 v[80:81], v10 offset:8192
    ds_read_b64_tr_b16 v[82:83], v10 offset:9216
    ds_read_b64_tr_b16 v[84:85], v11 offset:8192
    ds_read_b64_tr_b16 v[86:87], v11 offset:9216
    ds_read_b128 v[36:39], v7 offset:0
    ds_read_b64_tr_b16 v[88:89], v8 offset:12288
    ds_read_b64_tr_b16 v[90:91], v8 offset:13312
    ds_read_b64_tr_b16 v[92:93], v9 offset:12288
    ds_read_b64_tr_b16 v[94:95], v9 offset:13312
    ds_read_b64_tr_b16 v[96:97], v10 offset:12288
    ds_read_b64_tr_b16 v[98:99], v10 offset:13312
    ds_read_b64_tr_b16 v[100:101], v11 offset:12288
    ds_read_b64_tr_b16 v[102:103], v11 offset:13312
    s_waitcnt lgkmcnt(0)
    v_mfma_f32_32x32x16_bf16 a[0:15], v[40:43], v[24:27], 0
    s_add_u32 s69, s74, 4
    s_and_b32 s69, s69, 15
    s_lshl_b32 s69, s69, 7
    s_add_u32 s69, s69, s72
    s_add_u32 m0, s75, 0
    s_add_u32 s68, s69, 0
    buffer_load_dwordx4 v1, s[52:55], s68 offen lds
    v_mfma_f32_32x32x16_bf16 a[16:31], v[44:47], v[24:27], 0
    s_add_u32 m0, s75, 1024
    s_add_u32 s68, s69, 16384
    buffer_load_dwordx4 v2, s[52:55], s68 offen lds
    s_waitcnt vmcnt(18)
    s_barrier
    v_mfma_f32_32x32x16_bf16 a[32:47], v[48:51], v[24:27], 0
    ds_read_b128 v[104:107], v4 offset:4096
    ds_read_b64_tr_b16 v[120:121], v8 offset:16384
    ds_read_b64_tr_b16 v[122:123], v8 offset:17408
    s_add_u32 m0, s75, 2048
    s_add_u32 s68, s69, 32768
    buffer_load_dwordx4 v1, s[52:55], s68 offen lds
    v_mfma_f32_32x32x16_bf16 a[48:63], v[52:55], v[24:27], 0
    ds_read_b64_tr_b16 v[124:125], v9 offset:16384
    ds_read_b64_tr_b16 v[126:127], v9 offset:17408
    ds_read_b64_tr_b16 v[128:129], v10 offset:16384
    s_add_u32 m0, s75, 3072
    s_add_u32 s68, s69, 49152
    buffer_load_dwordx4 v2, s[52:55], s68 offen lds
    v_mfma_f32_32x32x16_bf16 a[0:15], v[56:59], v[28:31], a[0:15]
    ds_read_b64_tr_b16 v[130:131], v10 offset:17408
    ds_read_b64_tr_b16 v[132:133], v11 offset:16384
    ds_read_b64_tr_b16 v[134:135], v11 offset:17408
    s_add_u32 s69, s74, 4
    s_and_b32 s69, s69, 15
    s_lshl_b32 s69, s69, 19
    s_add_u32 s69, s69, s73
    s_add_u32 m0, s76, 0
    s_add_u32 s68, s69, 0
    buffer_load_dwordx4 v3, s[56:59], s68 offen lds
    v_mfma_f32_32x32x16_bf16 a[16:31], v[60:63], v[28:31], a[16:31]
    ds_read_b128 v[108:111], v5 offset:4096
    ds_read_b64_tr_b16 v[136:137], v8 offset:20480
    ds_read_b64_tr_b16 v[138:139], v8 offset:21504
    s_add_u32 m0, s76, 1024
    s_add_u32 s68, s69, 32768
    buffer_load_dwordx4 v3, s[56:59], s68 offen lds
    v_mfma_f32_32x32x16_bf16 a[32:47], v[64:67], v[28:31], a[32:47]
    ds_read_b64_tr_b16 v[140:141], v9 offset:20480
    ds_read_b64_tr_b16 v[142:143], v9 offset:21504
    ds_read_b64_tr_b16 v[144:145], v10 offset:20480
    s_add_u32 s69, s74, 4
    s_and_b32 s69, s69, 15
    s_lshl_b32 s69, s69, 19
    s_add_u32 s69, s69, s73
    s_add_u32 m0, s76, 8192
    s_add_u32 s68, s69, 262144
    buffer_load_dwordx4 v3, s[56:59], s68 offen lds
    v_mfma_f32_32x32x16_bf16 a[48:63], v[68:71], v[28:31], a[48:63]
    ds_read_b64_tr_b16 v[146:147], v10 offset:21504
    ds_read_b64_tr_b16 v[148:149], v11 offset:20480
    ds_read_b64_tr_b16 v[150:151], v11 offset:21504
    s_add_u32 m0, s76, 9216
    s_add_u32 s68, s69, 294912
    buffer_load_dwordx4 v3, s[56:59], s68 offen lds
    v_mfma_f32_32x32x16_bf16 a[0:15], v[72:75], v[32:35], a[0:15]
    ds_read_b128 v[112:115], v6 offset:4096
    ds_read_b64_tr_b16 v[152:153], v8 offset:24576
    ds_read_b64_tr_b16 v[154:155], v8 offset:25600
    v_mfma_f32_32x32x16_bf16 a[16:31], v[76:79], v[32:35], a[16:31]
    ds_read_b64_tr_b16 v[156:157], v9 offset:24576
    ds_read_b64_tr_b16 v[158:159], v9 offset:25600
    ds_read_b64_tr_b16 v[160:161], v10 offset:24576
    v_mfma_f32_32x32x16_bf16 a[32:47], v[80:83], v[32:35], a[32:47]
    ds_read_b64_tr_b16 v[162:163], v10 offset:25600
    ds_read_b64_tr_b16 v[164:165], v11 offset:24576
    ds_read_b64_tr_b16 v[166:167], v11 offset:25600
    v_mfma_f32_32x32x16_bf16 a[48:63], v[84:87], v[32:35], a[48:63]
    ds_read_b128 v[116:119], v7 offset:4096
    ds_read_b64_tr_b16 v[168:169], v8 offset:28672
    ds_read_b64_tr_b16 v[170:171], v8 offset:29696
    v_mfma_f32_32x32x16_bf16 a[0:15], v[88:91], v[36:39], a[0:15]
    ds_read_b64_tr_b16 v[172:173], v9 offset:28672
    ds_read_b64_tr_b16 v[174:175], v9 offset:29696
    ds_read_b64_tr_b16 v[176:177], v10 offset:28672
    v_mfma_f32_32x32x16_bf16 a[16:31], v[92:95], v[36:39], a[16:31]
    ds_read_b64_tr_b16 v[178:179], v10 offset:29696
    ds_read_b64_tr_b16 v[180:181], v11 offset:28672
    ds_read_b64_tr_b16 v[182:183], v11 offset:29696
    v_mfma_f32_32x32x16_bf16 a[32:47], v[96:99], v[36:39], a[32:47]
    v_mfma_f32_32x32x16_bf16 a[48:63], v[100:103], v[36:39], a[48:63]
    s_waitcnt lgkmcnt(0)
    v_mfma_f32_32x32x16_bf16 a[0:15], v[120:123], v[104:107], a[0:15]
    s_add_u32 s69, s74, 5
    s_and_b32 s69, s69, 15
    s_lshl_b32 s69, s69, 7
    s_add_u32 s69, s69, s72
    s_add_u32 m0, s75, 4096
    s_add_u32 s68, s69, 0
    buffer_load_dwordx4 v1, s[52:55], s68 offen lds
    v_mfma_f32_32x32x16_bf16 a[16:31], v[124:127], v[104:107], a[16:31]
    s_add_u32 m0, s75, 5120
    s_add_u32 s68, s69, 16384
    buffer_load_dwordx4 v2, s[52:55], s68 offen lds
    s_waitcnt vmcnt(18)
    s_barrier
    v_mfma_f32_32x32x16_bf16 a[32:47], v[128:131], v[104:107], a[32:47]
    ds_read_b128 v[24:27], v4 offset:8192
    ds_read_b64_tr_b16 v[40:41], v8 offset:32768
    ds_read_b64_tr_b16 v[42:43], v8 offset:33792
    s_add_u32 m0, s75, 6144
    s_add_u32 s68, s69, 32768
    buffer_load_dwordx4 v1, s[52:55], s68 offen lds
    v_mfma_f32_32x32x16_bf16 a[48:63], v[132:135], v[104:107], a[48:63]
    ds_read_b64_tr_b16 v[44:45], v9 offset:32768
    ds_read_b64_tr_b16 v[46:47], v9 offset:33792
    ds_read_b64_tr_b16 v[48:49], v10 offset:32768
    s_add_u32 m0, s75, 7168
    s_add_u32 s68, s69, 49152
    buffer_load_dwordx4 v2, s[52:55], s68 offen lds
    v_mfma_f32_32x32x16_bf16 a[0:15], v[136:139], v[108:111], a[0:15]
    ds_read_b64_tr_b16 v[50:51], v10 offset:33792
    ds_read_b64_tr_b16 v[52:53], v11 offset:32768
    ds_read_b64_tr_b16 v[54:55], v11 offset:33792
    s_add_u32 s69, s74, 5
    s_and_b32 s69, s69, 15
    s_lshl_b32 s69, s69, 19
    s_add_u32 s69, s69, s73
    s_add_u32 m0, s76, 16384
    s_add_u32 s68, s69, 0
    buffer_load_dwordx4 v3, s[56:59], s68 offen lds
    v_mfma_f32_32x32x16_bf16 a[16:31], v[140:143], v[108:111], a[16:31]
    ds_read_b128 v[28:31], v5 offset:8192
    ds_read_b64_tr_b16 v[56:57], v8 offset:36864
    ds_read_b64_tr_b16 v[58:59], v8 offset:37888
    s_add_u32 m0, s76, 17408
    s_add_u32 s68, s69, 32768
    buffer_load_dwordx4 v3, s[56:59], s68 offen lds
    v_mfma_f32_32x32x16_bf16 a[32:47], v[144:147], v[108:111], a[32:47]
    ds_read_b64_tr_b16 v[60:61], v9 offset:36864
    ds_read_b64_tr_b16 v[62:63], v9 offset:37888
    ds_read_b64_tr_b16 v[64:65], v10 offset:36864
    s_add_u32 s69, s74, 5
    s_and_b32 s69, s69, 15
    s_lshl_b32 s69, s69, 19
    s_add_u32 s69, s69, s73
    s_add_u32 m0, s76, 24576
    s_add_u32 s68, s69, 262144
    buffer_load_dwordx4 v3, s[56:59], s68 offen lds
    v_mfma_f32_32x32x16_bf16 a[48:63], v[148:151], v[108:111], a[48:63]
    ds_read_b64_tr_b16 v[66:67], v10 offset:37888
    ds_read_b64_tr_b16 v[68:69], v11 offset:36864
    ds_read_b64_tr_b16 v[70:71], v11 offset:37888
    s_add_u32 m0, s76, 25600
    s_add_u32 s68, s69, 294912
    buffer_load_dwordx4 v3, s[56:59], s68 offen lds
    v_mfma_f32_32x32x16_bf16 a[0:15], v[152:155], v[112:115], a[0:15]
    ds_read_b128 v[32:35], v6 offset:8192
    ds_read_b64_tr_b16 v[72:73], v8 offset:40960
    ds_read_b64_tr_b16 v[74:75], v8 offset:41984
    v_mfma_f32_32x32x16_bf16 a[16:31], v[156:159], v[112:115], a[16:31]
    ds_read_b64_tr_b16 v[76:77], v9 offset:40960
    ds_read_b64_tr_b16 v[78:79], v9 offset:41984
    ds_read_b64_tr_b16 v[80:81], v10 offset:40960
    v_mfma_f32_32x32x16_bf16 a[32:47], v[160:163], v[112:115], a[32:47]
    ds_read_b64_tr_b16 v[82:83], v10 offset:41984
    ds_read_b64_tr_b16 v[84:85], v11 offset:40960
    ds_read_b64_tr_b16 v[86:87], v11 offset:41984
    v_mfma_f32_32x32x16_bf16 a[48:63], v[164:167], v[112:115], a[48:63]
    ds_read_b128 v[36:39], v7 offset:8192
    ds_read_b64_tr_b16 v[88:89], v8 offset:45056
    ds_read_b64_tr_b16 v[90:91], v8 offset:46080
    v_mfma_f32_32x32x16_bf16 a[0:15], v[168:171], v[116:119], a[0:15]
    ds_read_b64_tr_b16 v[92:93], v9 offset:45056
    ds_read_b64_tr_b16 v[94:95], v9 offset:46080
    ds_read_b64_tr_b16 v[96:97], v10 offset:45056
    v_mfma_f32_32x32x16_bf16 a[16:31], v[172:175], v[116:119], a[16:31]
    ds_read_b64_tr_b16 v[98:99], v10 offset:46080
    ds_read_b64_tr_b16 v[100:101], v11 offset:45056
    ds_read_b64_tr_b16 v[102:103], v11 offset:46080
    v_mfma_f32_32x32x16_bf16 a[32:47], v[176:179], v[116:119], a[32:47]
    v_mfma_f32_32x32x16_bf16 a[48:63], v[180:183], v[116:119], a[48:63]
    s_waitcnt lgkmcnt(0)
    v_mfma_f32_32x32x16_bf16 a[0:15], v[40:43], v[24:27], a[0:15]
    s_add_u32 s69, s74, 6
    s_and_b32 s69, s69, 15
    s_lshl_b32 s69, s69, 7
    s_add_u32 s69, s69, s72
    s_add_u32 m0, s75, 8192
    s_add_u32 s68, s69, 0
    buffer_load_dwordx4 v1, s[52:55], s68 offen lds
    v_mfma_f32_32x32x16_bf16 a[16:31], v[44:47], v[24:27], a[16:31]
    s_add_u32 m0, s75, 9216
    s_add_u32 s68, s69, 16384
    buffer_load_dwordx4 v2, s[52:55], s68 offen lds
    s_waitcnt vmcnt(18)
    s_barrier
    v_mfma_f32_32x32x16_bf16 a[32:47], v[48:51], v[24:27], a[32:47]
    ds_read_b128 v[104:107], v4 offset:12288
    ds_read_b64_tr_b16 v[120:121], v8 offset:49152
    ds_read_b64_tr_b16 v[122:123], v8 offset:50176
    s_add_u32 m0, s75, 10240
    s_add_u32 s68, s69, 32768
    buffer_load_dwordx4 v1, s[52:55], s68 offen lds
    v_mfma_f32_32x32x16_bf16 a[48:63], v[52:55], v[24:27], a[48:63]
    ds_read_b64_tr_b16 v[124:125], v9 offset:49152
    ds_read_b64_tr_b16 v[126:127], v9 offset:50176
    ds_read_b64_tr_b16 v[128:129], v10 offset:49152
    s_add_u32 m0, s75, 11264
    s_add_u32 s68, s69, 49152
    buffer_load_dwordx4 v2, s[52:55], s68 offen lds
    v_mfma_f32_32x32x16_bf16 a[0:15], v[56:59], v[28:31], a[0:15]
    ds_read_b64_tr_b16 v[130:131], v10 offset:50176
    ds_read_b64_tr_b16 v[132:133], v11 offset:49152
    ds_read_b64_tr_b16 v[134:135], v11 offset:50176
    s_add_u32 s69, s74, 6
    s_and_b32 s69, s69, 15
    s_lshl_b32 s69, s69, 19
    s_add_u32 s69, s69, s73
    s_add_u32 m0, s76, 32768
    s_add_u32 s68, s69, 0
    buffer_load_dwordx4 v3, s[56:59], s68 offen lds
    v_mfma_f32_32x32x16_bf16 a[16:31], v[60:63], v[28:31], a[16:31]
    ds_read_b128 v[108:111], v5 offset:12288
    ds_read_b64_tr_b16 v[136:137], v8 offset:53248
    ds_read_b64_tr_b16 v[138:139], v8 offset:54272
    s_add_u32 m0, s76, 33792
    s_add_u32 s68, s69, 32768
    buffer_load_dwordx4 v3, s[56:59], s68 offen lds
    v_mfma_f32_32x32x16_bf16 a[32:47], v[64:67], v[28:31], a[32:47]
    ds_read_b64_tr_b16 v[140:141], v9 offset:53248
    ds_read_b64_tr_b16 v[142:143], v9 offset:54272
    ds_read_b64_tr_b16 v[144:145], v10 offset:53248
    s_add_u32 s69, s74, 6
    s_and_b32 s69, s69, 15
    s_lshl_b32 s69, s69, 19
    s_add_u32 s69, s69, s73
    s_add_u32 m0, s76, 40960
    s_add_u32 s68, s69, 262144
    buffer_load_dwordx4 v3, s[56:59], s68 offen lds
    v_mfma_f32_32x32x16_bf16 a[48:63], v[68:71], v[28:31], a[48:63]
    ds_read_b64_tr_b16 v[146:147], v10 offset:54272
    ds_read_b64_tr_b16 v[148:149], v11 offset:53248
    ds_read_b64_tr_b16 v[150:151], v11 offset:54272
    s_add_u32 m0, s76, 41984
    s_add_u32 s68, s69, 294912
    buffer_load_dwordx4 v3, s[56:59], s68 offen lds
    v_mfma_f32_32x32x16_bf16 a[0:15], v[72:75], v[32:35], a[0:15]
    ds_read_b128 v[112:115], v6 offset:12288
    ds_read_b64_tr_b16 v[152:153], v8 offset:57344
    ds_read_b64_tr_b16 v[154:155], v8 offset:58368
    v_mfma_f32_32x32x16_bf16 a[16:31], v[76:79], v[32:35], a[16:31]
    ds_read_b64_tr_b16 v[156:157], v9 offset:57344
    ds_read_b64_tr_b16 v[158:159], v9 offset:58368
    ds_read_b64_tr_b16 v[160:161], v10 offset:57344
    v_mfma_f32_32x32x16_bf16 a[32:47], v[80:83], v[32:35], a[32:47]
    ds_read_b64_tr_b16 v[162:163], v10 offset:58368
    ds_read_b64_tr_b16 v[164:165], v11 offset:57344
    ds_read_b64_tr_b16 v[166:167], v11 offset:58368
    v_mfma_f32_32x32x16_bf16 a[48:63], v[84:87], v[32:35], a[48:63]
    ds_read_b128 v[116:119], v7 offset:12288
    ds_read_b64_tr_b16 v[168:169], v8 offset:61440
    ds_read_b64_tr_b16 v[170:171], v8 offset:62464
    v_mfma_f32_32x32x16_bf16 a[0:15], v[88:91], v[36:39], a[0:15]
    ds_read_b64_tr_b16 v[172:173], v9 offset:61440
    ds_read_b64_tr_b16 v[174:175], v9 offset:62464
    ds_read_b64_tr_b16 v[176:177], v10 offset:61440
    v_mfma_f32_32x32x16_bf16 a[16:31], v[92:95], v[36:39], a[16:31]
    ds_read_b64_tr_b16 v[178:179], v10 offset:62464
    ds_read_b64_tr_b16 v[180:181], v11 offset:61440
    ds_read_b64_tr_b16 v[182:183], v11 offset:62464
    v_mfma_f32_32x32x16_bf16 a[32:47], v[96:99], v[36:39], a[32:47]
    v_mfma_f32_32x32x16_bf16 a[48:63], v[100:103], v[36:39], a[48:63]
    s_waitcnt lgkmcnt(0)
    v_mfma_f32_32x32x16_bf16 a[0:15], v[120:123], v[104:107], a[0:15]
    s_add_u32 s69, s74, 7
    s_and_b32 s69, s69, 15
    s_lshl_b32 s69, s69, 7
    s_add_u32 s69, s69, s72
    s_add_u32 m0, s75, 12288
    s_add_u32 s68, s69, 0
    buffer_load_dwordx4 v1, s[52:55], s68 offen lds
    v_mfma_f32_32x32x16_bf16 a[16:31], v[124:127], v[104:107], a[16:31]
    s_add_u32 m0, s75, 13312
    s_add_u32 s68, s69, 16384
    buffer_load_dwordx4 v2, s[52:55], s68 offen lds
    s_waitcnt vmcnt(18)
    s_barrier
    v_mfma_f32_32x32x16_bf16 a[32:47], v[128:131], v[104:107], a[32:47]
    ds_read_b128 v[24:27], v4 offset:0
    ds_read_b64_tr_b16 v[40:41], v8 offset:0
    ds_read_b64_tr_b16 v[42:43], v8 offset:1024
    s_add_u32 m0, s75, 14336
    s_add_u32 s68, s69, 32768
    buffer_load_dwordx4 v1, s[52:55], s68 offen lds
    v_mfma_f32_32x32x16_bf16 a[48:63], v[132:135], v[104:107], a[48:63]
    ds_read_b64_tr_b16 v[44:45], v9 offset:0
    ds_read_b64_tr_b16 v[46:47], v9 offset:1024
    ds_read_b64_tr_b16 v[48:49], v10 offset:0
    s_add_u32 m0, s75, 15360
    s_add_u32 s68, s69, 49152
    buffer_load_dwordx4 v2, s[52:55], s68 offen lds
    v_mfma_f32_32x32x16_bf16 a[0:15], v[136:139], v[108:111], a[0:15]
    ds_read_b64_tr_b16 v[50:51], v10 offset:1024
    ds_read_b64_tr_b16 v[52:53], v11 offset:0
    ds_read_b64_tr_b16 v[54:55], v11 offset:1024
    s_add_u32 s69, s74, 7
    s_and_b32 s69, s69, 15
    s_lshl_b32 s69, s69, 19
    s_add_u32 s69, s69, s73
    s_add_u32 m0, s76, 49152
    s_add_u32 s68, s69, 0
    buffer_load_dwordx4 v3, s[56:59], s68 offen lds
    v_mfma_f32_32x32x16_bf16 a[16:31], v[140:143], v[108:111], a[16:31]
    ds_read_b128 v[28:31], v5 offset:0
    ds_read_b64_tr_b16 v[56:57], v8 offset:4096
    ds_read_b64_tr_b16 v[58:59], v8 offset:5120
    s_add_u32 m0, s76, 50176
    s_add_u32 s68, s69, 32768
    buffer_load_dwordx4 v3, s[56:59], s68 offen lds
    v_mfma_f32_32x32x16_bf16 a[32:47], v[144:147], v[108:111], a[32:47]
    ds_read_b64_tr_b16 v[60:61], v9 offset:4096
    ds_read_b64_tr_b16 v[62:63], v9 offset:5120
    ds_read_b64_tr_b16 v[64:65], v10 offset:4096
    s_add_u32 s69, s74, 7
    s_and_b32 s69, s69, 15
    s_lshl_b32 s69, s69, 19
    s_add_u32 s69, s69, s73
    s_add_u32 m0, s76, 57344
    s_add_u32 s68, s69, 262144
    buffer_load_dwordx4 v3, s[56:59], s68 offen lds
    v_mfma_f32_32x32x16_bf16 a[48:63], v[148:151], v[108:111], a[48:63]
    ds_read_b64_tr_b16 v[66:67], v10 offset:5120
    ds_read_b64_tr_b16 v[68:69], v11 offset:4096
    ds_read_b64_tr_b16 v[70:71], v11 offset:5120
    s_add_u32 m0, s76, 58368
    s_add_u32 s68, s69, 294912
    buffer_load_dwordx4 v3, s[56:59], s68 offen lds
    v_mfma_f32_32x32x16_bf16 a[0:15], v[152:155], v[112:115], a[0:15]
    ds_read_b128 v[32:35], v6 offset:0
    ds_read_b64_tr_b16 v[72:73], v8 offset:8192
    ds_read_b64_tr_b16 v[74:75], v8 offset:9216
    v_mfma_f32_32x32x16_bf16 a[16:31], v[156:159], v[112:115], a[16:31]
    ds_read_b64_tr_b16 v[76:77], v9 offset:8192
    ds_read_b64_tr_b16 v[78:79], v9 offset:9216
    ds_read_b64_tr_b16 v[80:81], v10 offset:8192
    v_mfma_f32_32x32x16_bf16 a[32:47], v[160:163], v[112:115], a[32:47]
    ds_read_b64_tr_b16 v[82:83], v10 offset:9216
    ds_read_b64_tr_b16 v[84:85], v11 offset:8192
    ds_read_b64_tr_b16 v[86:87], v11 offset:9216
    v_mfma_f32_32x32x16_bf16 a[48:63], v[164:167], v[112:115], a[48:63]
    ds_read_b128 v[36:39], v7 offset:0
    ds_read_b64_tr_b16 v[88:89], v8 offset:12288
    ds_read_b64_tr_b16 v[90:91], v8 offset:13312
    v_mfma_f32_32x32x16_bf16 a[0:15], v[168:171], v[116:119], a[0:15]
    ds_read_b64_tr_b16 v[92:93], v9 offset:12288
    ds_read_b64_tr_b16 v[94:95], v9 offset:13312
    ds_read_b64_tr_b16 v[96:97], v10 offset:12288
    v_mfma_f32_32x32x16_bf16 a[16:31], v[172:175], v[116:119], a[16:31]
    ds_read_b64_tr_b16 v[98:99], v10 offset:13312
    ds_read_b64_tr_b16 v[100:101], v11 offset:12288
    ds_read_b64_tr_b16 v[102:103], v11 offset:13312
    v_mfma_f32_32x32x16_bf16 a[32:47], v[176:179], v[116:119], a[32:47]
    v_mfma_f32_32x32x16_bf16 a[48:63], v[180:183], v[116:119], a[48:63]
    s_waitcnt lgkmcnt(0)
    v_mfma_f32_32x32x16_bf16 a[0:15], v[40:43], v[24:27], a[0:15]
    s_add_u32 s69, s74, 8
    s_and_b32 s69, s69, 15
    s_lshl_b32 s69, s69, 7
    s_add_u32 s69, s69, s72
    s_add_u32 m0, s75, 0
    s_add_u32 s68, s69, 0
    buffer_load_dwordx4 v1, s[52:55], s68 offen lds
    v_mfma_f32_32x32x16_bf16 a[16:31], v[44:47], v[24:27], a[16:31]
    s_add_u32 m0, s75, 1024
    s_add_u32 s68, s69, 16384
    buffer_load_dwordx4 v2, s[52:55], s68 offen lds
    s_waitcnt vmcnt(18)
    s_barrier
    v_mfma_f32_32x32x16_bf16 a[32:47], v[48:51], v[24:27], a[32:47]
    ds_read_b128 v[104:107], v4 offset:4096
    ds_read_b64_tr_b16 v[120:121], v8 offset:16384
    ds_read_b64_tr_b16 v[122:123], v8 offset:17408
    s_add_u32 m0, s75, 2048
    s_add_u32 s68, s69, 32768
    buffer_load_dwordx4 v1, s[52:55], s68 offen lds
    v_mfma_f32_32x32x16_bf16 a[48:63], v[52:55], v[24:27], a[48:63]
    ds_read_b64_tr_b16 v[124:125], v9 offset:16384
    ds_read_b64_tr_b16 v[126:127], v9 offset:17408
    ds_read_b64_tr_b16 v[128:129], v10 offset:16384
    s_add_u32 m0, s75, 3072
    s_add_u32 s68, s69, 49152
    buffer_load_dwordx4 v2, s[52:55], s68 offen lds
    v_mfma_f32_32x32x16_bf16 a[0:15], v[56:59], v[28:31], a[0:15]
    ds_read_b64_tr_b16 v[130:131], v10 offset:17408
    ds_read_b64_tr_b16 v[132:133], v11 offset:16384
    ds_read_b64_tr_b16 v[134:135], v11 offset:17408
    s_add_u32 s69, s74, 8
    s_and_b32 s69, s69, 15
    s_lshl_b32 s69, s69, 19
    s_add_u32 s69, s69, s73
    s_add_u32 m0, s76, 0
    s_add_u32 s68, s69, 0
    buffer_load_dwordx4 v3, s[56:59], s68 offen lds
    v_mfma_f32_32x32x16_bf16 a[16:31], v[60:63], v[28:31], a[16:31]
    ds_read_b128 v[108:111], v5 offset:4096
    ds_read_b64_tr_b16 v[136:137], v8 offset:20480
    ds_read_b64_tr_b16 v[138:139], v8 offset:21504
    s_add_u32 m0, s76, 1024
    s_add_u32 s68, s69, 32768
    buffer_load_dwordx4 v3, s[56:59], s68 offen lds
    v_mfma_f32_32x32x16_bf16 a[32:47], v[64:67], v[28:31], a[32:47]
    ds_read_b64_tr_b16 v[140:141], v9 offset:20480
    ds_read_b64_tr_b16 v[142:143], v9 offset:21504
    ds_read_b64_tr_b16 v[144:145], v10 offset:20480
    s_add_u32 s69, s74, 8
    s_and_b32 s69, s69, 15
    s_lshl_b32 s69, s69, 19
    s_add_u32 s69, s69, s73
    s_add_u32 m0, s76, 8192
    s_add_u32 s68, s69, 262144
    buffer_load_dwordx4 v3, s[56:59], s68 offen lds
    v_mfma_f32_32x32x16_bf16 a[48:63], v[68:71], v[28:31], a[48:63]
    ds_read_b64_tr_b16 v[146:147], v10 offset:21504
    ds_read_b64_tr_b16 v[148:149], v11 offset:20480
    ds_read_b64_tr_b16 v[150:151], v11 offset:21504
    s_add_u32 m0, s76, 9216
    s_add_u32 s68, s69, 294912
    buffer_load_dwordx4 v3, s[56:59], s68 offen lds
    v_mfma_f32_32x32x16_bf16 a[0:15], v[72:75], v[32:35], a[0:15]
    ds_read_b128 v[112:115], v6 offset:4096
    ds_read_b64_tr_b16 v[152:153], v8 offset:24576
    ds_read_b64_tr_b16 v[154:155], v8 offset:25600
    v_mfma_f32_32x32x16_bf16 a[16:31], v[76:79], v[32:35], a[16:31]
    ds_read_b64_tr_b16 v[156:157], v9 offset:24576
    ds_read_b64_tr_b16 v[158:159], v9 offset:25600
    ds_read_b64_tr_b16 v[160:161], v10 offset:24576
    v_mfma_f32_32x32x16_bf16 a[32:47], v[80:83], v[32:35], a[32:47]
    ds_read_b64_tr_b16 v[162:163], v10 offset:25600
    ds_read_b64_tr_b16 v[164:165], v11 offset:24576
    ds_read_b64_tr_b16 v[166:167], v11 offset:25600
    v_mfma_f32_32x32x16_bf16 a[48:63], v[84:87], v[32:35], a[48:63]
    ds_read_b128 v[116:119], v7 offset:4096
    ds_read_b64_tr_b16 v[168:169], v8 offset:28672
    ds_read_b64_tr_b16 v[170:171], v8 offset:29696
    v_mfma_f32_32x32x16_bf16 a[0:15], v[88:91], v[36:39], a[0:15]
    ds_read_b64_tr_b16 v[172:173], v9 offset:28672
    ds_read_b64_tr_b16 v[174:175], v9 offset:29696
    ds_read_b64_tr_b16 v[176:177], v10 offset:28672
    v_mfma_f32_32x32x16_bf16 a[16:31], v[92:95], v[36:39], a[16:31]
    ds_read_b64_tr_b16 v[178:179], v10 offset:29696
    ds_read_b64_tr_b16 v[180:181], v11 offset:28672
    ds_read_b64_tr_b16 v[182:183], v11 offset:29696
    v_mfma_f32_32x32x16_bf16 a[32:47], v[96:99], v[36:39], a[32:47]
    v_mfma_f32_32x32x16_bf16 a[48:63], v[100:103], v[36:39], a[48:63]
    s_waitcnt lgkmcnt(0)
    v_mfma_f32_32x32x16_bf16 a[0:15], v[120:123], v[104:107], a[0:15]
    s_add_u32 s69, s74, 9
    s_and_b32 s69, s69, 15
    s_lshl_b32 s69, s69, 7
    s_add_u32 s69, s69, s72
    s_add_u32 m0, s75, 4096
    s_add_u32 s68, s69, 0
    buffer_load_dwordx4 v1, s[52:55], s68 offen lds
    v_mfma_f32_32x32x16_bf16 a[16:31], v[124:127], v[104:107], a[16:31]
    s_add_u32 m0, s75, 5120
    s_add_u32 s68, s69, 16384
    buffer_load_dwordx4 v2, s[52:55], s68 offen lds
    s_waitcnt vmcnt(18)
    s_barrier
    v_mfma_f32_32x32x16_bf16 a[32:47], v[128:131], v[104:107], a[32:47]
    ds_read_b128 v[24:27], v4 offset:8192
    ds_read_b64_tr_b16 v[40:41], v8 offset:32768
    ds_read_b64_tr_b16 v[42:43], v8 offset:33792
    s_add_u32 m0, s75, 6144
    s_add_u32 s68, s69, 32768
    buffer_load_dwordx4 v1, s[52:55], s68 offen lds
    v_mfma_f32_32x32x16_bf16 a[48:63], v[132:135], v[104:107], a[48:63]
    ds_read_b64_tr_b16 v[44:45], v9 offset:32768
    ds_read_b64_tr_b16 v[46:47], v9 offset:33792
    ds_read_b64_tr_b16 v[48:49], v10 offset:32768
    s_add_u32 m0, s75, 7168
    s_add_u32 s68, s69, 49152
    buffer_load_dwordx4 v2, s[52:55], s68 offen lds
    v_mfma_f32_32x32x16_bf16 a[0:15], v[136:139], v[108:111], a[0:15]
    ds_read_b64_tr_b16 v[50:51], v10 offset:33792
    ds_read_b64_tr_b16 v[52:53], v11 offset:32768
    ds_read_b64_tr_b16 v[54:55], v11 offset:33792
    s_add_u32 s69, s74, 9
    s_and_b32 s69, s69, 15
    s_lshl_b32 s69, s69, 19
    s_add_u32 s69, s69, s73
    s_add_u32 m0, s76, 16384
    s_add_u32 s68, s69, 0
    buffer_load_dwordx4 v3, s[56:59], s68 offen lds
    v_mfma_f32_32x32x16_bf16 a[16:31], v[140:143], v[108:111], a[16:31]
    ds_read_b128 v[28:31], v5 offset:8192
    ds_read_b64_tr_b16 v[56:57], v8 offset:36864
    ds_read_b64_tr_b16 v[58:59], v8 offset:37888
    s_add_u32 m0, s76, 17408
    s_add_u32 s68, s69, 32768
    buffer_load_dwordx4 v3, s[56:59], s68 offen lds
    v_mfma_f32_32x32x16_bf16 a[32:47], v[144:147], v[108:111], a[32:47]
    ds_read_b64_tr_b16 v[60:61], v9 offset:36864
    ds_read_b64_tr_b16 v[62:63], v9 offset:37888
    ds_read_b64_tr_b16 v[64:65], v10 offset:36864
    s_add_u32 s69, s74, 9
    s_and_b32 s69, s69, 15
    s_lshl_b32 s69, s69, 19
    s_add_u32 s69, s69, s73
    s_add_u32 m0, s76, 24576
    s_add_u32 s68, s69, 262144
    buffer_load_dwordx4 v3, s[56:59], s68 offen lds
    v_mfma_f32_32x32x16_bf16 a[48:63], v[148:151], v[108:111], a[48:63]
    ds_read_b64_tr_b16 v[66:67], v10 offset:37888
    ds_read_b64_tr_b16 v[68:69], v11 offset:36864
    ds_read_b64_tr_b16 v[70:71], v11 offset:37888
    s_add_u32 m0, s76, 25600
    s_add_u32 s68, s69, 294912
    buffer_load_dwordx4 v3, s[56:59], s68 offen lds
    v_mfma_f32_32x32x16_bf16 a[0:15], v[152:155], v[112:115], a[0:15]
    ds_read_b128 v[32:35], v6 offset:8192
    ds_read_b64_tr_b16 v[72:73], v8 offset:40960
    ds_read_b64_tr_b16 v[74:75], v8 offset:41984
    v_mfma_f32_32x32x16_bf16 a[16:31], v[156:159], v[112:115], a[16:31]
    ds_read_b64_tr_b16 v[76:77], v9 offset:40960
    ds_read_b64_tr_b16 v[78:79], v9 offset:41984
    ds_read_b64_tr_b16 v[80:81], v10 offset:40960
    v_mfma_f32_32x32x16_bf16 a[32:47], v[160:163], v[112:115], a[32:47]
    ds_read_b64_tr_b16 v[82:83], v10 offset:41984
    ds_read_b64_tr_b16 v[84:85], v11 offset:40960
    ds_read_b64_tr_b16 v[86:87], v11 offset:41984
    v_mfma_f32_32x32x16_bf16 a[48:63], v[164:167], v[112:115], a[48:63]
    ds_read_b128 v[36:39], v7 offset:8192
    ds_read_b64_tr_b16 v[88:89], v8 offset:45056
    ds_read_b64_tr_b16 v[90:91], v8 offset:46080
    v_mfma_f32_32x32x16_bf16 a[0:15], v[168:171], v[116:119], a[0:15]
    ds_read_b64_tr_b16 v[92:93], v9 offset:45056
    ds_read_b64_tr_b16 v[94:95], v9 offset:46080
    ds_read_b64_tr_b16 v[96:97], v10 offset:45056
    v_mfma_f32_32x32x16_bf16 a[16:31], v[172:175], v[116:119], a[16:31]
    ds_read_b64_tr_b16 v[98:99], v10 offset:46080
    ds_read_b64_tr_b16 v[100:101], v11 offset:45056
    ds_read_b64_tr_b16 v[102:103], v11 offset:46080
    v_mfma_f32_32x32x16_bf16 a[32:47], v[176:179], v[116:119], a[32:47]
    v_mfma_f32_32x32x16_bf16 a[48:63], v[180:183], v[116:119], a[48:63]
    s_waitcnt lgkmcnt(0)
    v_mfma_f32_32x32x16_bf16 a[0:15], v[40:43], v[24:27], a[0:15]
    s_add_u32 s69, s74, 10
    s_and_b32 s69, s69, 15
    s_lshl_b32 s69, s69, 7
    s_add_u32 s69, s69, s72
    s_add_u32 m0, s75, 8192
    s_add_u32 s68, s69, 0
    buffer_load_dwordx4 v1, s[52:55], s68 offen lds
    v_mfma_f32_32x32x16_bf16 a[16:31], v[44:47], v[24:27], a[16:31]
    s_add_u32 m0, s75, 9216
    s_add_u32 s68, s69, 16384
    buffer_load_dwordx4 v2, s[52:55], s68 offen lds
    s_waitcnt vmcnt(18)
    s_barrier
    v_mfma_f32_32x32x16_bf16 a[32:47], v[48:51], v[24:27], a[32:47]
    ds_read_b128 v[104:107], v4 offset:12288
    ds_read_b64_tr_b16 v[120:121], v8 offset:49152
    ds_read_b64_tr_b16 v[122:123], v8 offset:50176
    s_add_u32 m0, s75, 10240
    s_add_u32 s68, s69, 32768
    buffer_load_dwordx4 v1, s[52:55], s68 offen lds
    v_mfma_f32_32x32x16_bf16 a[48:63], v[52:55], v[24:27], a[48:63]
    ds_read_b64_tr_b16 v[124:125], v9 offset:49152
    ds_read_b64_tr_b16 v[126:127], v9 offset:50176
    ds_read_b64_tr_b16 v[128:129], v10 offset:49152
    s_add_u32 m0, s75, 11264
    s_add_u32 s68, s69, 49152
    buffer_load_dwordx4 v2, s[52:55], s68 offen lds
    v_mfma_f32_32x32x16_bf16 a[0:15], v[56:59], v[28:31], a[0:15]
    ds_read_b64_tr_b16 v[130:131], v10 offset:50176
    ds_read_b64_tr_b16 v[132:133], v11 offset:49152
    ds_read_b64_tr_b16 v[134:135], v11 offset:50176
    s_add_u32 s69, s74, 10
    s_and_b32 s69, s69, 15
    s_lshl_b32 s69, s69, 19
    s_add_u32 s69, s69, s73
    s_add_u32 m0, s76, 32768
    s_add_u32 s68, s69, 0
    buffer_load_dwordx4 v3, s[56:59], s68 offen lds
    v_mfma_f32_32x32x16_bf16 a[16:31], v[60:63], v[28:31], a[16:31]
    ds_read_b128 v[108:111], v5 offset:12288
    ds_read_b64_tr_b16 v[136:137], v8 offset:53248
    ds_read_b64_tr_b16 v[138:139], v8 offset:54272
    s_add_u32 m0, s76, 33792
    s_add_u32 s68, s69, 32768
    buffer_load_dwordx4 v3, s[56:59], s68 offen lds
    v_mfma_f32_32x32x16_bf16 a[32:47], v[64:67], v[28:31], a[32:47]
    ds_read_b64_tr_b16 v[140:141], v9 offset:53248
    ds_read_b64_tr_b16 v[142:143], v9 offset:54272
    ds_read_b64_tr_b16 v[144:145], v10 offset:53248
    s_add_u32 s69, s74, 10
    s_and_b32 s69, s69, 15
    s_lshl_b32 s69, s69, 19
    s_add_u32 s69, s69, s73
    s_add_u32 m0, s76, 40960
    s_add_u32 s68, s69, 262144
    buffer_load_dwordx4 v3, s[56:59], s68 offen lds
    v_mfma_f32_32x32x16_bf16 a[48:63], v[68:71], v[28:31], a[48:63]
    ds_read_b64_tr_b16 v[146:147], v10 offset:54272
    ds_read_b64_tr_b16 v[148:149], v11 offset:53248
    ds_read_b64_tr_b16 v[150:151], v11 offset:54272
    s_add_u32 m0, s76, 41984
    s_add_u32 s68, s69, 294912
    buffer_load_dwordx4 v3, s[56:59], s68 offen lds
    v_mfma_f32_32x32x16_bf16 a[0:15], v[72:75], v[32:35], a[0:15]
    ds_read_b128 v[112:115], v6 offset:12288
    ds_read_b64_tr_b16 v[152:153], v8 offset:57344
    ds_read_b64_tr_b16 v[154:155], v8 offset:58368
    v_mfma_f32_32x32x16_bf16 a[16:31], v[76:79], v[32:35], a[16:31]
    ds_read_b64_tr_b16 v[156:157], v9 offset:57344
    ds_read_b64_tr_b16 v[158:159], v9 offset:58368
    ds_read_b64_tr_b16 v[160:161], v10 offset:57344
    v_mfma_f32_32x32x16_bf16 a[32:47], v[80:83], v[32:35], a[32:47]
    ds_read_b64_tr_b16 v[162:163], v10 offset:58368
    ds_read_b64_tr_b16 v[164:165], v11 offset:57344
    ds_read_b64_tr_b16 v[166:167], v11 offset:58368
    v_mfma_f32_32x32x16_bf16 a[48:63], v[84:87], v[32:35], a[48:63]
    ds_read_b128 v[116:119], v7 offset:12288
    ds_read_b64_tr_b16 v[168:169], v8 offset:61440
    ds_read_b64_tr_b16 v[170:171], v8 offset:62464
    v_mfma_f32_32x32x16_bf16 a[0:15], v[88:91], v[36:39], a[0:15]
    ds_read_b64_tr_b16 v[172:173], v9 offset:61440
    ds_read_b64_tr_b16 v[174:175], v9 offset:62464
    ds_read_b64_tr_b16 v[176:177], v10 offset:61440
    v_mfma_f32_32x32x16_bf16 a[16:31], v[92:95], v[36:39], a[16:31]
    ds_read_b64_tr_b16 v[178:179], v10 offset:62464
    ds_read_b64_tr_b16 v[180:181], v11 offset:61440
    ds_read_b64_tr_b16 v[182:183], v11 offset:62464
    v_mfma_f32_32x32x16_bf16 a[32:47], v[96:99], v[36:39], a[32:47]
    v_mfma_f32_32x32x16_bf16 a[48:63], v[100:103], v[36:39], a[48:63]
    s_waitcnt lgkmcnt(0)
    v_mfma_f32_32x32x16_bf16 a[0:15], v[120:123], v[104:107], a[0:15]
    s_add_u32 s69, s74, 11
    s_and_b32 s69, s69, 15
    s_lshl_b32 s69, s69, 7
    s_add_u32 s69, s69, s72
    s_add_u32 m0, s75, 12288
    s_add_u32 s68, s69, 0
    buffer_load_dwordx4 v1, s[52:55], s68 offen lds
    v_mfma_f32_32x32x16_bf16 a[16:31], v[124:127], v[104:107], a[16:31]
    s_add_u32 m0, s75, 13312
    s_add_u32 s68, s69, 16384
    buffer_load_dwordx4 v2, s[52:55], s68 offen lds
    s_waitcnt vmcnt(18)
    s_barrier
    v_mfma_f32_32x32x16_bf16 a[32:47], v[128:131], v[104:107], a[32:47]
    ds_read_b128 v[24:27], v4 offset:0
    ds_read_b64_tr_b16 v[40:41], v8 offset:0
    ds_read_b64_tr_b16 v[42:43], v8 offset:1024
    s_add_u32 m0, s75, 14336
    s_add_u32 s68, s69, 32768
    buffer_load_dwordx4 v1, s[52:55], s68 offen lds
    v_mfma_f32_32x32x16_bf16 a[48:63], v[132:135], v[104:107], a[48:63]
    ds_read_b64_tr_b16 v[44:45], v9 offset:0
    ds_read_b64_tr_b16 v[46:47], v9 offset:1024
    ds_read_b64_tr_b16 v[48:49], v10 offset:0
    s_add_u32 m0, s75, 15360
    s_add_u32 s68, s69, 49152
    buffer_load_dwordx4 v2, s[52:55], s68 offen lds
    v_mfma_f32_32x32x16_bf16 a[0:15], v[136:139], v[108:111], a[0:15]
    ds_read_b64_tr_b16 v[50:51], v10 offset:1024
    ds_read_b64_tr_b16 v[52:53], v11 offset:0
    ds_read_b64_tr_b16 v[54:55], v11 offset:1024
    s_add_u32 s69, s74, 11
    s_and_b32 s69, s69, 15
    s_lshl_b32 s69, s69, 19
    s_add_u32 s69, s69, s73
    s_add_u32 m0, s76, 49152
    s_add_u32 s68, s69, 0
    buffer_load_dwordx4 v3, s[56:59], s68 offen lds
    v_mfma_f32_32x32x16_bf16 a[16:31], v[140:143], v[108:111], a[16:31]
    ds_read_b128 v[28:31], v5 offset:0
    ds_read_b64_tr_b16 v[56:57], v8 offset:4096
    ds_read_b64_tr_b16 v[58:59], v8 offset:5120
    s_add_u32 m0, s76, 50176
    s_add_u32 s68, s69, 32768
    buffer_load_dwordx4 v3, s[56:59], s68 offen lds
    v_mfma_f32_32x32x16_bf16 a[32:47], v[144:147], v[108:111], a[32:47]
    ds_read_b64_tr_b16 v[60:61], v9 offset:4096
    ds_read_b64_tr_b16 v[62:63], v9 offset:5120
    ds_read_b64_tr_b16 v[64:65], v10 offset:4096
    s_add_u32 s69, s74, 11
    s_and_b32 s69, s69, 15
    s_lshl_b32 s69, s69, 19
    s_add_u32 s69, s69, s73
    s_add_u32 m0, s76, 57344
    s_add_u32 s68, s69, 262144
    buffer_load_dwordx4 v3, s[56:59], s68 offen lds
    v_mfma_f32_32x32x16_bf16 a[48:63], v[148:151], v[108:111], a[48:63]
    ds_read_b64_tr_b16 v[66:67], v10 offset:5120
    ds_read_b64_tr_b16 v[68:69], v11 offset:4096
    ds_read_b64_tr_b16 v[70:71], v11 offset:5120
    s_add_u32 m0, s76, 58368
    s_add_u32 s68, s69, 294912
    buffer_load_dwordx4 v3, s[56:59], s68 offen lds
    v_mfma_f32_32x32x16_bf16 a[0:15], v[152:155], v[112:115], a[0:15]
    ds_read_b128 v[32:35], v6 offset:0
    ds_read_b64_tr_b16 v[72:73], v8 offset:8192
    ds_read_b64_tr_b16 v[74:75], v8 offset:9216
    v_mfma_f32_32x32x16_bf16 a[16:31], v[156:159], v[112:115], a[16:31]
    ds_read_b64_tr_b16 v[76:77], v9 offset:8192
    ds_read_b64_tr_b16 v[78:79], v9 offset:9216
    ds_read_b64_tr_b16 v[80:81], v10 offset:8192
    v_mfma_f32_32x32x16_bf16 a[32:47], v[160:163], v[112:115], a[32:47]
    ds_read_b64_tr_b16 v[82:83], v10 offset:9216
    ds_read_b64_tr_b16 v[84:85], v11 offset:8192
    ds_read_b64_tr_b16 v[86:87], v11 offset:9216
    v_mfma_f32_32x32x16_bf16 a[48:63], v[164:167], v[112:115], a[48:63]
    ds_read_b128 v[36:39], v7 offset:0
    ds_read_b64_tr_b16 v[88:89], v8 offset:12288
    ds_read_b64_tr_b16 v[90:91], v8 offset:13312
    v_mfma_f32_32x32x16_bf16 a[0:15], v[168:171], v[116:119], a[0:15]
    ds_read_b64_tr_b16 v[92:93], v9 offset:12288
    ds_read_b64_tr_b16 v[94:95], v9 offset:13312
    ds_read_b64_tr_b16 v[96:97], v10 offset:12288
    v_mfma_f32_32x32x16_bf16 a[16:31], v[172:175], v[116:119], a[16:31]
    ds_read_b64_tr_b16 v[98:99], v10 offset:13312
    ds_read_b64_tr_b16 v[100:101], v11 offset:12288
    ds_read_b64_tr_b16 v[102:103], v11 offset:13312
    v_mfma_f32_32x32x16_bf16 a[32:47], v[176:179], v[116:119], a[32:47]
    v_mfma_f32_32x32x16_bf16 a[48:63], v[180:183], v[116:119], a[48:63]
    s_waitcnt lgkmcnt(0)
    v_mfma_f32_32x32x16_bf16 a[0:15], v[40:43], v[24:27], a[0:15]
    s_add_u32 s69, s74, 12
    s_and_b32 s69, s69, 15
    s_lshl_b32 s69, s69, 7
    s_add_u32 s69, s69, s72
    s_add_u32 m0, s75, 0
    s_add_u32 s68, s69, 0
    buffer_load_dwordx4 v1, s[52:55], s68 offen lds
    v_mfma_f32_32x32x16_bf16 a[16:31], v[44:47], v[24:27], a[16:31]
    s_add_u32 m0, s75, 1024
    s_add_u32 s68, s69, 16384
    buffer_load_dwordx4 v2, s[52:55], s68 offen lds
    s_waitcnt vmcnt(18)
    s_barrier
    v_mfma_f32_32x32x16_bf16 a[32:47], v[48:51], v[24:27], a[32:47]
    ds_read_b128 v[104:107], v4 offset:4096
    ds_read_b64_tr_b16 v[120:121], v8 offset:16384
    ds_read_b64_tr_b16 v[122:123], v8 offset:17408
    s_add_u32 m0, s75, 2048
    s_add_u32 s68, s69, 32768
    buffer_load_dwordx4 v1, s[52:55], s68 offen lds
    v_mfma_f32_32x32x16_bf16 a[48:63], v[52:55], v[24:27], a[48:63]
    ds_read_b64_tr_b16 v[124:125], v9 offset:16384
    ds_read_b64_tr_b16 v[126:127], v9 offset:17408
    ds_read_b64_tr_b16 v[128:129], v10 offset:16384
    s_add_u32 m0, s75, 3072
    s_add_u32 s68, s69, 49152
    buffer_load_dwordx4 v2, s[52:55], s68 offen lds
    v_mfma_f32_32x32x16_bf16 a[0:15], v[56:59], v[28:31], a[0:15]
    ds_read_b64_tr_b16 v[130:131], v10 offset:17408
    ds_read_b64_tr_b16 v[132:133], v11 offset:16384
    ds_read_b64_tr_b16 v[134:135], v11 offset:17408
    s_add_u32 s69, s74, 12
    s_and_b32 s69, s69, 15
    s_lshl_b32 s69, s69, 19
    s_add_u32 s69, s69, s73
    s_add_u32 m0, s76, 0
    s_add_u32 s68, s69, 0
    buffer_load_dwordx4 v3, s[56:59], s68 offen lds
    v_mfma_f32_32x32x16_bf16 a[16:31], v[60:63], v[28:31], a[16:31]
    ds_read_b128 v[108:111], v5 offset:4096
    ds_read_b64_tr_b16 v[136:137], v8 offset:20480
    ds_read_b64_tr_b16 v[138:139], v8 offset:21504
    s_add_u32 m0, s76, 1024
    s_add_u32 s68, s69, 32768
    buffer_load_dwordx4 v3, s[56:59], s68 offen lds
    v_mfma_f32_32x32x16_bf16 a[32:47], v[64:67], v[28:31], a[32:47]
    ds_read_b64_tr_b16 v[140:141], v9 offset:20480
    ds_read_b64_tr_b16 v[142:143], v9 offset:21504
    ds_read_b64_tr_b16 v[144:145], v10 offset:20480
    s_add_u32 s69, s74, 12
    s_and_b32 s69, s69, 15
    s_lshl_b32 s69, s69, 19
    s_add_u32 s69, s69, s73
    s_add_u32 m0, s76, 8192
    s_add_u32 s68, s69, 262144
    buffer_load_dwordx4 v3, s[56:59], s68 offen lds
    v_mfma_f32_32x32x16_bf16 a[48:63], v[68:71], v[28:31], a[48:63]
    ds_read_b64_tr_b16 v[146:147], v10 offset:21504
    ds_read_b64_tr_b16 v[148:149], v11 offset:20480
    ds_read_b64_tr_b16 v[150:151], v11 offset:21504
    s_add_u32 m0, s76, 9216
    s_add_u32 s68, s69, 294912
    buffer_load_dwordx4 v3, s[56:59], s68 offen lds
    v_mfma_f32_32x32x16_bf16 a[0:15], v[72:75], v[32:35], a[0:15]
    ds_read_b128 v[112:115], v6 offset:4096
    ds_read_b64_tr_b16 v[152:153], v8 offset:24576
    ds_read_b64_tr_b16 v[154:155], v8 offset:25600
    v_mfma_f32_32x32x16_bf16 a[16:31], v[76:79], v[32:35], a[16:31]
    ds_read_b64_tr_b16 v[156:157], v9 offset:24576
    ds_read_b64_tr_b16 v[158:159], v9 offset:25600
    ds_read_b64_tr_b16 v[160:161], v10 offset:24576
    v_mfma_f32_32x32x16_bf16 a[32:47], v[80:83], v[32:35], a[32:47]
    ds_read_b64_tr_b16 v[162:163], v10 offset:25600
    ds_read_b64_tr_b16 v[164:165], v11 offset:24576
    ds_read_b64_tr_b16 v[166:167], v11 offset:25600
    v_mfma_f32_32x32x16_bf16 a[48:63], v[84:87], v[32:35], a[48:63]
    ds_read_b128 v[116:119], v7 offset:4096
    ds_read_b64_tr_b16 v[168:169], v8 offset:28672
    ds_read_b64_tr_b16 v[170:171], v8 offset:29696
    v_mfma_f32_32x32x16_bf16 a[0:15], v[88:91], v[36:39], a[0:15]
    ds_read_b64_tr_b16 v[172:173], v9 offset:28672
    ds_read_b64_tr_b16 v[174:175], v9 offset:29696
    ds_read_b64_tr_b16 v[176:177], v10 offset:28672
    v_mfma_f32_32x32x16_bf16 a[16:31], v[92:95], v[36:39], a[16:31]
    ds_read_b64_tr_b16 v[178:179], v10 offset:29696
    ds_read_b64_tr_b16 v[180:181], v11 offset:28672
    ds_read_b64_tr_b16 v[182:183], v11 offset:29696
    v_mfma_f32_32x32x16_bf16 a[32:47], v[96:99], v[36:39], a[32:47]
    v_mfma_f32_32x32x16_bf16 a[48:63], v[100:103], v[36:39], a[48:63]
    s_waitcnt lgkmcnt(0)
    v_mfma_f32_32x32x16_bf16 a[0:15], v[120:123], v[104:107], a[0:15]
    s_add_u32 s69, s74, 13
    s_and_b32 s69, s69, 15
    s_lshl_b32 s69, s69, 7
    s_add_u32 s69, s69, s72
    s_add_u32 m0, s75, 4096
    s_add_u32 s68, s69, 0
    buffer_load_dwordx4 v1, s[52:55], s68 offen lds
    v_mfma_f32_32x32x16_bf16 a[16:31], v[124:127], v[104:107], a[16:31]
    s_add_u32 m0, s75, 5120
    s_add_u32 s68, s69, 16384
    buffer_load_dwordx4 v2, s[52:55], s68 offen lds
    s_waitcnt vmcnt(18)
    s_barrier
    v_mfma_f32_32x32x16_bf16 a[32:47], v[128:131], v[104:107], a[32:47]
    ds_read_b128 v[24:27], v4 offset:8192
    ds_read_b64_tr_b16 v[40:41], v8 offset:32768
    ds_read_b64_tr_b16 v[42:43], v8 offset:33792
    s_add_u32 m0, s75, 6144
    s_add_u32 s68, s69, 32768
    buffer_load_dwordx4 v1, s[52:55], s68 offen lds
    v_mfma_f32_32x32x16_bf16 a[48:63], v[132:135], v[104:107], a[48:63]
    ds_read_b64_tr_b16 v[44:45], v9 offset:32768
    ds_read_b64_tr_b16 v[46:47], v9 offset:33792
    ds_read_b64_tr_b16 v[48:49], v10 offset:32768
    s_add_u32 m0, s75, 7168
    s_add_u32 s68, s69, 49152
    buffer_load_dwordx4 v2, s[52:55], s68 offen lds
    v_mfma_f32_32x32x16_bf16 a[0:15], v[136:139], v[108:111], a[0:15]
    ds_read_b64_tr_b16 v[50:51], v10 offset:33792
    ds_read_b64_tr_b16 v[52:53], v11 offset:32768
    ds_read_b64_tr_b16 v[54:55], v11 offset:33792
    s_add_u32 s69, s74, 13
    s_and_b32 s69, s69, 15
    s_lshl_b32 s69, s69, 19
    s_add_u32 s69, s69, s73
    s_add_u32 m0, s76, 16384
    s_add_u32 s68, s69, 0
    buffer_load_dwordx4 v3, s[56:59], s68 offen lds
    v_mfma_f32_32x32x16_bf16 a[16:31], v[140:143], v[108:111], a[16:31]
    ds_read_b128 v[28:31], v5 offset:8192
    ds_read_b64_tr_b16 v[56:57], v8 offset:36864
    ds_read_b64_tr_b16 v[58:59], v8 offset:37888
    s_add_u32 m0, s76, 17408
    s_add_u32 s68, s69, 32768
    buffer_load_dwordx4 v3, s[56:59], s68 offen lds
    v_mfma_f32_32x32x16_bf16 a[32:47], v[144:147], v[108:111], a[32:47]
    ds_read_b64_tr_b16 v[60:61], v9 offset:36864
    ds_read_b64_tr_b16 v[62:63], v9 offset:37888
    ds_read_b64_tr_b16 v[64:65], v10 offset:36864
    s_add_u32 s69, s74, 13
    s_and_b32 s69, s69, 15
    s_lshl_b32 s69, s69, 19
    s_add_u32 s69, s69, s73
    s_add_u32 m0, s76, 24576
    s_add_u32 s68, s69, 262144
    buffer_load_dwordx4 v3, s[56:59], s68 offen lds
    v_mfma_f32_32x32x16_bf16 a[48:63], v[148:151], v[108:111], a[48:63]
    ds_read_b64_tr_b16 v[66:67], v10 offset:37888
    ds_read_b64_tr_b16 v[68:69], v11 offset:36864
    ds_read_b64_tr_b16 v[70:71], v11 offset:37888
    s_add_u32 m0, s76, 25600
    s_add_u32 s68, s69, 294912
    buffer_load_dwordx4 v3, s[56:59], s68 offen lds
    v_mfma_f32_32x32x16_bf16 a[0:15], v[152:155], v[112:115], a[0:15]
    ds_read_b128 v[32:35], v6 offset:8192
    ds_read_b64_tr_b16 v[72:73], v8 offset:40960
    ds_read_b64_tr_b16 v[74:75], v8 offset:41984
    v_mfma_f32_32x32x16_bf16 a[16:31], v[156:159], v[112:115], a[16:31]
    ds_read_b64_tr_b16 v[76:77], v9 offset:40960
    ds_read_b64_tr_b16 v[78:79], v9 offset:41984
    ds_read_b64_tr_b16 v[80:81], v10 offset:40960
    v_mfma_f32_32x32x16_bf16 a[32:47], v[160:163], v[112:115], a[32:47]
    ds_read_b64_tr_b16 v[82:83], v10 offset:41984
    ds_read_b64_tr_b16 v[84:85], v11 offset:40960
    ds_read_b64_tr_b16 v[86:87], v11 offset:41984
    v_mfma_f32_32x32x16_bf16 a[48:63], v[164:167], v[112:115], a[48:63]
    ds_read_b128 v[36:39], v7 offset:8192
    ds_read_b64_tr_b16 v[88:89], v8 offset:45056
    ds_read_b64_tr_b16 v[90:91], v8 offset:46080
    v_mfma_f32_32x32x16_bf16 a[0:15], v[168:171], v[116:119], a[0:15]
    ds_read_b64_tr_b16 v[92:93], v9 offset:45056
    ds_read_b64_tr_b16 v[94:95], v9 offset:46080
    ds_read_b64_tr_b16 v[96:97], v10 offset:45056
    v_mfma_f32_32x32x16_bf16 a[16:31], v[172:175], v[116:119], a[16:31]
    ds_read_b64_tr_b16 v[98:99], v10 offset:46080
    ds_read_b64_tr_b16 v[100:101], v11 offset:45056
    ds_read_b64_tr_b16 v[102:103], v11 offset:46080
    v_mfma_f32_32x32x16_bf16 a[32:47], v[176:179], v[116:119], a[32:47]
    v_mfma_f32_32x32x16_bf16 a[48:63], v[180:183], v[116:119], a[48:63]
    s_waitcnt lgkmcnt(0)
    v_mfma_f32_32x32x16_bf16 a[0:15], v[40:43], v[24:27], a[0:15]
    s_add_u32 s69, s74, 14
    s_and_b32 s69, s69, 15
    s_lshl_b32 s69, s69, 7
    s_add_u32 s69, s69, s72
    s_add_u32 m0, s75, 8192
    s_add_u32 s68, s69, 0
    buffer_load_dwordx4 v1, s[52:55], s68 offen lds
    v_mfma_f32_32x32x16_bf16 a[16:31], v[44:47], v[24:27], a[16:31]
    s_add_u32 m0, s75, 9216
    s_add_u32 s68, s69, 16384
    buffer_load_dwordx4 v2, s[52:55], s68 offen lds
    s_waitcnt vmcnt(18)
    s_barrier
    v_mfma_f32_32x32x16_bf16 a[32:47], v[48:51], v[24:27], a[32:47]
    ds_read_b128 v[104:107], v4 offset:12288
    ds_read_b64_tr_b16 v[120:121], v8 offset:49152
    ds_read_b64_tr_b16 v[122:123], v8 offset:50176
    s_add_u32 m0, s75, 10240
    s_add_u32 s68, s69, 32768
    buffer_load_dwordx4 v1, s[52:55], s68 offen lds
    v_mfma_f32_32x32x16_bf16 a[48:63], v[52:55], v[24:27], a[48:63]
    ds_read_b64_tr_b16 v[124:125], v9 offset:49152
    ds_read_b64_tr_b16 v[126:127], v9 offset:50176
    ds_read_b64_tr_b16 v[128:129], v10 offset:49152
    s_add_u32 m0, s75, 11264
    s_add_u32 s68, s69, 49152
    buffer_load_dwordx4 v2, s[52:55], s68 offen lds
    v_mfma_f32_32x32x16_bf16 a[0:15], v[56:59], v[28:31], a[0:15]
    ds_read_b64_tr_b16 v[130:131], v10 offset:50176
    ds_read_b64_tr_b16 v[132:133], v11 offset:49152
    ds_read_b64_tr_b16 v[134:135], v11 offset:50176
    s_add_u32 s69, s74, 14
    s_and_b32 s69, s69, 15
    s_lshl_b32 s69, s69, 19
    s_add_u32 s69, s69, s73
    s_add_u32 m0, s76, 32768
    s_add_u32 s68, s69, 0
    buffer_load_dwordx4 v3, s[56:59], s68 offen lds
    v_mfma_f32_32x32x16_bf16 a[16:31], v[60:63], v[28:31], a[16:31]
    ds_read_b128 v[108:111], v5 offset:12288
    ds_read_b64_tr_b16 v[136:137], v8 offset:53248
    ds_read_b64_tr_b16 v[138:139], v8 offset:54272
    s_add_u32 m0, s76, 33792
    s_add_u32 s68, s69, 32768
    buffer_load_dwordx4 v3, s[56:59], s68 offen lds
    v_mfma_f32_32x32x16_bf16 a[32:47], v[64:67], v[28:31], a[32:47]
    ds_read_b64_tr_b16 v[140:141], v9 offset:53248
    ds_read_b64_tr_b16 v[142:143], v9 offset:54272
    ds_read_b64_tr_b16 v[144:145], v10 offset:53248
    s_add_u32 s69, s74, 14
    s_and_b32 s69, s69, 15
    s_lshl_b32 s69, s69, 19
    s_add_u32 s69, s69, s73
    s_add_u32 m0, s76, 40960
    s_add_u32 s68, s69, 262144
    buffer_load_dwordx4 v3, s[56:59], s68 offen lds
    v_mfma_f32_32x32x16_bf16 a[48:63], v[68:71], v[28:31], a[48:63]
    ds_read_b64_tr_b16 v[146:147], v10 offset:54272
    ds_read_b64_tr_b16 v[148:149], v11 offset:53248
    ds_read_b64_tr_b16 v[150:151], v11 offset:54272
    s_add_u32 m0, s76, 41984
    s_add_u32 s68, s69, 294912
    buffer_load_dwordx4 v3, s[56:59], s68 offen lds
    v_mfma_f32_32x32x16_bf16 a[0:15], v[72:75], v[32:35], a[0:15]
    ds_read_b128 v[112:115], v6 offset:12288
    ds_read_b64_tr_b16 v[152:153], v8 offset:57344
    ds_read_b64_tr_b16 v[154:155], v8 offset:58368
    v_mfma_f32_32x32x16_bf16 a[16:31], v[76:79], v[32:35], a[16:31]
    ds_read_b64_tr_b16 v[156:157], v9 offset:57344
    ds_read_b64_tr_b16 v[158:159], v9 offset:58368
    ds_read_b64_tr_b16 v[160:161], v10 offset:57344
    v_mfma_f32_32x32x16_bf16 a[32:47], v[80:83], v[32:35], a[32:47]
    ds_read_b64_tr_b16 v[162:163], v10 offset:58368
    ds_read_b64_tr_b16 v[164:165], v11 offset:57344
    ds_read_b64_tr_b16 v[166:167], v11 offset:58368
    v_mfma_f32_32x32x16_bf16 a[48:63], v[84:87], v[32:35], a[48:63]
    ds_read_b128 v[116:119], v7 offset:12288
    ds_read_b64_tr_b16 v[168:169], v8 offset:61440
    ds_read_b64_tr_b16 v[170:171], v8 offset:62464
    v_mfma_f32_32x32x16_bf16 a[0:15], v[88:91], v[36:39], a[0:15]
    ds_read_b64_tr_b16 v[172:173], v9 offset:61440
    ds_read_b64_tr_b16 v[174:175], v9 offset:62464
    ds_read_b64_tr_b16 v[176:177], v10 offset:61440
    v_mfma_f32_32x32x16_bf16 a[16:31], v[92:95], v[36:39], a[16:31]
    ds_read_b64_tr_b16 v[178:179], v10 offset:62464
    ds_read_b64_tr_b16 v[180:181], v11 offset:61440
    ds_read_b64_tr_b16 v[182:183], v11 offset:62464
    v_mfma_f32_32x32x16_bf16 a[32:47], v[96:99], v[36:39], a[32:47]
    v_mfma_f32_32x32x16_bf16 a[48:63], v[100:103], v[36:39], a[48:63]
    s_waitcnt lgkmcnt(0)
    v_mfma_f32_32x32x16_bf16 a[0:15], v[120:123], v[104:107], a[0:15]
    s_add_u32 s69, s74, 15
    s_and_b32 s69, s69, 15
    s_lshl_b32 s69, s69, 7
    s_add_u32 s69, s69, s72
    s_add_u32 m0, s75, 12288
    s_add_u32 s68, s69, 0
    buffer_load_dwordx4 v1, s[52:55], s68 offen lds
    v_mfma_f32_32x32x16_bf16 a[16:31], v[124:127], v[104:107], a[16:31]
    s_add_u32 m0, s75, 13312
    s_add_u32 s68, s69, 16384
    buffer_load_dwordx4 v2, s[52:55], s68 offen lds
    s_waitcnt vmcnt(18)
    s_barrier
    v_mfma_f32_32x32x16_bf16 a[32:47], v[128:131], v[104:107], a[32:47]
    ds_read_b128 v[24:27], v4 offset:0
    ds_read_b64_tr_b16 v[40:41], v8 offset:0
    ds_read_b64_tr_b16 v[42:43], v8 offset:1024
    s_add_u32 m0, s75, 14336
    s_add_u32 s68, s69, 32768
    buffer_load_dwordx4 v1, s[52:55], s68 offen lds
    v_mfma_f32_32x32x16_bf16 a[48:63], v[132:135], v[104:107], a[48:63]
    ds_read_b64_tr_b16 v[44:45], v9 offset:0
    ds_read_b64_tr_b16 v[46:47], v9 offset:1024
    ds_read_b64_tr_b16 v[48:49], v10 offset:0
    s_add_u32 m0, s75, 15360
    s_add_u32 s68, s69, 49152
    buffer_load_dwordx4 v2, s[52:55], s68 offen lds
    v_mfma_f32_32x32x16_bf16 a[0:15], v[136:139], v[108:111], a[0:15]
    ds_read_b64_tr_b16 v[50:51], v10 offset:1024
    ds_read_b64_tr_b16 v[52:53], v11 offset:0
    ds_read_b64_tr_b16 v[54:55], v11 offset:1024
    s_add_u32 s69, s74, 15
    s_and_b32 s69, s69, 15
    s_lshl_b32 s69, s69, 19
    s_add_u32 s69, s69, s73
    s_add_u32 m0, s76, 49152
    s_add_u32 s68, s69, 0
    buffer_load_dwordx4 v3, s[56:59], s68 offen lds
    v_mfma_f32_32x32x16_bf16 a[16:31], v[140:143], v[108:111], a[16:31]
    ds_read_b128 v[28:31], v5 offset:0
    ds_read_b64_tr_b16 v[56:57], v8 offset:4096
    ds_read_b64_tr_b16 v[58:59], v8 offset:5120
    s_add_u32 m0, s76, 50176
    s_add_u32 s68, s69, 32768
    buffer_load_dwordx4 v3, s[56:59], s68 offen lds
    v_mfma_f32_32x32x16_bf16 a[32:47], v[144:147], v[108:111], a[32:47]
    ds_read_b64_tr_b16 v[60:61], v9 offset:4096
    ds_read_b64_tr_b16 v[62:63], v9 offset:5120
    ds_read_b64_tr_b16 v[64:65], v10 offset:4096
    s_add_u32 s69, s74, 15
    s_and_b32 s69, s69, 15
    s_lshl_b32 s69, s69, 19
    s_add_u32 s69, s69, s73
    s_add_u32 m0, s76, 57344
    s_add_u32 s68, s69, 262144
    buffer_load_dwordx4 v3, s[56:59], s68 offen lds
    v_mfma_f32_32x32x16_bf16 a[48:63], v[148:151], v[108:111], a[48:63]
    ds_read_b64_tr_b16 v[66:67], v10 offset:5120
    ds_read_b64_tr_b16 v[68:69], v11 offset:4096
    ds_read_b64_tr_b16 v[70:71], v11 offset:5120
    s_add_u32 m0, s76, 58368
    s_add_u32 s68, s69, 294912
    buffer_load_dwordx4 v3, s[56:59], s68 offen lds
    v_mfma_f32_32x32x16_bf16 a[0:15], v[152:155], v[112:115], a[0:15]
    ds_read_b128 v[32:35], v6 offset:0
    ds_read_b64_tr_b16 v[72:73], v8 offset:8192
    ds_read_b64_tr_b16 v[74:75], v8 offset:9216
    v_mfma_f32_32x32x16_bf16 a[16:31], v[156:159], v[112:115], a[16:31]
    ds_read_b64_tr_b16 v[76:77], v9 offset:8192
    ds_read_b64_tr_b16 v[78:79], v9 offset:9216
    ds_read_b64_tr_b16 v[80:81], v10 offset:8192
    v_mfma_f32_32x32x16_bf16 a[32:47], v[160:163], v[112:115], a[32:47]
    ds_read_b64_tr_b16 v[82:83], v10 offset:9216
    ds_read_b64_tr_b16 v[84:85], v11 offset:8192
    ds_read_b64_tr_b16 v[86:87], v11 offset:9216
    v_mfma_f32_32x32x16_bf16 a[48:63], v[164:167], v[112:115], a[48:63]
    ds_read_b128 v[36:39], v7 offset:0
    ds_read_b64_tr_b16 v[88:89], v8 offset:12288
    ds_read_b64_tr_b16 v[90:91], v8 offset:13312
    v_mfma_f32_32x32x16_bf16 a[0:15], v[168:171], v[116:119], a[0:15]
    ds_read_b64_tr_b16 v[92:93], v9 offset:12288
    ds_read_b64_tr_b16 v[94:95], v9 offset:13312
    ds_read_b64_tr_b16 v[96:97], v10 offset:12288
    v_mfma_f32_32x32x16_bf16 a[16:31], v[172:175], v[116:119], a[16:31]
    ds_read_b64_tr_b16 v[98:99], v10 offset:13312
    ds_read_b64_tr_b16 v[100:101], v11 offset:12288
    ds_read_b64_tr_b16 v[102:103], v11 offset:13312
    v_mfma_f32_32x32x16_bf16 a[32:47], v[176:179], v[116:119], a[32:47]
    v_mfma_f32_32x32x16_bf16 a[48:63], v[180:183], v[116:119], a[48:63]
    s_waitcnt lgkmcnt(0)
    v_mfma_f32_32x32x16_bf16 a[0:15], v[40:43], v[24:27], a[0:15]
    s_add_u32 s69, s74, 0
    s_and_b32 s69, s69, 15
    s_lshl_b32 s69, s69, 7
    s_add_u32 s69, s69, s72
    s_add_u32 m0, s75, 0
    s_add_u32 s68, s69, 0
    buffer_load_dwordx4 v1, s[60:63], s68 offen lds
    v_mfma_f32_32x32x16_bf16 a[16:31], v[44:47], v[24:27], a[16:31]
    s_add_u32 m0, s75, 1024
    s_add_u32 s68, s69, 16384
    buffer_load_dwordx4 v2, s[60:63], s68 offen lds
    s_waitcnt vmcnt(18)
    s_barrier
    v_mov_b32 v16, 0
    buffer_load_dword v13, v16, s[48:51], 0 offen sc1

    v_mfma_f32_32x32x16_bf16 a[32:47], v[48:51], v[24:27], a[32:47]
    ds_read_b128 v[104:107], v4 offset:4096
    ds_read_b64_tr_b16 v[120:121], v8 offset:16384
    ds_read_b64_tr_b16 v[122:123], v8 offset:17408
    s_add_u32 m0, s75, 2048
    s_add_u32 s68, s69, 32768
    buffer_load_dwordx4 v1, s[60:63], s68 offen lds
    v_mfma_f32_32x32x16_bf16 a[48:63], v[52:55], v[24:27], a[48:63]
    ds_read_b64_tr_b16 v[124:125], v9 offset:16384
    ds_read_b64_tr_b16 v[126:127], v9 offset:17408
    ds_read_b64_tr_b16 v[128:129], v10 offset:16384
    s_add_u32 m0, s75, 3072
    s_add_u32 s68, s69, 49152
    buffer_load_dwordx4 v2, s[60:63], s68 offen lds
    v_mfma_f32_32x32x16_bf16 a[0:15], v[56:59], v[28:31], a[0:15]
    ds_read_b64_tr_b16 v[130:131], v10 offset:17408
    ds_read_b64_tr_b16 v[132:133], v11 offset:16384
    ds_read_b64_tr_b16 v[134:135], v11 offset:17408
    s_add_u32 s69, s74, 0
    s_and_b32 s69, s69, 15
    s_lshl_b32 s69, s69, 19
    s_add_u32 s69, s69, s73
    s_add_u32 m0, s76, 0
    s_add_u32 s68, s69, 0
    buffer_load_dwordx4 v3, s[64:67], s68 offen lds
    v_mfma_f32_32x32x16_bf16 a[16:31], v[60:63], v[28:31], a[16:31]
    ds_read_b128 v[108:111], v5 offset:4096
    ds_read_b64_tr_b16 v[136:137], v8 offset:20480
    ds_read_b64_tr_b16 v[138:139], v8 offset:21504
    s_add_u32 m0, s76, 1024
    s_add_u32 s68, s69, 32768
    buffer_load_dwordx4 v3, s[64:67], s68 offen lds
    v_mfma_f32_32x32x16_bf16 a[32:47], v[64:67], v[28:31], a[32:47]
    ds_read_b64_tr_b16 v[140:141], v9 offset:20480
    ds_read_b64_tr_b16 v[142:143], v9 offset:21504
    ds_read_b64_tr_b16 v[144:145], v10 offset:20480
    s_add_u32 s69, s74, 0
    s_and_b32 s69, s69, 15
    s_lshl_b32 s69, s69, 19
    s_add_u32 s69, s69, s73
    s_add_u32 m0, s76, 8192
    s_add_u32 s68, s69, 262144
    buffer_load_dwordx4 v3, s[64:67], s68 offen lds
    v_mfma_f32_32x32x16_bf16 a[48:63], v[68:71], v[28:31], a[48:63]
    ds_read_b64_tr_b16 v[146:147], v10 offset:21504
    ds_read_b64_tr_b16 v[148:149], v11 offset:20480
    ds_read_b64_tr_b16 v[150:151], v11 offset:21504
    s_add_u32 m0, s76, 9216
    s_add_u32 s68, s69, 294912
    buffer_load_dwordx4 v3, s[64:67], s68 offen lds
    v_mfma_f32_32x32x16_bf16 a[0:15], v[72:75], v[32:35], a[0:15]
    ds_read_b128 v[112:115], v6 offset:4096
    ds_read_b64_tr_b16 v[152:153], v8 offset:24576
    ds_read_b64_tr_b16 v[154:155], v8 offset:25600
    v_mfma_f32_32x32x16_bf16 a[16:31], v[76:79], v[32:35], a[16:31]
    ds_read_b64_tr_b16 v[156:157], v9 offset:24576
    ds_read_b64_tr_b16 v[158:159], v9 offset:25600
    ds_read_b64_tr_b16 v[160:161], v10 offset:24576
    v_mfma_f32_32x32x16_bf16 a[32:47], v[80:83], v[32:35], a[32:47]
    ds_read_b64_tr_b16 v[162:163], v10 offset:25600
    ds_read_b64_tr_b16 v[164:165], v11 offset:24576
    ds_read_b64_tr_b16 v[166:167], v11 offset:25600
    v_mfma_f32_32x32x16_bf16 a[48:63], v[84:87], v[32:35], a[48:63]
    ds_read_b128 v[116:119], v7 offset:4096
    ds_read_b64_tr_b16 v[168:169], v8 offset:28672
    ds_read_b64_tr_b16 v[170:171], v8 offset:29696
    v_mfma_f32_32x32x16_bf16 a[0:15], v[88:91], v[36:39], a[0:15]
    ds_read_b64_tr_b16 v[172:173], v9 offset:28672
    ds_read_b64_tr_b16 v[174:175], v9 offset:29696
    ds_read_b64_tr_b16 v[176:177], v10 offset:28672
    v_mfma_f32_32x32x16_bf16 a[16:31], v[92:95], v[36:39], a[16:31]
    ds_read_b64_tr_b16 v[178:179], v10 offset:29696
    ds_read_b64_tr_b16 v[180:181], v11 offset:28672
    ds_read_b64_tr_b16 v[182:183], v11 offset:29696
    v_mfma_f32_32x32x16_bf16 a[32:47], v[96:99], v[36:39], a[32:47]
    v_mfma_f32_32x32x16_bf16 a[48:63], v[100:103], v[36:39], a[48:63]
    s_waitcnt lgkmcnt(0)
    v_mfma_f32_32x32x16_bf16 a[0:15], v[120:123], v[104:107], a[0:15]
    s_add_u32 s69, s74, 1
    s_and_b32 s69, s69, 15
    s_lshl_b32 s69, s69, 7
    s_add_u32 s69, s69, s72
    s_add_u32 m0, s75, 4096
    s_add_u32 s68, s69, 0
    buffer_load_dwordx4 v1, s[60:63], s68 offen lds
    v_mfma_f32_32x32x16_bf16 a[16:31], v[124:127], v[104:107], a[16:31]
    s_add_u32 m0, s75, 5120
    s_add_u32 s68, s69, 16384
    buffer_load_dwordx4 v2, s[60:63], s68 offen lds
    s_waitcnt vmcnt(19)
    s_barrier
    v_mfma_f32_32x32x16_bf16 a[32:47], v[128:131], v[104:107], a[32:47]
    ds_read_b128 v[24:27], v4 offset:8192
    ds_read_b64_tr_b16 v[40:41], v8 offset:32768
    ds_read_b64_tr_b16 v[42:43], v8 offset:33792
    s_add_u32 m0, s75, 6144
    s_add_u32 s68, s69, 32768
    buffer_load_dwordx4 v1, s[60:63], s68 offen lds
    v_mfma_f32_32x32x16_bf16 a[48:63], v[132:135], v[104:107], a[48:63]
    ds_read_b64_tr_b16 v[44:45], v9 offset:32768
    ds_read_b64_tr_b16 v[46:47], v9 offset:33792
    ds_read_b64_tr_b16 v[48:49], v10 offset:32768
    s_add_u32 m0, s75, 7168
    s_add_u32 s68, s69, 49152
    buffer_load_dwordx4 v2, s[60:63], s68 offen lds
    v_mfma_f32_32x32x16_bf16 a[0:15], v[136:139], v[108:111], a[0:15]
    ds_read_b64_tr_b16 v[50:51], v10 offset:33792
    ds_read_b64_tr_b16 v[52:53], v11 offset:32768
    ds_read_b64_tr_b16 v[54:55], v11 offset:33792
    s_add_u32 s69, s74, 1
    s_and_b32 s69, s69, 15
    s_lshl_b32 s69, s69, 19
    s_add_u32 s69, s69, s73
    s_add_u32 m0, s76, 16384
    s_add_u32 s68, s69, 0
    buffer_load_dwordx4 v3, s[64:67], s68 offen lds
    v_mfma_f32_32x32x16_bf16 a[16:31], v[140:143], v[108:111], a[16:31]
    ds_read_b128 v[28:31], v5 offset:8192
    ds_read_b64_tr_b16 v[56:57], v8 offset:36864
    ds_read_b64_tr_b16 v[58:59], v8 offset:37888
    s_add_u32 m0, s76, 17408
    s_add_u32 s68, s69, 32768
    buffer_load_dwordx4 v3, s[64:67], s68 offen lds
    v_mfma_f32_32x32x16_bf16 a[32:47], v[144:147], v[108:111], a[32:47]
    ds_read_b64_tr_b16 v[60:61], v9 offset:36864
    ds_read_b64_tr_b16 v[62:63], v9 offset:37888
    ds_read_b64_tr_b16 v[64:65], v10 offset:36864
    s_add_u32 s69, s74, 1
    s_and_b32 s69, s69, 15
    s_lshl_b32 s69, s69, 19
    s_add_u32 s69, s69, s73
    s_add_u32 m0, s76, 24576
    s_add_u32 s68, s69, 262144
    buffer_load_dwordx4 v3, s[64:67], s68 offen lds
    v_mfma_f32_32x32x16_bf16 a[48:63], v[148:151], v[108:111], a[48:63]
    ds_read_b64_tr_b16 v[66:67], v10 offset:37888
    ds_read_b64_tr_b16 v[68:69], v11 offset:36864
    ds_read_b64_tr_b16 v[70:71], v11 offset:37888
    s_add_u32 m0, s76, 25600
    s_add_u32 s68, s69, 294912
    buffer_load_dwordx4 v3, s[64:67], s68 offen lds
    v_mfma_f32_32x32x16_bf16 a[0:15], v[152:155], v[112:115], a[0:15]
    ds_read_b128 v[32:35], v6 offset:8192
    ds_read_b64_tr_b16 v[72:73], v8 offset:40960
    ds_read_b64_tr_b16 v[74:75], v8 offset:41984
    v_mfma_f32_32x32x16_bf16 a[16:31], v[156:159], v[112:115], a[16:31]
    ds_read_b64_tr_b16 v[76:77], v9 offset:40960
    ds_read_b64_tr_b16 v[78:79], v9 offset:41984
    ds_read_b64_tr_b16 v[80:81], v10 offset:40960
    v_mfma_f32_32x32x16_bf16 a[32:47], v[160:163], v[112:115], a[32:47]
    ds_read_b64_tr_b16 v[82:83], v10 offset:41984
    ds_read_b64_tr_b16 v[84:85], v11 offset:40960
    ds_read_b64_tr_b16 v[86:87], v11 offset:41984
    v_mfma_f32_32x32x16_bf16 a[48:63], v[164:167], v[112:115], a[48:63]
    ds_read_b128 v[36:39], v7 offset:8192
    ds_read_b64_tr_b16 v[88:89], v8 offset:45056
    ds_read_b64_tr_b16 v[90:91], v8 offset:46080
    v_mfma_f32_32x32x16_bf16 a[0:15], v[168:171], v[116:119], a[0:15]
    ds_read_b64_tr_b16 v[92:93], v9 offset:45056
    ds_read_b64_tr_b16 v[94:95], v9 offset:46080
    ds_read_b64_tr_b16 v[96:97], v10 offset:45056
    v_mfma_f32_32x32x16_bf16 a[16:31], v[172:175], v[116:119], a[16:31]
    ds_read_b64_tr_b16 v[98:99], v10 offset:46080
    ds_read_b64_tr_b16 v[100:101], v11 offset:45056
    ds_read_b64_tr_b16 v[102:103], v11 offset:46080
    v_mfma_f32_32x32x16_bf16 a[32:47], v[176:179], v[116:119], a[32:47]
    v_mfma_f32_32x32x16_bf16 a[48:63], v[180:183], v[116:119], a[48:63]
    s_waitcnt lgkmcnt(0)
    v_mfma_f32_32x32x16_bf16 a[0:15], v[40:43], v[24:27], a[0:15]
    s_add_u32 s69, s74, 2
    s_and_b32 s69, s69, 15
    s_lshl_b32 s69, s69, 7
    s_add_u32 s69, s69, s72
    s_add_u32 m0, s75, 8192
    s_add_u32 s68, s69, 0
    buffer_load_dwordx4 v1, s[60:63], s68 offen lds
    v_mfma_f32_32x32x16_bf16 a[16:31], v[44:47], v[24:27], a[16:31]
    s_add_u32 m0, s75, 9216
    s_add_u32 s68, s69, 16384
    buffer_load_dwordx4 v2, s[60:63], s68 offen lds
    s_waitcnt vmcnt(19)
    s_barrier
    v_mfma_f32_32x32x16_bf16 a[32:47], v[48:51], v[24:27], a[32:47]
    ds_read_b128 v[104:107], v4 offset:12288
    ds_read_b64_tr_b16 v[120:121], v8 offset:49152
    ds_read_b64_tr_b16 v[122:123], v8 offset:50176
    s_add_u32 m0, s75, 10240
    s_add_u32 s68, s69, 32768
    buffer_load_dwordx4 v1, s[60:63], s68 offen lds
    v_mfma_f32_32x32x16_bf16 a[48:63], v[52:55], v[24:27], a[48:63]
    ds_read_b64_tr_b16 v[124:125], v9 offset:49152
    ds_read_b64_tr_b16 v[126:127], v9 offset:50176
    ds_read_b64_tr_b16 v[128:129], v10 offset:49152
    s_add_u32 m0, s75, 11264
    s_add_u32 s68, s69, 49152
    buffer_load_dwordx4 v2, s[60:63], s68 offen lds
    v_mfma_f32_32x32x16_bf16 a[0:15], v[56:59], v[28:31], a[0:15]
    ds_read_b64_tr_b16 v[130:131], v10 offset:50176
    ds_read_b64_tr_b16 v[132:133], v11 offset:49152
    ds_read_b64_tr_b16 v[134:135], v11 offset:50176
    s_add_u32 s69, s74, 2
    s_and_b32 s69, s69, 15
    s_lshl_b32 s69, s69, 19
    s_add_u32 s69, s69, s73
    s_add_u32 m0, s76, 32768
    s_add_u32 s68, s69, 0
    buffer_load_dwordx4 v3, s[64:67], s68 offen lds
    v_mfma_f32_32x32x16_bf16 a[16:31], v[60:63], v[28:31], a[16:31]
    ds_read_b128 v[108:111], v5 offset:12288
    ds_read_b64_tr_b16 v[136:137], v8 offset:53248
    ds_read_b64_tr_b16 v[138:139], v8 offset:54272
    s_add_u32 m0, s76, 33792
    s_add_u32 s68, s69, 32768
    buffer_load_dwordx4 v3, s[64:67], s68 offen lds
    v_mfma_f32_32x32x16_bf16 a[32:47], v[64:67], v[28:31], a[32:47]
    ds_read_b64_tr_b16 v[140:141], v9 offset:53248
    ds_read_b64_tr_b16 v[142:143], v9 offset:54272
    ds_read_b64_tr_b16 v[144:145], v10 offset:53248
    s_add_u32 s69, s74, 2
    s_and_b32 s69, s69, 15
    s_lshl_b32 s69, s69, 19
    s_add_u32 s69, s69, s73
    s_add_u32 m0, s76, 40960
    s_add_u32 s68, s69, 262144
    buffer_load_dwordx4 v3, s[64:67], s68 offen lds
    v_mfma_f32_32x32x16_bf16 a[48:63], v[68:71], v[28:31], a[48:63]
    ds_read_b64_tr_b16 v[146:147], v10 offset:54272
    ds_read_b64_tr_b16 v[148:149], v11 offset:53248
    ds_read_b64_tr_b16 v[150:151], v11 offset:54272
    s_add_u32 m0, s76, 41984
    s_add_u32 s68, s69, 294912
    buffer_load_dwordx4 v3, s[64:67], s68 offen lds
    v_mfma_f32_32x32x16_bf16 a[0:15], v[72:75], v[32:35], a[0:15]
    ds_read_b128 v[112:115], v6 offset:12288
    ds_read_b64_tr_b16 v[152:153], v8 offset:57344
    ds_read_b64_tr_b16 v[154:155], v8 offset:58368
    v_mfma_f32_32x32x16_bf16 a[16:31], v[76:79], v[32:35], a[16:31]
    ds_read_b64_tr_b16 v[156:157], v9 offset:57344
    ds_read_b64_tr_b16 v[158:159], v9 offset:58368
    ds_read_b64_tr_b16 v[160:161], v10 offset:57344
    v_mfma_f32_32x32x16_bf16 a[32:47], v[80:83], v[32:35], a[32:47]
    ds_read_b64_tr_b16 v[162:163], v10 offset:58368
    ds_read_b64_tr_b16 v[164:165], v11 offset:57344
    ds_read_b64_tr_b16 v[166:167], v11 offset:58368
    v_mfma_f32_32x32x16_bf16 a[48:63], v[84:87], v[32:35], a[48:63]
    ds_read_b128 v[116:119], v7 offset:12288
    ds_read_b64_tr_b16 v[168:169], v8 offset:61440
    ds_read_b64_tr_b16 v[170:171], v8 offset:62464
    v_mfma_f32_32x32x16_bf16 a[0:15], v[88:91], v[36:39], a[0:15]
    ds_read_b64_tr_b16 v[172:173], v9 offset:61440
    ds_read_b64_tr_b16 v[174:175], v9 offset:62464
    ds_read_b64_tr_b16 v[176:177], v10 offset:61440
    v_mfma_f32_32x32x16_bf16 a[16:31], v[92:95], v[36:39], a[16:31]
    ds_read_b64_tr_b16 v[178:179], v10 offset:62464
    ds_read_b64_tr_b16 v[180:181], v11 offset:61440
    ds_read_b64_tr_b16 v[182:183], v11 offset:62464
    v_mfma_f32_32x32x16_bf16 a[32:47], v[96:99], v[36:39], a[32:47]
    v_mfma_f32_32x32x16_bf16 a[48:63], v[100:103], v[36:39], a[48:63]
    s_waitcnt lgkmcnt(0)
    v_mfma_f32_32x32x16_bf16 a[0:15], v[120:123], v[104:107], a[0:15]
    s_add_u32 s69, s74, 3
    s_and_b32 s69, s69, 15
    s_lshl_b32 s69, s69, 7
    s_add_u32 s69, s69, s72
    s_add_u32 m0, s75, 12288
    s_add_u32 s68, s69, 0
    buffer_load_dwordx4 v1, s[60:63], s68 offen lds
    v_mfma_f32_32x32x16_bf16 a[16:31], v[124:127], v[104:107], a[16:31]
    s_add_u32 m0, s75, 13312
    s_add_u32 s68, s69, 16384
    buffer_load_dwordx4 v2, s[60:63], s68 offen lds
    v_mfma_f32_32x32x16_bf16 a[32:47], v[128:131], v[104:107], a[32:47]
    s_add_u32 m0, s75, 14336
    s_add_u32 s68, s69, 32768
    buffer_load_dwordx4 v1, s[60:63], s68 offen lds
    v_mfma_f32_32x32x16_bf16 a[48:63], v[132:135], v[104:107], a[48:63]
    s_add_u32 m0, s75, 15360
    s_add_u32 s68, s69, 49152
    buffer_load_dwordx4 v2, s[60:63], s68 offen lds
    v_mfma_f32_32x32x16_bf16 a[0:15], v[136:139], v[108:111], a[0:15]
    v_mfma_f32_32x32x16_bf16 a[16:31], v[140:143], v[108:111], a[16:31]
    v_mfma_f32_32x32x16_bf16 a[32:47], v[144:147], v[108:111], a[32:47]
    v_mfma_f32_32x32x16_bf16 a[48:63], v[148:151], v[108:111], a[48:63]
    v_mfma_f32_32x32x16_bf16 a[0:15], v[152:155], v[112:115], a[0:15]
    v_mfma_f32_32x32x16_bf16 a[16:31], v[156:159], v[112:115], a[16:31]
    v_mfma_f32_32x32x16_bf16 a[32:47], v[160:163], v[112:115], a[32:47]
    v_mfma_f32_32x32x16_bf16 a[48:63], v[164:167], v[112:115], a[48:63]
    v_mfma_f32_32x32x16_bf16 a[0:15], v[168:171], v[116:119], a[0:15]
    v_mfma_f32_32x32x16_bf16 a[16:31], v[172:175], v[116:119], a[16:31]
    v_mfma_f32_32x32x16_bf16 a[32:47], v[176:179], v[116:119], a[32:47]
    v_mfma_f32_32x32x16_bf16 a[48:63], v[180:183], v[116:119], a[48:63]
    s_nop 15
    v_accvgpr_read_b32 v16, a0
    v_accvgpr_read_b32 v17, a1
    v_accvgpr_read_b32 v18, a2
    v_accvgpr_read_b32 v19, a3
    v_cvt_pk_bf16_f32 v192, v16, v17
    v_cvt_pk_bf16_f32 v193, v18, v19
    v_accvgpr_read_b32 v16, a4
    v_accvgpr_read_b32 v17, a5
    v_accvgpr_read_b32 v18, a6
    v_accvgpr_read_b32 v19, a7
    v_cvt_pk_bf16_f32 v194, v16, v17
    v_cvt_pk_bf16_f32 v195, v18, v19
    v_accvgpr_read_b32 v16, a8
    v_accvgpr_read_b32 v17, a9
    v_accvgpr_read_b32 v18, a10
    v_accvgpr_read_b32 v19, a11
    v_cvt_pk_bf16_f32 v196, v16, v17
    v_cvt_pk_bf16_f32 v197, v18, v19
    v_accvgpr_read_b32 v16, a12
    v_accvgpr_read_b32 v17, a13
    v_accvgpr_read_b32 v18, a14
    v_accvgpr_read_b32 v19, a15
    v_cvt_pk_bf16_f32 v198, v16, v17
    v_cvt_pk_bf16_f32 v199, v18, v19
    v_accvgpr_read_b32 v16, a16
    v_accvgpr_read_b32 v17, a17
    v_accvgpr_read_b32 v18, a18
    v_accvgpr_read_b32 v19, a19
    v_cvt_pk_bf16_f32 v200, v16, v17
    v_cvt_pk_bf16_f32 v201, v18, v19
    v_accvgpr_read_b32 v16, a20
    v_accvgpr_read_b32 v17, a21
    v_accvgpr_read_b32 v18, a22
    v_accvgpr_read_b32 v19, a23
    v_cvt_pk_bf16_f32 v202, v16, v17
    v_cvt_pk_bf16_f32 v203, v18, v19
    v_accvgpr_read_b32 v16, a24
    v_accvgpr_read_b32 v17, a25
    v_accvgpr_read_b32 v18, a26
    v_accvgpr_read_b32 v19, a27
    v_cvt_pk_bf16_f32 v204, v16, v17
    v_cvt_pk_bf16_f32 v205, v18, v19
    v_accvgpr_read_b32 v16, a28
    v_accvgpr_read_b32 v17, a29
    v_accvgpr_read_b32 v18, a30
    v_accvgpr_read_b32 v19, a31
    v_cvt_pk_bf16_f32 v206, v16, v17
    v_cvt_pk_bf16_f32 v207, v18, v19
    v_accvgpr_read_b32 v16, a32
    v_accvgpr_read_b32 v17, a33
    v_accvgpr_read_b32 v18, a34
    v_accvgpr_read_b32 v19, a35
    v_cvt_pk_bf16_f32 v208, v16, v17
    v_cvt_pk_bf16_f32 v209, v18, v19
    v_accvgpr_read_b32 v16, a36
    v_accvgpr_read_b32 v17, a37
    v_accvgpr_read_b32 v18, a38
    v_accvgpr_read_b32 v19, a39
    v_cvt_pk_bf16_f32 v210, v16, v17
    v_cvt_pk_bf16_f32 v211, v18, v19
    v_accvgpr_read_b32 v16, a40
    v_accvgpr_read_b32 v17, a41
    v_accvgpr_read_b32 v18, a42
    v_accvgpr_read_b32 v19, a43
    v_cvt_pk_bf16_f32 v212, v16, v17
    v_cvt_pk_bf16_f32 v213, v18, v19
    v_accvgpr_read_b32 v16, a44
    v_accvgpr_read_b32 v17, a45
    v_accvgpr_read_b32 v18, a46
    v_accvgpr_read_b32 v19, a47
    v_cvt_pk_bf16_f32 v214, v16, v17
    v_cvt_pk_bf16_f32 v215, v18, v19
    v_accvgpr_read_b32 v16, a48
    v_accvgpr_read_b32 v17, a49
    v_accvgpr_read_b32 v18, a50
    v_accvgpr_read_b32 v19, a51
    v_cvt_pk_bf16_f32 v216, v16, v17
    v_cvt_pk_bf16_f32 v217, v18, v19
    v_accvgpr_read_b32 v16, a52
    v_accvgpr_read_b32 v17, a53
    v_accvgpr_read_b32 v18, a54
    v_accvgpr_read_b32 v19, a55
    v_cvt_pk_bf16_f32 v218, v16, v17
    v_cvt_pk_bf16_f32 v219, v18, v19
    v_accvgpr_read_b32 v16, a56
    v_accvgpr_read_b32 v17, a57
    v_accvgpr_read_b32 v18, a58
    v_accvgpr_read_b32 v19, a59
    v_cvt_pk_bf16_f32 v220, v16, v17
    v_cvt_pk_bf16_f32 v221, v18, v19
    v_accvgpr_read_b32 v16, a60
    v_accvgpr_read_b32 v17, a61
    v_accvgpr_read_b32 v18, a62
    v_accvgpr_read_b32 v19, a63
    v_cvt_pk_bf16_f32 v222, v16, v17
    v_cvt_pk_bf16_f32 v223, v18, v19
    s_mov_b32 s68, 4096
    buffer_store_dwordx4 v[192:195], v12, s[88:91], 0 offen offset:0 sc1
    buffer_store_dwordx4 v[196:199], v12, s[88:91], 0 offen offset:1024 sc1
    buffer_store_dwordx4 v[200:203], v12, s[88:91], 0 offen offset:2048 sc1
    buffer_store_dwordx4 v[204:207], v12, s[88:91], 0 offen offset:3072 sc1
    buffer_store_dwordx4 v[208:211], v12, s[88:91], s68 offen offset:0 sc1
    buffer_store_dwordx4 v[212:215], v12, s[88:91], s68 offen offset:1024 sc1
    buffer_store_dwordx4 v[216:219], v12, s[88:91], s68 offen offset:2048 sc1
    buffer_store_dwordx4 v[220:223], v12, s[88:91], s68 offen offset:3072 sc1
    s_waitcnt vmcnt(28)
    s_barrier
    ds_read_b128 v[24:27], v4 offset:0
    ds_read_b64_tr_b16 v[40:41], v8 offset:0
    ds_read_b64_tr_b16 v[42:43], v8 offset:1024
    ds_read_b64_tr_b16 v[44:45], v9 offset:0
    ds_read_b64_tr_b16 v[46:47], v9 offset:1024
    ds_read_b64_tr_b16 v[48:49], v10 offset:0
    ds_read_b64_tr_b16 v[50:51], v10 offset:1024
    ds_read_b64_tr_b16 v[52:53], v11 offset:0
    ds_read_b64_tr_b16 v[54:55], v11 offset:1024
    ds_read_b128 v[28:31], v5 offset:0
    ds_read_b64_tr_b16 v[56:57], v8 offset:4096
    ds_read_b64_tr_b16 v[58:59], v8 offset:5120
    ds_read_b64_tr_b16 v[60:61], v9 offset:4096
    ds_read_b64_tr_b16 v[62:63], v9 offset:5120
    ds_read_b64_tr_b16 v[64:65], v10 offset:4096
    ds_read_b64_tr_b16 v[66:67], v10 offset:5120
    ds_read_b64_tr_b16 v[68:69], v11 offset:4096
    ds_read_b64_tr_b16 v[70:71], v11 offset:5120
    ds_read_b128 v[32:35], v6 offset:0
    ds_read_b64_tr_b16 v[72:73], v8 offset:8192
    ds_read_b64_tr_b16 v[74:75], v8 offset:9216
    ds_read_b64_tr_b16 v[76:77], v9 offset:8192
    ds_read_b64_tr_b16 v[78:79], v9 offset:9216
    ds_read_b64_tr_b16 v[80:81], v10 offset:8192
    ds_read_b64_tr_b16 v[82:83], v10 offset:9216
    ds_read_b64_tr_b16 v[84:85], v11 offset:8192
    ds_read_b64_tr_b16 v[86:87], v11 offset:9216
    ds_read_b128 v[36:39], v7 offset:0
    ds_read_b64_tr_b16 v[88:89], v8 offset:12288
    ds_read_b64_tr_b16 v[90:91], v8 offset:13312
    ds_read_b64_tr_b16 v[92:93], v9 offset:12288
    ds_read_b64_tr_b16 v[94:95], v9 offset:13312
    ds_read_b64_tr_b16 v[96:97], v10 offset:12288
    ds_read_b64_tr_b16 v[98:99], v10 offset:13312
    ds_read_b64_tr_b16 v[100:101], v11 offset:12288
    ds_read_b64_tr_b16 v[102:103], v11 offset:13312
    s_waitcnt lgkmcnt(0)
    v_mfma_f32_32x32x16_bf16 a[0:15], v[40:43], v[24:27], 0
    s_add_u32 s69, s74, 3
    s_and_b32 s69, s69, 15
    s_lshl_b32 s69, s69, 19
    s_add_u32 s69, s69, s73
    s_add_u32 m0, s76, 49152
    s_add_u32 s68, s69, 0
    buffer_load_dwordx4 v3, s[64:67], s68 offen lds
    v_mfma_f32_32x32x16_bf16 a[16:31], v[44:47], v[24:27], 0
    s_add_u32 m0, s76, 50176
    s_add_u32 s68, s69, 32768
    buffer_load_dwordx4 v3, s[64:67], s68 offen lds
    s_waitcnt vmcnt(22)
    s_barrier
    v_mfma_f32_32x32x16_bf16 a[32:47], v[48:51], v[24:27], 0
    ds_read_b128 v[104:107], v4 offset:4096
    ds_read_b64_tr_b16 v[120:121], v8 offset:16384
    ds_read_b64_tr_b16 v[122:123], v8 offset:17408
    s_add_u32 s69, s74, 3
    s_and_b32 s69, s69, 15
    s_lshl_b32 s69, s69, 19
    s_add_u32 s69, s69, s73
    s_add_u32 m0, s76, 57344
    s_add_u32 s68, s69, 262144
    buffer_load_dwordx4 v3, s[64:67], s68 offen lds
    v_mfma_f32_32x32x16_bf16 a[48:63], v[52:55], v[24:27], 0
    ds_read_b64_tr_b16 v[124:125], v9 offset:16384
    ds_read_b64_tr_b16 v[126:127], v9 offset:17408
    ds_read_b64_tr_b16 v[128:129], v10 offset:16384
    s_add_u32 m0, s76, 58368
    s_add_u32 s68, s69, 294912
    buffer_load_dwordx4 v3, s[64:67], s68 offen lds
    v_mfma_f32_32x32x16_bf16 a[0:15], v[56:59], v[28:31], a[0:15]
    ds_read_b64_tr_b16 v[130:131], v10 offset:17408
    ds_read_b64_tr_b16 v[132:133], v11 offset:16384
    ds_read_b64_tr_b16 v[134:135], v11 offset:17408
    s_add_u32 s69, s74, 4
    s_and_b32 s69, s69, 15
    s_lshl_b32 s69, s69, 7
    s_add_u32 s69, s69, s72
    s_add_u32 m0, s75, 0
    s_add_u32 s68, s69, 0
    buffer_load_dwordx4 v1, s[60:63], s68 offen lds
    v_mfma_f32_32x32x16_bf16 a[16:31], v[60:63], v[28:31], a[16:31]
    ds_read_b128 v[108:111], v5 offset:4096
    ds_read_b64_tr_b16 v[136:137], v8 offset:20480
    ds_read_b64_tr_b16 v[138:139], v8 offset:21504
    s_add_u32 m0, s75, 1024
    s_add_u32 s68, s69, 16384
    buffer_load_dwordx4 v2, s[60:63], s68 offen lds
    v_mfma_f32_32x32x16_bf16 a[32:47], v[64:67], v[28:31], a[32:47]
    ds_read_b64_tr_b16 v[140:141], v9 offset:20480
    ds_read_b64_tr_b16 v[142:143], v9 offset:21504
    ds_read_b64_tr_b16 v[144:145], v10 offset:20480
    s_add_u32 m0, s75, 2048
    s_add_u32 s68, s69, 32768
    buffer_load_dwordx4 v1, s[60:63], s68 offen lds
    v_mfma_f32_32x32x16_bf16 a[48:63], v[68:71], v[28:31], a[48:63]
    ds_read_b64_tr_b16 v[146:147], v10 offset:21504
    ds_read_b64_tr_b16 v[148:149], v11 offset:20480
    ds_read_b64_tr_b16 v[150:151], v11 offset:21504
    s_add_u32 m0, s75, 3072
    s_add_u32 s68, s69, 49152
    buffer_load_dwordx4 v2, s[60:63], s68 offen lds
    v_mfma_f32_32x32x16_bf16 a[0:15], v[72:75], v[32:35], a[0:15]
    ds_read_b128 v[112:115], v6 offset:4096
    ds_read_b64_tr_b16 v[152:153], v8 offset:24576
    ds_read_b64_tr_b16 v[154:155], v8 offset:25600
    s_add_u32 s69, s74, 4
    s_and_b32 s69, s69, 15
    s_lshl_b32 s69, s69, 19
    s_add_u32 s69, s69, s73
    s_add_u32 m0, s76, 0
    s_add_u32 s68, s69, 0
    buffer_load_dwordx4 v3, s[64:67], s68 offen lds
    v_mfma_f32_32x32x16_bf16 a[16:31], v[76:79], v[32:35], a[16:31]
    ds_read_b64_tr_b16 v[156:157], v9 offset:24576
    ds_read_b64_tr_b16 v[158:159], v9 offset:25600
    ds_read_b64_tr_b16 v[160:161], v10 offset:24576
    s_add_u32 m0, s76, 1024
    s_add_u32 s68, s69, 32768
    buffer_load_dwordx4 v3, s[64:67], s68 offen lds
    v_mfma_f32_32x32x16_bf16 a[32:47], v[80:83], v[32:35], a[32:47]
    ds_read_b64_tr_b16 v[162:163], v10 offset:25600
    ds_read_b64_tr_b16 v[164:165], v11 offset:24576
    ds_read_b64_tr_b16 v[166:167], v11 offset:25600
    s_add_u32 s69, s74, 4
    s_and_b32 s69, s69, 15
    s_lshl_b32 s69, s69, 19
    s_add_u32 s69, s69, s73
    s_add_u32 m0, s76, 8192
    s_add_u32 s68, s69, 262144
    buffer_load_dwordx4 v3, s[64:67], s68 offen lds
    v_mfma_f32_32x32x16_bf16 a[48:63], v[84:87], v[32:35], a[48:63]
    ds_read_b128 v[116:119], v7 offset:4096
    ds_read_b64_tr_b16 v[168:169], v8 offset:28672
    ds_read_b64_tr_b16 v[170:171], v8 offset:29696
    s_add_u32 m0, s76, 9216
    s_add_u32 s68, s69, 294912
    buffer_load_dwordx4 v3, s[64:67], s68 offen lds
    v_mfma_f32_32x32x16_bf16 a[0:15], v[88:91], v[36:39], a[0:15]
    ds_read_b64_tr_b16 v[172:173], v9 offset:28672
    ds_read_b64_tr_b16 v[174:175], v9 offset:29696
    ds_read_b64_tr_b16 v[176:177], v10 offset:28672
    v_mfma_f32_32x32x16_bf16 a[16:31], v[92:95], v[36:39], a[16:31]
    ds_read_b64_tr_b16 v[178:179], v10 offset:29696
    ds_read_b64_tr_b16 v[180:181], v11 offset:28672
    ds_read_b64_tr_b16 v[182:183], v11 offset:29696
    v_mfma_f32_32x32x16_bf16 a[32:47], v[96:99], v[36:39], a[32:47]
    v_mfma_f32_32x32x16_bf16 a[48:63], v[100:103], v[36:39], a[48:63]
    s_waitcnt lgkmcnt(0)
    v_mfma_f32_32x32x16_bf16 a[0:15], v[120:123], v[104:107], a[0:15]
    s_add_u32 s69, s74, 5
    s_and_b32 s69, s69, 15
    s_lshl_b32 s69, s69, 7
    s_add_u32 s69, s69, s72
    s_add_u32 m0, s75, 4096
    s_add_u32 s68, s69, 0
    buffer_load_dwordx4 v1, s[60:63], s68 offen lds
    v_mfma_f32_32x32x16_bf16 a[16:31], v[124:127], v[104:107], a[16:31]
    s_add_u32 m0, s75, 5120
    s_add_u32 s68, s69, 16384
    buffer_load_dwordx4 v2, s[60:63], s68 offen lds
    s_waitcnt vmcnt(14)
    v_readfirstlane_b32 s68, v13
    s_cmp_ge_u32 s68, 256
    s_cbranch_scc1 L_gated_13
    v_mov_b32 v15, 0

L_gate_12:
    s_sleep 32
    buffer_load_dword v14, v15, s[48:51], 0 offen sc1
    s_waitcnt vmcnt(0)
    v_readfirstlane_b32 s68, v14
    s_cmp_ge_u32 s68, 256
    s_cbranch_scc0 L_gate_12

L_gated_13:
    s_mov_b32 s46, 1
    v_mov_b32 v14, 1
    v_mov_b32 v15, 0
    s_mov_b64 exec, 1
    buffer_store_dword v14, v15, s[96:99], s14 offen sc1
    s_mov_b64 exec, -1

    s_barrier
    v_mfma_f32_32x32x16_bf16 a[32:47], v[128:131], v[104:107], a[32:47]
    ds_read_b128 v[24:27], v4 offset:8192
    ds_read_b64_tr_b16 v[40:41], v8 offset:32768
    ds_read_b64_tr_b16 v[42:43], v8 offset:33792
    s_add_u32 m0, s75, 6144
    s_add_u32 s68, s69, 32768
    buffer_load_dwordx4 v1, s[60:63], s68 offen lds
    v_mfma_f32_32x32x16_bf16 a[48:63], v[132:135], v[104:107], a[48:63]
    ds_read_b64_tr_b16 v[44:45], v9 offset:32768
    ds_read_b64_tr_b16 v[46:47], v9 offset:33792
    ds_read_b64_tr_b16 v[48:49], v10 offset:32768
    s_add_u32 m0, s75, 7168
    s_add_u32 s68, s69, 49152
    buffer_load_dwordx4 v2, s[60:63], s68 offen lds
    v_mfma_f32_32x32x16_bf16 a[0:15], v[136:139], v[108:111], a[0:15]
    ds_read_b64_tr_b16 v[50:51], v10 offset:33792
    ds_read_b64_tr_b16 v[52:53], v11 offset:32768
    ds_read_b64_tr_b16 v[54:55], v11 offset:33792
    s_add_u32 s69, s74, 5
    s_and_b32 s69, s69, 15
    s_lshl_b32 s69, s69, 19
    s_add_u32 s69, s69, s73
    s_add_u32 m0, s76, 16384
    s_add_u32 s68, s69, 0
    buffer_load_dwordx4 v3, s[64:67], s68 offen lds
    v_mfma_f32_32x32x16_bf16 a[16:31], v[140:143], v[108:111], a[16:31]
    ds_read_b128 v[28:31], v5 offset:8192
    ds_read_b64_tr_b16 v[56:57], v8 offset:36864
    ds_read_b64_tr_b16 v[58:59], v8 offset:37888
    s_add_u32 m0, s76, 17408
    s_add_u32 s68, s69, 32768
    buffer_load_dwordx4 v3, s[64:67], s68 offen lds
    v_mfma_f32_32x32x16_bf16 a[32:47], v[144:147], v[108:111], a[32:47]
    ds_read_b64_tr_b16 v[60:61], v9 offset:36864
    ds_read_b64_tr_b16 v[62:63], v9 offset:37888
    ds_read_b64_tr_b16 v[64:65], v10 offset:36864
    s_add_u32 s69, s74, 5
    s_and_b32 s69, s69, 15
    s_lshl_b32 s69, s69, 19
    s_add_u32 s69, s69, s73
    s_add_u32 m0, s76, 24576
    s_add_u32 s68, s69, 262144
    buffer_load_dwordx4 v3, s[64:67], s68 offen lds
    v_mfma_f32_32x32x16_bf16 a[48:63], v[148:151], v[108:111], a[48:63]
    ds_read_b64_tr_b16 v[66:67], v10 offset:37888
    ds_read_b64_tr_b16 v[68:69], v11 offset:36864
    ds_read_b64_tr_b16 v[70:71], v11 offset:37888
    s_add_u32 m0, s76, 25600
    s_add_u32 s68, s69, 294912
    buffer_load_dwordx4 v3, s[64:67], s68 offen lds
    v_mfma_f32_32x32x16_bf16 a[0:15], v[152:155], v[112:115], a[0:15]
    ds_read_b128 v[32:35], v6 offset:8192
    ds_read_b64_tr_b16 v[72:73], v8 offset:40960
    ds_read_b64_tr_b16 v[74:75], v8 offset:41984
    v_mfma_f32_32x32x16_bf16 a[16:31], v[156:159], v[112:115], a[16:31]
    ds_read_b64_tr_b16 v[76:77], v9 offset:40960
    ds_read_b64_tr_b16 v[78:79], v9 offset:41984
    ds_read_b64_tr_b16 v[80:81], v10 offset:40960
    v_mfma_f32_32x32x16_bf16 a[32:47], v[160:163], v[112:115], a[32:47]
    ds_read_b64_tr_b16 v[82:83], v10 offset:41984
    ds_read_b64_tr_b16 v[84:85], v11 offset:40960
    ds_read_b64_tr_b16 v[86:87], v11 offset:41984
    v_mfma_f32_32x32x16_bf16 a[48:63], v[164:167], v[112:115], a[48:63]
    ds_read_b128 v[36:39], v7 offset:8192
    ds_read_b64_tr_b16 v[88:89], v8 offset:45056
    ds_read_b64_tr_b16 v[90:91], v8 offset:46080
    v_mfma_f32_32x32x16_bf16 a[0:15], v[168:171], v[116:119], a[0:15]
    ds_read_b64_tr_b16 v[92:93], v9 offset:45056
    ds_read_b64_tr_b16 v[94:95], v9 offset:46080
    ds_read_b64_tr_b16 v[96:97], v10 offset:45056
    v_mfma_f32_32x32x16_bf16 a[16:31], v[172:175], v[116:119], a[16:31]
    ds_read_b64_tr_b16 v[98:99], v10 offset:46080
    ds_read_b64_tr_b16 v[100:101], v11 offset:45056
    ds_read_b64_tr_b16 v[102:103], v11 offset:46080
    v_mfma_f32_32x32x16_bf16 a[32:47], v[176:179], v[116:119], a[32:47]
    v_mfma_f32_32x32x16_bf16 a[48:63], v[180:183], v[116:119], a[48:63]
    s_waitcnt lgkmcnt(0)
    v_mfma_f32_32x32x16_bf16 a[0:15], v[40:43], v[24:27], a[0:15]
    s_add_u32 s69, s74, 6
    s_and_b32 s69, s69, 15
    s_lshl_b32 s69, s69, 7
    s_add_u32 s69, s69, s72
    s_add_u32 m0, s75, 8192
    s_add_u32 s68, s69, 0
    buffer_load_dwordx4 v1, s[60:63], s68 offen lds
    v_mfma_f32_32x32x16_bf16 a[16:31], v[44:47], v[24:27], a[16:31]
    s_add_u32 m0, s75, 9216
    s_add_u32 s68, s69, 16384
    buffer_load_dwordx4 v2, s[60:63], s68 offen lds
    s_waitcnt vmcnt(19)
    s_barrier
    v_mfma_f32_32x32x16_bf16 a[32:47], v[48:51], v[24:27], a[32:47]
    ds_read_b128 v[104:107], v4 offset:12288
    ds_read_b64_tr_b16 v[120:121], v8 offset:49152
    ds_read_b64_tr_b16 v[122:123], v8 offset:50176
    s_add_u32 m0, s75, 10240
    s_add_u32 s68, s69, 32768
    buffer_load_dwordx4 v1, s[60:63], s68 offen lds
    v_mfma_f32_32x32x16_bf16 a[48:63], v[52:55], v[24:27], a[48:63]
    ds_read_b64_tr_b16 v[124:125], v9 offset:49152
    ds_read_b64_tr_b16 v[126:127], v9 offset:50176
    ds_read_b64_tr_b16 v[128:129], v10 offset:49152
    s_add_u32 m0, s75, 11264
    s_add_u32 s68, s69, 49152
    buffer_load_dwordx4 v2, s[60:63], s68 offen lds
    v_mfma_f32_32x32x16_bf16 a[0:15], v[56:59], v[28:31], a[0:15]
    ds_read_b64_tr_b16 v[130:131], v10 offset:50176
    ds_read_b64_tr_b16 v[132:133], v11 offset:49152
    ds_read_b64_tr_b16 v[134:135], v11 offset:50176
    s_add_u32 s69, s74, 6
    s_and_b32 s69, s69, 15
    s_lshl_b32 s69, s69, 19
    s_add_u32 s69, s69, s73
    s_add_u32 m0, s76, 32768
    s_add_u32 s68, s69, 0
    buffer_load_dwordx4 v3, s[64:67], s68 offen lds
    v_mfma_f32_32x32x16_bf16 a[16:31], v[60:63], v[28:31], a[16:31]
    ds_read_b128 v[108:111], v5 offset:12288
    ds_read_b64_tr_b16 v[136:137], v8 offset:53248
    ds_read_b64_tr_b16 v[138:139], v8 offset:54272
    s_add_u32 m0, s76, 33792
    s_add_u32 s68, s69, 32768
    buffer_load_dwordx4 v3, s[64:67], s68 offen lds
    v_mfma_f32_32x32x16_bf16 a[32:47], v[64:67], v[28:31], a[32:47]
    ds_read_b64_tr_b16 v[140:141], v9 offset:53248
    ds_read_b64_tr_b16 v[142:143], v9 offset:54272
    ds_read_b64_tr_b16 v[144:145], v10 offset:53248
    s_add_u32 s69, s74, 6
    s_and_b32 s69, s69, 15
    s_lshl_b32 s69, s69, 19
    s_add_u32 s69, s69, s73
    s_add_u32 m0, s76, 40960
    s_add_u32 s68, s69, 262144
    buffer_load_dwordx4 v3, s[64:67], s68 offen lds
    v_mfma_f32_32x32x16_bf16 a[48:63], v[68:71], v[28:31], a[48:63]
    ds_read_b64_tr_b16 v[146:147], v10 offset:54272
    ds_read_b64_tr_b16 v[148:149], v11 offset:53248
    ds_read_b64_tr_b16 v[150:151], v11 offset:54272
    s_add_u32 m0, s76, 41984
    s_add_u32 s68, s69, 294912
    buffer_load_dwordx4 v3, s[64:67], s68 offen lds
    v_mfma_f32_32x32x16_bf16 a[0:15], v[72:75], v[32:35], a[0:15]
    ds_read_b128 v[112:115], v6 offset:12288
    ds_read_b64_tr_b16 v[152:153], v8 offset:57344
    ds_read_b64_tr_b16 v[154:155], v8 offset:58368
    v_mfma_f32_32x32x16_bf16 a[16:31], v[76:79], v[32:35], a[16:31]
    ds_read_b64_tr_b16 v[156:157], v9 offset:57344
    ds_read_b64_tr_b16 v[158:159], v9 offset:58368
    ds_read_b64_tr_b16 v[160:161], v10 offset:57344
    v_mfma_f32_32x32x16_bf16 a[32:47], v[80:83], v[32:35], a[32:47]
    ds_read_b64_tr_b16 v[162:163], v10 offset:58368
    ds_read_b64_tr_b16 v[164:165], v11 offset:57344
    ds_read_b64_tr_b16 v[166:167], v11 offset:58368
    v_mfma_f32_32x32x16_bf16 a[48:63], v[84:87], v[32:35], a[48:63]
    ds_read_b128 v[116:119], v7 offset:12288
    ds_read_b64_tr_b16 v[168:169], v8 offset:61440
    ds_read_b64_tr_b16 v[170:171], v8 offset:62464
    v_mfma_f32_32x32x16_bf16 a[0:15], v[88:91], v[36:39], a[0:15]
    ds_read_b64_tr_b16 v[172:173], v9 offset:61440
    ds_read_b64_tr_b16 v[174:175], v9 offset:62464
    ds_read_b64_tr_b16 v[176:177], v10 offset:61440
    v_mfma_f32_32x32x16_bf16 a[16:31], v[92:95], v[36:39], a[16:31]
    ds_read_b64_tr_b16 v[178:179], v10 offset:62464
    ds_read_b64_tr_b16 v[180:181], v11 offset:61440
    ds_read_b64_tr_b16 v[182:183], v11 offset:62464
    v_mfma_f32_32x32x16_bf16 a[32:47], v[96:99], v[36:39], a[32:47]
    v_mfma_f32_32x32x16_bf16 a[48:63], v[100:103], v[36:39], a[48:63]
    s_waitcnt lgkmcnt(0)
    v_mfma_f32_32x32x16_bf16 a[0:15], v[120:123], v[104:107], a[0:15]
    s_add_u32 s69, s74, 7
    s_and_b32 s69, s69, 15
    s_lshl_b32 s69, s69, 7
    s_add_u32 s69, s69, s72
    s_add_u32 m0, s75, 12288
    s_add_u32 s68, s69, 0
    buffer_load_dwordx4 v1, s[60:63], s68 offen lds
    v_mfma_f32_32x32x16_bf16 a[16:31], v[124:127], v[104:107], a[16:31]
    s_add_u32 m0, s75, 13312
    s_add_u32 s68, s69, 16384
    buffer_load_dwordx4 v2, s[60:63], s68 offen lds
    s_waitcnt vmcnt(19)
    s_barrier
    v_mfma_f32_32x32x16_bf16 a[32:47], v[128:131], v[104:107], a[32:47]
    ds_read_b128 v[24:27], v4 offset:0
    ds_read_b64_tr_b16 v[40:41], v8 offset:0
    ds_read_b64_tr_b16 v[42:43], v8 offset:1024
    s_add_u32 m0, s75, 14336
    s_add_u32 s68, s69, 32768
    buffer_load_dwordx4 v1, s[60:63], s68 offen lds
    v_mfma_f32_32x32x16_bf16 a[48:63], v[132:135], v[104:107], a[48:63]
    ds_read_b64_tr_b16 v[44:45], v9 offset:0
    ds_read_b64_tr_b16 v[46:47], v9 offset:1024
    ds_read_b64_tr_b16 v[48:49], v10 offset:0
    s_add_u32 m0, s75, 15360
    s_add_u32 s68, s69, 49152
    buffer_load_dwordx4 v2, s[60:63], s68 offen lds
    v_mfma_f32_32x32x16_bf16 a[0:15], v[136:139], v[108:111], a[0:15]
    ds_read_b64_tr_b16 v[50:51], v10 offset:1024
    ds_read_b64_tr_b16 v[52:53], v11 offset:0
    ds_read_b64_tr_b16 v[54:55], v11 offset:1024
    s_add_u32 s69, s74, 7
    s_and_b32 s69, s69, 15
    s_lshl_b32 s69, s69, 19
    s_add_u32 s69, s69, s73
    s_add_u32 m0, s76, 49152
    s_add_u32 s68, s69, 0
    buffer_load_dwordx4 v3, s[64:67], s68 offen lds
    v_mfma_f32_32x32x16_bf16 a[16:31], v[140:143], v[108:111], a[16:31]
    ds_read_b128 v[28:31], v5 offset:0
    ds_read_b64_tr_b16 v[56:57], v8 offset:4096
    ds_read_b64_tr_b16 v[58:59], v8 offset:5120
    s_add_u32 m0, s76, 50176
    s_add_u32 s68, s69, 32768
    buffer_load_dwordx4 v3, s[64:67], s68 offen lds
    v_mfma_f32_32x32x16_bf16 a[32:47], v[144:147], v[108:111], a[32:47]
    ds_read_b64_tr_b16 v[60:61], v9 offset:4096
    ds_read_b64_tr_b16 v[62:63], v9 offset:5120
    ds_read_b64_tr_b16 v[64:65], v10 offset:4096
    s_add_u32 s69, s74, 7
    s_and_b32 s69, s69, 15
    s_lshl_b32 s69, s69, 19
    s_add_u32 s69, s69, s73
    s_add_u32 m0, s76, 57344
    s_add_u32 s68, s69, 262144
    buffer_load_dwordx4 v3, s[64:67], s68 offen lds
    v_mfma_f32_32x32x16_bf16 a[48:63], v[148:151], v[108:111], a[48:63]
    ds_read_b64_tr_b16 v[66:67], v10 offset:5120
    ds_read_b64_tr_b16 v[68:69], v11 offset:4096
    ds_read_b64_tr_b16 v[70:71], v11 offset:5120
    s_add_u32 m0, s76, 58368
    s_add_u32 s68, s69, 294912
    buffer_load_dwordx4 v3, s[64:67], s68 offen lds
    v_mfma_f32_32x32x16_bf16 a[0:15], v[152:155], v[112:115], a[0:15]
    ds_read_b128 v[32:35], v6 offset:0
    ds_read_b64_tr_b16 v[72:73], v8 offset:8192
    ds_read_b64_tr_b16 v[74:75], v8 offset:9216
    v_mfma_f32_32x32x16_bf16 a[16:31], v[156:159], v[112:115], a[16:31]
    ds_read_b64_tr_b16 v[76:77], v9 offset:8192
    ds_read_b64_tr_b16 v[78:79], v9 offset:9216
    ds_read_b64_tr_b16 v[80:81], v10 offset:8192
    v_mfma_f32_32x32x16_bf16 a[32:47], v[160:163], v[112:115], a[32:47]
    ds_read_b64_tr_b16 v[82:83], v10 offset:9216
    ds_read_b64_tr_b16 v[84:85], v11 offset:8192
    ds_read_b64_tr_b16 v[86:87], v11 offset:9216
    v_mfma_f32_32x32x16_bf16 a[48:63], v[164:167], v[112:115], a[48:63]
    ds_read_b128 v[36:39], v7 offset:0
    ds_read_b64_tr_b16 v[88:89], v8 offset:12288
    ds_read_b64_tr_b16 v[90:91], v8 offset:13312
    v_mfma_f32_32x32x16_bf16 a[0:15], v[168:171], v[116:119], a[0:15]
    ds_read_b64_tr_b16 v[92:93], v9 offset:12288
    ds_read_b64_tr_b16 v[94:95], v9 offset:13312
    ds_read_b64_tr_b16 v[96:97], v10 offset:12288
    v_mfma_f32_32x32x16_bf16 a[16:31], v[172:175], v[116:119], a[16:31]
    ds_read_b64_tr_b16 v[98:99], v10 offset:13312
    ds_read_b64_tr_b16 v[100:101], v11 offset:12288
    ds_read_b64_tr_b16 v[102:103], v11 offset:13312
    v_mfma_f32_32x32x16_bf16 a[32:47], v[176:179], v[116:119], a[32:47]
    v_mfma_f32_32x32x16_bf16 a[48:63], v[180:183], v[116:119], a[48:63]
    s_waitcnt lgkmcnt(0)
    v_mfma_f32_32x32x16_bf16 a[0:15], v[40:43], v[24:27], a[0:15]
    s_add_u32 s69, s74, 8
    s_and_b32 s69, s69, 15
    s_lshl_b32 s69, s69, 7
    s_add_u32 s69, s69, s72
    s_add_u32 m0, s75, 0
    s_add_u32 s68, s69, 0
    buffer_load_dwordx4 v1, s[60:63], s68 offen lds
    v_mfma_f32_32x32x16_bf16 a[16:31], v[44:47], v[24:27], a[16:31]
    s_add_u32 m0, s75, 1024
    s_add_u32 s68, s69, 16384
    buffer_load_dwordx4 v2, s[60:63], s68 offen lds
    s_waitcnt vmcnt(18)
    s_barrier
    v_mfma_f32_32x32x16_bf16 a[32:47], v[48:51], v[24:27], a[32:47]
    ds_read_b128 v[104:107], v4 offset:4096
    ds_read_b64_tr_b16 v[120:121], v8 offset:16384
    ds_read_b64_tr_b16 v[122:123], v8 offset:17408
    s_add_u32 m0, s75, 2048
    s_add_u32 s68, s69, 32768
    buffer_load_dwordx4 v1, s[60:63], s68 offen lds
    v_mfma_f32_32x32x16_bf16 a[48:63], v[52:55], v[24:27], a[48:63]
    ds_read_b64_tr_b16 v[124:125], v9 offset:16384
    ds_read_b64_tr_b16 v[126:127], v9 offset:17408
    ds_read_b64_tr_b16 v[128:129], v10 offset:16384
    s_add_u32 m0, s75, 3072
    s_add_u32 s68, s69, 49152
    buffer_load_dwordx4 v2, s[60:63], s68 offen lds
    v_mfma_f32_32x32x16_bf16 a[0:15], v[56:59], v[28:31], a[0:15]
    ds_read_b64_tr_b16 v[130:131], v10 offset:17408
    ds_read_b64_tr_b16 v[132:133], v11 offset:16384
    ds_read_b64_tr_b16 v[134:135], v11 offset:17408
    s_add_u32 s69, s74, 8
    s_and_b32 s69, s69, 15
    s_lshl_b32 s69, s69, 19
    s_add_u32 s69, s69, s73
    s_add_u32 m0, s76, 0
    s_add_u32 s68, s69, 0
    buffer_load_dwordx4 v3, s[64:67], s68 offen lds
    v_mfma_f32_32x32x16_bf16 a[16:31], v[60:63], v[28:31], a[16:31]
    ds_read_b128 v[108:111], v5 offset:4096
    ds_read_b64_tr_b16 v[136:137], v8 offset:20480
    ds_read_b64_tr_b16 v[138:139], v8 offset:21504
    s_add_u32 m0, s76, 1024
    s_add_u32 s68, s69, 32768
    buffer_load_dwordx4 v3, s[64:67], s68 offen lds
    v_mfma_f32_32x32x16_bf16 a[32:47], v[64:67], v[28:31], a[32:47]
    ds_read_b64_tr_b16 v[140:141], v9 offset:20480
    ds_read_b64_tr_b16 v[142:143], v9 offset:21504
    ds_read_b64_tr_b16 v[144:145], v10 offset:20480
    s_add_u32 s69, s74, 8
    s_and_b32 s69, s69, 15
    s_lshl_b32 s69, s69, 19
    s_add_u32 s69, s69, s73
    s_add_u32 m0, s76, 8192
    s_add_u32 s68, s69, 262144
    buffer_load_dwordx4 v3, s[64:67], s68 offen lds
    v_mfma_f32_32x32x16_bf16 a[48:63], v[68:71], v[28:31], a[48:63]
    ds_read_b64_tr_b16 v[146:147], v10 offset:21504
    ds_read_b64_tr_b16 v[148:149], v11 offset:20480
    ds_read_b64_tr_b16 v[150:151], v11 offset:21504
    s_add_u32 m0, s76, 9216
    s_add_u32 s68, s69, 294912
    buffer_load_dwordx4 v3, s[64:67], s68 offen lds
    v_mfma_f32_32x32x16_bf16 a[0:15], v[72:75], v[32:35], a[0:15]
    ds_read_b128 v[112:115], v6 offset:4096
    ds_read_b64_tr_b16 v[152:153], v8 offset:24576
    ds_read_b64_tr_b16 v[154:155], v8 offset:25600
    v_mfma_f32_32x32x16_bf16 a[16:31], v[76:79], v[32:35], a[16:31]
    ds_read_b64_tr_b16 v[156:157], v9 offset:24576
    ds_read_b64_tr_b16 v[158:159], v9 offset:25600
    ds_read_b64_tr_b16 v[160:161], v10 offset:24576
    v_mfma_f32_32x32x16_bf16 a[32:47], v[80:83], v[32:35], a[32:47]
    ds_read_b64_tr_b16 v[162:163], v10 offset:25600
    ds_read_b64_tr_b16 v[164:165], v11 offset:24576
    ds_read_b64_tr_b16 v[166:167], v11 offset:25600
    v_mfma_f32_32x32x16_bf16 a[48:63], v[84:87], v[32:35], a[48:63]
    ds_read_b128 v[116:119], v7 offset:4096
    ds_read_b64_tr_b16 v[168:169], v8 offset:28672
    ds_read_b64_tr_b16 v[170:171], v8 offset:29696
    v_mfma_f32_32x32x16_bf16 a[0:15], v[88:91], v[36:39], a[0:15]
    ds_read_b64_tr_b16 v[172:173], v9 offset:28672
    ds_read_b64_tr_b16 v[174:175], v9 offset:29696
    ds_read_b64_tr_b16 v[176:177], v10 offset:28672
    v_mfma_f32_32x32x16_bf16 a[16:31], v[92:95], v[36:39], a[16:31]
    ds_read_b64_tr_b16 v[178:179], v10 offset:29696
    ds_read_b64_tr_b16 v[180:181], v11 offset:28672
    ds_read_b64_tr_b16 v[182:183], v11 offset:29696
    v_mfma_f32_32x32x16_bf16 a[32:47], v[96:99], v[36:39], a[32:47]
    v_mfma_f32_32x32x16_bf16 a[48:63], v[100:103], v[36:39], a[48:63]
    s_waitcnt lgkmcnt(0)
    v_mfma_f32_32x32x16_bf16 a[0:15], v[120:123], v[104:107], a[0:15]
    s_add_u32 s69, s74, 9
    s_and_b32 s69, s69, 15
    s_lshl_b32 s69, s69, 7
    s_add_u32 s69, s69, s72
    s_add_u32 m0, s75, 4096
    s_add_u32 s68, s69, 0
    buffer_load_dwordx4 v1, s[60:63], s68 offen lds
    v_mfma_f32_32x32x16_bf16 a[16:31], v[124:127], v[104:107], a[16:31]
    s_add_u32 m0, s75, 5120
    s_add_u32 s68, s69, 16384
    buffer_load_dwordx4 v2, s[60:63], s68 offen lds
    s_waitcnt vmcnt(18)
    s_barrier
    v_mfma_f32_32x32x16_bf16 a[32:47], v[128:131], v[104:107], a[32:47]
    ds_read_b128 v[24:27], v4 offset:8192
    ds_read_b64_tr_b16 v[40:41], v8 offset:32768
    ds_read_b64_tr_b16 v[42:43], v8 offset:33792
    s_add_u32 m0, s75, 6144
    s_add_u32 s68, s69, 32768
    buffer_load_dwordx4 v1, s[60:63], s68 offen lds
    v_mfma_f32_32x32x16_bf16 a[48:63], v[132:135], v[104:107], a[48:63]
    ds_read_b64_tr_b16 v[44:45], v9 offset:32768
    ds_read_b64_tr_b16 v[46:47], v9 offset:33792
    ds_read_b64_tr_b16 v[48:49], v10 offset:32768
    s_add_u32 m0, s75, 7168
    s_add_u32 s68, s69, 49152
    buffer_load_dwordx4 v2, s[60:63], s68 offen lds
    v_mfma_f32_32x32x16_bf16 a[0:15], v[136:139], v[108:111], a[0:15]
    ds_read_b64_tr_b16 v[50:51], v10 offset:33792
    ds_read_b64_tr_b16 v[52:53], v11 offset:32768
    ds_read_b64_tr_b16 v[54:55], v11 offset:33792
    s_add_u32 s69, s74, 9
    s_and_b32 s69, s69, 15
    s_lshl_b32 s69, s69, 19
    s_add_u32 s69, s69, s73
    s_add_u32 m0, s76, 16384
    s_add_u32 s68, s69, 0
    buffer_load_dwordx4 v3, s[64:67], s68 offen lds
    v_mfma_f32_32x32x16_bf16 a[16:31], v[140:143], v[108:111], a[16:31]
    ds_read_b128 v[28:31], v5 offset:8192
    ds_read_b64_tr_b16 v[56:57], v8 offset:36864
    ds_read_b64_tr_b16 v[58:59], v8 offset:37888
    s_add_u32 m0, s76, 17408
    s_add_u32 s68, s69, 32768
    buffer_load_dwordx4 v3, s[64:67], s68 offen lds
    v_mfma_f32_32x32x16_bf16 a[32:47], v[144:147], v[108:111], a[32:47]
    ds_read_b64_tr_b16 v[60:61], v9 offset:36864
    ds_read_b64_tr_b16 v[62:63], v9 offset:37888
    ds_read_b64_tr_b16 v[64:65], v10 offset:36864
    s_add_u32 s69, s74, 9
    s_and_b32 s69, s69, 15
    s_lshl_b32 s69, s69, 19
    s_add_u32 s69, s69, s73
    s_add_u32 m0, s76, 24576
    s_add_u32 s68, s69, 262144
    buffer_load_dwordx4 v3, s[64:67], s68 offen lds
    v_mfma_f32_32x32x16_bf16 a[48:63], v[148:151], v[108:111], a[48:63]
    ds_read_b64_tr_b16 v[66:67], v10 offset:37888
    ds_read_b64_tr_b16 v[68:69], v11 offset:36864
    ds_read_b64_tr_b16 v[70:71], v11 offset:37888
    s_add_u32 m0, s76, 25600
    s_add_u32 s68, s69, 294912
    buffer_load_dwordx4 v3, s[64:67], s68 offen lds
    v_mfma_f32_32x32x16_bf16 a[0:15], v[152:155], v[112:115], a[0:15]
    ds_read_b128 v[32:35], v6 offset:8192
    ds_read_b64_tr_b16 v[72:73], v8 offset:40960
    ds_read_b64_tr_b16 v[74:75], v8 offset:41984
    v_mfma_f32_32x32x16_bf16 a[16:31], v[156:159], v[112:115], a[16:31]
    ds_read_b64_tr_b16 v[76:77], v9 offset:40960
    ds_read_b64_tr_b16 v[78:79], v9 offset:41984
    ds_read_b64_tr_b16 v[80:81], v10 offset:40960
    v_mfma_f32_32x32x16_bf16 a[32:47], v[160:163], v[112:115], a[32:47]
    ds_read_b64_tr_b16 v[82:83], v10 offset:41984
    ds_read_b64_tr_b16 v[84:85], v11 offset:40960
    ds_read_b64_tr_b16 v[86:87], v11 offset:41984
    v_mfma_f32_32x32x16_bf16 a[48:63], v[164:167], v[112:115], a[48:63]
    ds_read_b128 v[36:39], v7 offset:8192
    ds_read_b64_tr_b16 v[88:89], v8 offset:45056
    ds_read_b64_tr_b16 v[90:91], v8 offset:46080
    v_mfma_f32_32x32x16_bf16 a[0:15], v[168:171], v[116:119], a[0:15]
    ds_read_b64_tr_b16 v[92:93], v9 offset:45056
    ds_read_b64_tr_b16 v[94:95], v9 offset:46080
    ds_read_b64_tr_b16 v[96:97], v10 offset:45056
    v_mfma_f32_32x32x16_bf16 a[16:31], v[172:175], v[116:119], a[16:31]
    ds_read_b64_tr_b16 v[98:99], v10 offset:46080
    ds_read_b64_tr_b16 v[100:101], v11 offset:45056
    ds_read_b64_tr_b16 v[102:103], v11 offset:46080
    v_mfma_f32_32x32x16_bf16 a[32:47], v[176:179], v[116:119], a[32:47]
    v_mfma_f32_32x32x16_bf16 a[48:63], v[180:183], v[116:119], a[48:63]
    s_waitcnt lgkmcnt(0)
    v_mfma_f32_32x32x16_bf16 a[0:15], v[40:43], v[24:27], a[0:15]
    s_add_u32 s69, s74, 10
    s_and_b32 s69, s69, 15
    s_lshl_b32 s69, s69, 7
    s_add_u32 s69, s69, s72
    s_add_u32 m0, s75, 8192
    s_add_u32 s68, s69, 0
    buffer_load_dwordx4 v1, s[60:63], s68 offen lds
    v_mfma_f32_32x32x16_bf16 a[16:31], v[44:47], v[24:27], a[16:31]
    s_add_u32 m0, s75, 9216
    s_add_u32 s68, s69, 16384
    buffer_load_dwordx4 v2, s[60:63], s68 offen lds
    s_waitcnt vmcnt(18)
    s_barrier
    v_mfma_f32_32x32x16_bf16 a[32:47], v[48:51], v[24:27], a[32:47]
    ds_read_b128 v[104:107], v4 offset:12288
    ds_read_b64_tr_b16 v[120:121], v8 offset:49152
    ds_read_b64_tr_b16 v[122:123], v8 offset:50176
    s_add_u32 m0, s75, 10240
    s_add_u32 s68, s69, 32768
    buffer_load_dwordx4 v1, s[60:63], s68 offen lds
    v_mfma_f32_32x32x16_bf16 a[48:63], v[52:55], v[24:27], a[48:63]
    ds_read_b64_tr_b16 v[124:125], v9 offset:49152
    ds_read_b64_tr_b16 v[126:127], v9 offset:50176
    ds_read_b64_tr_b16 v[128:129], v10 offset:49152
    s_add_u32 m0, s75, 11264
    s_add_u32 s68, s69, 49152
    buffer_load_dwordx4 v2, s[60:63], s68 offen lds
    v_mfma_f32_32x32x16_bf16 a[0:15], v[56:59], v[28:31], a[0:15]
    ds_read_b64_tr_b16 v[130:131], v10 offset:50176
    ds_read_b64_tr_b16 v[132:133], v11 offset:49152
    ds_read_b64_tr_b16 v[134:135], v11 offset:50176
    s_add_u32 s69, s74, 10
    s_and_b32 s69, s69, 15
    s_lshl_b32 s69, s69, 19
    s_add_u32 s69, s69, s73
    s_add_u32 m0, s76, 32768
    s_add_u32 s68, s69, 0
    buffer_load_dwordx4 v3, s[64:67], s68 offen lds
    v_mfma_f32_32x32x16_bf16 a[16:31], v[60:63], v[28:31], a[16:31]
    ds_read_b128 v[108:111], v5 offset:12288
    ds_read_b64_tr_b16 v[136:137], v8 offset:53248
    ds_read_b64_tr_b16 v[138:139], v8 offset:54272
    s_add_u32 m0, s76, 33792
    s_add_u32 s68, s69, 32768
    buffer_load_dwordx4 v3, s[64:67], s68 offen lds
    v_mfma_f32_32x32x16_bf16 a[32:47], v[64:67], v[28:31], a[32:47]
    ds_read_b64_tr_b16 v[140:141], v9 offset:53248
    ds_read_b64_tr_b16 v[142:143], v9 offset:54272
    ds_read_b64_tr_b16 v[144:145], v10 offset:53248
    s_add_u32 s69, s74, 10
    s_and_b32 s69, s69, 15
    s_lshl_b32 s69, s69, 19
    s_add_u32 s69, s69, s73
    s_add_u32 m0, s76, 40960
    s_add_u32 s68, s69, 262144
    buffer_load_dwordx4 v3, s[64:67], s68 offen lds
    v_mfma_f32_32x32x16_bf16 a[48:63], v[68:71], v[28:31], a[48:63]
    ds_read_b64_tr_b16 v[146:147], v10 offset:54272
    ds_read_b64_tr_b16 v[148:149], v11 offset:53248
    ds_read_b64_tr_b16 v[150:151], v11 offset:54272
    s_add_u32 m0, s76, 41984
    s_add_u32 s68, s69, 294912
    buffer_load_dwordx4 v3, s[64:67], s68 offen lds
    v_mfma_f32_32x32x16_bf16 a[0:15], v[72:75], v[32:35], a[0:15]
    ds_read_b128 v[112:115], v6 offset:12288
    ds_read_b64_tr_b16 v[152:153], v8 offset:57344
    ds_read_b64_tr_b16 v[154:155], v8 offset:58368
    v_mfma_f32_32x32x16_bf16 a[16:31], v[76:79], v[32:35], a[16:31]
    ds_read_b64_tr_b16 v[156:157], v9 offset:57344
    ds_read_b64_tr_b16 v[158:159], v9 offset:58368
    ds_read_b64_tr_b16 v[160:161], v10 offset:57344
    v_mfma_f32_32x32x16_bf16 a[32:47], v[80:83], v[32:35], a[32:47]
    ds_read_b64_tr_b16 v[162:163], v10 offset:58368
    ds_read_b64_tr_b16 v[164:165], v11 offset:57344
    ds_read_b64_tr_b16 v[166:167], v11 offset:58368
    v_mfma_f32_32x32x16_bf16 a[48:63], v[84:87], v[32:35], a[48:63]
    ds_read_b128 v[116:119], v7 offset:12288
    ds_read_b64_tr_b16 v[168:169], v8 offset:61440
    ds_read_b64_tr_b16 v[170:171], v8 offset:62464
    v_mfma_f32_32x32x16_bf16 a[0:15], v[88:91], v[36:39], a[0:15]
    ds_read_b64_tr_b16 v[172:173], v9 offset:61440
    ds_read_b64_tr_b16 v[174:175], v9 offset:62464
    ds_read_b64_tr_b16 v[176:177], v10 offset:61440
    v_mfma_f32_32x32x16_bf16 a[16:31], v[92:95], v[36:39], a[16:31]
    ds_read_b64_tr_b16 v[178:179], v10 offset:62464
    ds_read_b64_tr_b16 v[180:181], v11 offset:61440
    ds_read_b64_tr_b16 v[182:183], v11 offset:62464
    v_mfma_f32_32x32x16_bf16 a[32:47], v[96:99], v[36:39], a[32:47]
    v_mfma_f32_32x32x16_bf16 a[48:63], v[100:103], v[36:39], a[48:63]
    s_waitcnt lgkmcnt(0)
    v_mfma_f32_32x32x16_bf16 a[0:15], v[120:123], v[104:107], a[0:15]
    s_add_u32 s69, s74, 11
    s_and_b32 s69, s69, 15
    s_lshl_b32 s69, s69, 7
    s_add_u32 s69, s69, s72
    s_add_u32 m0, s75, 12288
    s_add_u32 s68, s69, 0
    buffer_load_dwordx4 v1, s[60:63], s68 offen lds
    v_mfma_f32_32x32x16_bf16 a[16:31], v[124:127], v[104:107], a[16:31]
    s_add_u32 m0, s75, 13312
    s_add_u32 s68, s69, 16384
    buffer_load_dwordx4 v2, s[60:63], s68 offen lds
    s_waitcnt vmcnt(18)
    s_barrier
    v_mfma_f32_32x32x16_bf16 a[32:47], v[128:131], v[104:107], a[32:47]
    ds_read_b128 v[24:27], v4 offset:0
    ds_read_b64_tr_b16 v[40:41], v8 offset:0
    ds_read_b64_tr_b16 v[42:43], v8 offset:1024
    s_add_u32 m0, s75, 14336
    s_add_u32 s68, s69, 32768
    buffer_load_dwordx4 v1, s[60:63], s68 offen lds
    v_mfma_f32_32x32x16_bf16 a[48:63], v[132:135], v[104:107], a[48:63]
    ds_read_b64_tr_b16 v[44:45], v9 offset:0
    ds_read_b64_tr_b16 v[46:47], v9 offset:1024
    ds_read_b64_tr_b16 v[48:49], v10 offset:0
    s_add_u32 m0, s75, 15360
    s_add_u32 s68, s69, 49152
    buffer_load_dwordx4 v2, s[60:63], s68 offen lds
    v_mfma_f32_32x32x16_bf16 a[0:15], v[136:139], v[108:111], a[0:15]
    ds_read_b64_tr_b16 v[50:51], v10 offset:1024
    ds_read_b64_tr_b16 v[52:53], v11 offset:0
    ds_read_b64_tr_b16 v[54:55], v11 offset:1024
    s_add_u32 s69, s74, 11
    s_and_b32 s69, s69, 15
    s_lshl_b32 s69, s69, 19
    s_add_u32 s69, s69, s73
    s_add_u32 m0, s76, 49152
    s_add_u32 s68, s69, 0
    buffer_load_dwordx4 v3, s[64:67], s68 offen lds
    v_mfma_f32_32x32x16_bf16 a[16:31], v[140:143], v[108:111], a[16:31]
    ds_read_b128 v[28:31], v5 offset:0
    ds_read_b64_tr_b16 v[56:57], v8 offset:4096
    ds_read_b64_tr_b16 v[58:59], v8 offset:5120
    s_add_u32 m0, s76, 50176
    s_add_u32 s68, s69, 32768
    buffer_load_dwordx4 v3, s[64:67], s68 offen lds
    v_mfma_f32_32x32x16_bf16 a[32:47], v[144:147], v[108:111], a[32:47]
    ds_read_b64_tr_b16 v[60:61], v9 offset:4096
    ds_read_b64_tr_b16 v[62:63], v9 offset:5120
    ds_read_b64_tr_b16 v[64:65], v10 offset:4096
    s_add_u32 s69, s74, 11
    s_and_b32 s69, s69, 15
    s_lshl_b32 s69, s69, 19
    s_add_u32 s69, s69, s73
    s_add_u32 m0, s76, 57344
    s_add_u32 s68, s69, 262144
    buffer_load_dwordx4 v3, s[64:67], s68 offen lds
    v_mfma_f32_32x32x16_bf16 a[48:63], v[148:151], v[108:111], a[48:63]
    ds_read_b64_tr_b16 v[66:67], v10 offset:5120
    ds_read_b64_tr_b16 v[68:69], v11 offset:4096
    ds_read_b64_tr_b16 v[70:71], v11 offset:5120
    s_add_u32 m0, s76, 58368
    s_add_u32 s68, s69, 294912
    buffer_load_dwordx4 v3, s[64:67], s68 offen lds
    v_mfma_f32_32x32x16_bf16 a[0:15], v[152:155], v[112:115], a[0:15]
    ds_read_b128 v[32:35], v6 offset:0
    ds_read_b64_tr_b16 v[72:73], v8 offset:8192
    ds_read_b64_tr_b16 v[74:75], v8 offset:9216
    v_mfma_f32_32x32x16_bf16 a[16:31], v[156:159], v[112:115], a[16:31]
    ds_read_b64_tr_b16 v[76:77], v9 offset:8192
    ds_read_b64_tr_b16 v[78:79], v9 offset:9216
    ds_read_b64_tr_b16 v[80:81], v10 offset:8192
    v_mfma_f32_32x32x16_bf16 a[32:47], v[160:163], v[112:115], a[32:47]
    ds_read_b64_tr_b16 v[82:83], v10 offset:9216
    ds_read_b64_tr_b16 v[84:85], v11 offset:8192
    ds_read_b64_tr_b16 v[86:87], v11 offset:9216
    v_mfma_f32_32x32x16_bf16 a[48:63], v[164:167], v[112:115], a[48:63]
    ds_read_b128 v[36:39], v7 offset:0
    ds_read_b64_tr_b16 v[88:89], v8 offset:12288
    ds_read_b64_tr_b16 v[90:91], v8 offset:13312
    v_mfma_f32_32x32x16_bf16 a[0:15], v[168:171], v[116:119], a[0:15]
    ds_read_b64_tr_b16 v[92:93], v9 offset:12288
    ds_read_b64_tr_b16 v[94:95], v9 offset:13312
    ds_read_b64_tr_b16 v[96:97], v10 offset:12288
    v_mfma_f32_32x32x16_bf16 a[16:31], v[172:175], v[116:119], a[16:31]
    ds_read_b64_tr_b16 v[98:99], v10 offset:13312
    ds_read_b64_tr_b16 v[100:101], v11 offset:12288
    ds_read_b64_tr_b16 v[102:103], v11 offset:13312
    v_mfma_f32_32x32x16_bf16 a[32:47], v[176:179], v[116:119], a[32:47]
    v_mfma_f32_32x32x16_bf16 a[48:63], v[180:183], v[116:119], a[48:63]
    s_waitcnt lgkmcnt(0)
    v_mfma_f32_32x32x16_bf16 a[0:15], v[40:43], v[24:27], a[0:15]
    s_add_u32 s69, s74, 12
    s_and_b32 s69, s69, 15
    s_lshl_b32 s69, s69, 7
    s_add_u32 s69, s69, s72
    s_add_u32 m0, s75, 0
    s_add_u32 s68, s69, 0
    buffer_load_dwordx4 v1, s[60:63], s68 offen lds
    v_mfma_f32_32x32x16_bf16 a[16:31], v[44:47], v[24:27], a[16:31]
    s_add_u32 m0, s75, 1024
    s_add_u32 s68, s69, 16384
    buffer_load_dwordx4 v2, s[60:63], s68 offen lds
    s_waitcnt vmcnt(18)
    s_barrier
    v_mfma_f32_32x32x16_bf16 a[32:47], v[48:51], v[24:27], a[32:47]
    ds_read_b128 v[104:107], v4 offset:4096
    ds_read_b64_tr_b16 v[120:121], v8 offset:16384
    ds_read_b64_tr_b16 v[122:123], v8 offset:17408
    s_add_u32 m0, s75, 2048
    s_add_u32 s68, s69, 32768
    buffer_load_dwordx4 v1, s[60:63], s68 offen lds
    v_mfma_f32_32x32x16_bf16 a[48:63], v[52:55], v[24:27], a[48:63]
    ds_read_b64_tr_b16 v[124:125], v9 offset:16384
    ds_read_b64_tr_b16 v[126:127], v9 offset:17408
    ds_read_b64_tr_b16 v[128:129], v10 offset:16384
    s_add_u32 m0, s75, 3072
    s_add_u32 s68, s69, 49152
    buffer_load_dwordx4 v2, s[60:63], s68 offen lds
    v_mfma_f32_32x32x16_bf16 a[0:15], v[56:59], v[28:31], a[0:15]
    ds_read_b64_tr_b16 v[130:131], v10 offset:17408
    ds_read_b64_tr_b16 v[132:133], v11 offset:16384
    ds_read_b64_tr_b16 v[134:135], v11 offset:17408
    s_add_u32 s69, s74, 12
    s_and_b32 s69, s69, 15
    s_lshl_b32 s69, s69, 19
    s_add_u32 s69, s69, s73
    s_add_u32 m0, s76, 0
    s_add_u32 s68, s69, 0
    buffer_load_dwordx4 v3, s[64:67], s68 offen lds
    v_mfma_f32_32x32x16_bf16 a[16:31], v[60:63], v[28:31], a[16:31]
    ds_read_b128 v[108:111], v5 offset:4096
    ds_read_b64_tr_b16 v[136:137], v8 offset:20480
    ds_read_b64_tr_b16 v[138:139], v8 offset:21504
    s_add_u32 m0, s76, 1024
    s_add_u32 s68, s69, 32768
    buffer_load_dwordx4 v3, s[64:67], s68 offen lds
    v_mfma_f32_32x32x16_bf16 a[32:47], v[64:67], v[28:31], a[32:47]
    ds_read_b64_tr_b16 v[140:141], v9 offset:20480
    ds_read_b64_tr_b16 v[142:143], v9 offset:21504
    ds_read_b64_tr_b16 v[144:145], v10 offset:20480
    s_add_u32 s69, s74, 12
    s_and_b32 s69, s69, 15
    s_lshl_b32 s69, s69, 19
    s_add_u32 s69, s69, s73
    s_add_u32 m0, s76, 8192
    s_add_u32 s68, s69, 262144
    buffer_load_dwordx4 v3, s[64:67], s68 offen lds
    v_mfma_f32_32x32x16_bf16 a[48:63], v[68:71], v[28:31], a[48:63]
    ds_read_b64_tr_b16 v[146:147], v10 offset:21504
    ds_read_b64_tr_b16 v[148:149], v11 offset:20480
    ds_read_b64_tr_b16 v[150:151], v11 offset:21504
    s_add_u32 m0, s76, 9216
    s_add_u32 s68, s69, 294912
    buffer_load_dwordx4 v3, s[64:67], s68 offen lds
    v_mfma_f32_32x32x16_bf16 a[0:15], v[72:75], v[32:35], a[0:15]
    ds_read_b128 v[112:115], v6 offset:4096
    ds_read_b64_tr_b16 v[152:153], v8 offset:24576
    ds_read_b64_tr_b16 v[154:155], v8 offset:25600
    v_mfma_f32_32x32x16_bf16 a[16:31], v[76:79], v[32:35], a[16:31]
    ds_read_b64_tr_b16 v[156:157], v9 offset:24576
    ds_read_b64_tr_b16 v[158:159], v9 offset:25600
    ds_read_b64_tr_b16 v[160:161], v10 offset:24576
    v_mfma_f32_32x32x16_bf16 a[32:47], v[80:83], v[32:35], a[32:47]
    ds_read_b64_tr_b16 v[162:163], v10 offset:25600
    ds_read_b64_tr_b16 v[164:165], v11 offset:24576
    ds_read_b64_tr_b16 v[166:167], v11 offset:25600
    v_mfma_f32_32x32x16_bf16 a[48:63], v[84:87], v[32:35], a[48:63]
    ds_read_b128 v[116:119], v7 offset:4096
    ds_read_b64_tr_b16 v[168:169], v8 offset:28672
    ds_read_b64_tr_b16 v[170:171], v8 offset:29696
    v_mfma_f32_32x32x16_bf16 a[0:15], v[88:91], v[36:39], a[0:15]
    ds_read_b64_tr_b16 v[172:173], v9 offset:28672
    ds_read_b64_tr_b16 v[174:175], v9 offset:29696
    ds_read_b64_tr_b16 v[176:177], v10 offset:28672
    v_mfma_f32_32x32x16_bf16 a[16:31], v[92:95], v[36:39], a[16:31]
    ds_read_b64_tr_b16 v[178:179], v10 offset:29696
    ds_read_b64_tr_b16 v[180:181], v11 offset:28672
    ds_read_b64_tr_b16 v[182:183], v11 offset:29696
    v_mfma_f32_32x32x16_bf16 a[32:47], v[96:99], v[36:39], a[32:47]
    v_mfma_f32_32x32x16_bf16 a[48:63], v[100:103], v[36:39], a[48:63]
    s_waitcnt lgkmcnt(0)
    v_mfma_f32_32x32x16_bf16 a[0:15], v[120:123], v[104:107], a[0:15]
    s_add_u32 s69, s74, 13
    s_and_b32 s69, s69, 15
    s_lshl_b32 s69, s69, 7
    s_add_u32 s69, s69, s72
    s_add_u32 m0, s75, 4096
    s_add_u32 s68, s69, 0
    buffer_load_dwordx4 v1, s[60:63], s68 offen lds
    v_mfma_f32_32x32x16_bf16 a[16:31], v[124:127], v[104:107], a[16:31]
    s_add_u32 m0, s75, 5120
    s_add_u32 s68, s69, 16384
    buffer_load_dwordx4 v2, s[60:63], s68 offen lds
    s_waitcnt vmcnt(18)
    s_barrier
    v_mfma_f32_32x32x16_bf16 a[32:47], v[128:131], v[104:107], a[32:47]
    ds_read_b128 v[24:27], v4 offset:8192
    ds_read_b64_tr_b16 v[40:41], v8 offset:32768
    ds_read_b64_tr_b16 v[42:43], v8 offset:33792
    s_add_u32 m0, s75, 6144
    s_add_u32 s68, s69, 32768
    buffer_load_dwordx4 v1, s[60:63], s68 offen lds
    v_mfma_f32_32x32x16_bf16 a[48:63], v[132:135], v[104:107], a[48:63]
    ds_read_b64_tr_b16 v[44:45], v9 offset:32768
    ds_read_b64_tr_b16 v[46:47], v9 offset:33792
    ds_read_b64_tr_b16 v[48:49], v10 offset:32768
    s_add_u32 m0, s75, 7168
    s_add_u32 s68, s69, 49152
    buffer_load_dwordx4 v2, s[60:63], s68 offen lds
    v_mfma_f32_32x32x16_bf16 a[0:15], v[136:139], v[108:111], a[0:15]
    ds_read_b64_tr_b16 v[50:51], v10 offset:33792
    ds_read_b64_tr_b16 v[52:53], v11 offset:32768
    ds_read_b64_tr_b16 v[54:55], v11 offset:33792
    s_add_u32 s69, s74, 13
    s_and_b32 s69, s69, 15
    s_lshl_b32 s69, s69, 19
    s_add_u32 s69, s69, s73
    s_add_u32 m0, s76, 16384
    s_add_u32 s68, s69, 0
    buffer_load_dwordx4 v3, s[64:67], s68 offen lds
    v_mfma_f32_32x32x16_bf16 a[16:31], v[140:143], v[108:111], a[16:31]
    ds_read_b128 v[28:31], v5 offset:8192
    ds_read_b64_tr_b16 v[56:57], v8 offset:36864
    ds_read_b64_tr_b16 v[58:59], v8 offset:37888
    s_add_u32 m0, s76, 17408
    s_add_u32 s68, s69, 32768
    buffer_load_dwordx4 v3, s[64:67], s68 offen lds
    v_mfma_f32_32x32x16_bf16 a[32:47], v[144:147], v[108:111], a[32:47]
    ds_read_b64_tr_b16 v[60:61], v9 offset:36864
    ds_read_b64_tr_b16 v[62:63], v9 offset:37888
    ds_read_b64_tr_b16 v[64:65], v10 offset:36864
    s_add_u32 s69, s74, 13
    s_and_b32 s69, s69, 15
    s_lshl_b32 s69, s69, 19
    s_add_u32 s69, s69, s73
    s_add_u32 m0, s76, 24576
    s_add_u32 s68, s69, 262144
    buffer_load_dwordx4 v3, s[64:67], s68 offen lds
    v_mfma_f32_32x32x16_bf16 a[48:63], v[148:151], v[108:111], a[48:63]
    ds_read_b64_tr_b16 v[66:67], v10 offset:37888
    ds_read_b64_tr_b16 v[68:69], v11 offset:36864
    ds_read_b64_tr_b16 v[70:71], v11 offset:37888
    s_add_u32 m0, s76, 25600
    s_add_u32 s68, s69, 294912
    buffer_load_dwordx4 v3, s[64:67], s68 offen lds
    v_mfma_f32_32x32x16_bf16 a[0:15], v[152:155], v[112:115], a[0:15]
    ds_read_b128 v[32:35], v6 offset:8192
    ds_read_b64_tr_b16 v[72:73], v8 offset:40960
    ds_read_b64_tr_b16 v[74:75], v8 offset:41984
    v_mfma_f32_32x32x16_bf16 a[16:31], v[156:159], v[112:115], a[16:31]
    ds_read_b64_tr_b16 v[76:77], v9 offset:40960
    ds_read_b64_tr_b16 v[78:79], v9 offset:41984
    ds_read_b64_tr_b16 v[80:81], v10 offset:40960
    v_mfma_f32_32x32x16_bf16 a[32:47], v[160:163], v[112:115], a[32:47]
    ds_read_b64_tr_b16 v[82:83], v10 offset:41984
    ds_read_b64_tr_b16 v[84:85], v11 offset:40960
    ds_read_b64_tr_b16 v[86:87], v11 offset:41984
    v_mfma_f32_32x32x16_bf16 a[48:63], v[164:167], v[112:115], a[48:63]
    ds_read_b128 v[36:39], v7 offset:8192
    ds_read_b64_tr_b16 v[88:89], v8 offset:45056
    ds_read_b64_tr_b16 v[90:91], v8 offset:46080
    v_mfma_f32_32x32x16_bf16 a[0:15], v[168:171], v[116:119], a[0:15]
    ds_read_b64_tr_b16 v[92:93], v9 offset:45056
    ds_read_b64_tr_b16 v[94:95], v9 offset:46080
    ds_read_b64_tr_b16 v[96:97], v10 offset:45056
    v_mfma_f32_32x32x16_bf16 a[16:31], v[172:175], v[116:119], a[16:31]
    ds_read_b64_tr_b16 v[98:99], v10 offset:46080
    ds_read_b64_tr_b16 v[100:101], v11 offset:45056
    ds_read_b64_tr_b16 v[102:103], v11 offset:46080
    v_mfma_f32_32x32x16_bf16 a[32:47], v[176:179], v[116:119], a[32:47]
    v_mfma_f32_32x32x16_bf16 a[48:63], v[180:183], v[116:119], a[48:63]
    s_waitcnt lgkmcnt(0)
    v_mfma_f32_32x32x16_bf16 a[0:15], v[40:43], v[24:27], a[0:15]
    s_add_u32 s69, s74, 14
    s_and_b32 s69, s69, 15
    s_lshl_b32 s69, s69, 7
    s_add_u32 s69, s69, s72
    s_add_u32 m0, s75, 8192
    s_add_u32 s68, s69, 0
    buffer_load_dwordx4 v1, s[60:63], s68 offen lds
    v_mfma_f32_32x32x16_bf16 a[16:31], v[44:47], v[24:27], a[16:31]
    s_add_u32 m0, s75, 9216
    s_add_u32 s68, s69, 16384
    buffer_load_dwordx4 v2, s[60:63], s68 offen lds
    s_waitcnt vmcnt(18)
    s_barrier
    v_mfma_f32_32x32x16_bf16 a[32:47], v[48:51], v[24:27], a[32:47]
    ds_read_b128 v[104:107], v4 offset:12288
    ds_read_b64_tr_b16 v[120:121], v8 offset:49152
    ds_read_b64_tr_b16 v[122:123], v8 offset:50176
    s_add_u32 m0, s75, 10240
    s_add_u32 s68, s69, 32768
    buffer_load_dwordx4 v1, s[60:63], s68 offen lds
    v_mfma_f32_32x32x16_bf16 a[48:63], v[52:55], v[24:27], a[48:63]
    ds_read_b64_tr_b16 v[124:125], v9 offset:49152
    ds_read_b64_tr_b16 v[126:127], v9 offset:50176
    ds_read_b64_tr_b16 v[128:129], v10 offset:49152
    s_add_u32 m0, s75, 11264
    s_add_u32 s68, s69, 49152
    buffer_load_dwordx4 v2, s[60:63], s68 offen lds
    v_mfma_f32_32x32x16_bf16 a[0:15], v[56:59], v[28:31], a[0:15]
    ds_read_b64_tr_b16 v[130:131], v10 offset:50176
    ds_read_b64_tr_b16 v[132:133], v11 offset:49152
    ds_read_b64_tr_b16 v[134:135], v11 offset:50176
    s_add_u32 s69, s74, 14
    s_and_b32 s69, s69, 15
    s_lshl_b32 s69, s69, 19
    s_add_u32 s69, s69, s73
    s_add_u32 m0, s76, 32768
    s_add_u32 s68, s69, 0
    buffer_load_dwordx4 v3, s[64:67], s68 offen lds
    v_mfma_f32_32x32x16_bf16 a[16:31], v[60:63], v[28:31], a[16:31]
    ds_read_b128 v[108:111], v5 offset:12288
    ds_read_b64_tr_b16 v[136:137], v8 offset:53248
    ds_read_b64_tr_b16 v[138:139], v8 offset:54272
    s_add_u32 m0, s76, 33792
    s_add_u32 s68, s69, 32768
    buffer_load_dwordx4 v3, s[64:67], s68 offen lds
    v_mfma_f32_32x32x16_bf16 a[32:47], v[64:67], v[28:31], a[32:47]
    ds_read_b64_tr_b16 v[140:141], v9 offset:53248
    ds_read_b64_tr_b16 v[142:143], v9 offset:54272
    ds_read_b64_tr_b16 v[144:145], v10 offset:53248
    s_add_u32 s69, s74, 14
    s_and_b32 s69, s69, 15
    s_lshl_b32 s69, s69, 19
    s_add_u32 s69, s69, s73
    s_add_u32 m0, s76, 40960
    s_add_u32 s68, s69, 262144
    buffer_load_dwordx4 v3, s[64:67], s68 offen lds
    v_mfma_f32_32x32x16_bf16 a[48:63], v[68:71], v[28:31], a[48:63]
    ds_read_b64_tr_b16 v[146:147], v10 offset:54272
    ds_read_b64_tr_b16 v[148:149], v11 offset:53248
    ds_read_b64_tr_b16 v[150:151], v11 offset:54272
    s_add_u32 m0, s76, 41984
    s_add_u32 s68, s69, 294912
    buffer_load_dwordx4 v3, s[64:67], s68 offen lds
    v_mfma_f32_32x32x16_bf16 a[0:15], v[72:75], v[32:35], a[0:15]
    ds_read_b128 v[112:115], v6 offset:12288
    ds_read_b64_tr_b16 v[152:153], v8 offset:57344
    ds_read_b64_tr_b16 v[154:155], v8 offset:58368
    v_mfma_f32_32x32x16_bf16 a[16:31], v[76:79], v[32:35], a[16:31]
    ds_read_b64_tr_b16 v[156:157], v9 offset:57344
    ds_read_b64_tr_b16 v[158:159], v9 offset:58368
    ds_read_b64_tr_b16 v[160:161], v10 offset:57344
    v_mfma_f32_32x32x16_bf16 a[32:47], v[80:83], v[32:35], a[32:47]
    ds_read_b64_tr_b16 v[162:163], v10 offset:58368
    ds_read_b64_tr_b16 v[164:165], v11 offset:57344
    ds_read_b64_tr_b16 v[166:167], v11 offset:58368
    v_mfma_f32_32x32x16_bf16 a[48:63], v[84:87], v[32:35], a[48:63]
    ds_read_b128 v[116:119], v7 offset:12288
    ds_read_b64_tr_b16 v[168:169], v8 offset:61440
    ds_read_b64_tr_b16 v[170:171], v8 offset:62464
    v_mfma_f32_32x32x16_bf16 a[0:15], v[88:91], v[36:39], a[0:15]
    ds_read_b64_tr_b16 v[172:173], v9 offset:61440
    ds_read_b64_tr_b16 v[174:175], v9 offset:62464
    ds_read_b64_tr_b16 v[176:177], v10 offset:61440
    v_mfma_f32_32x32x16_bf16 a[16:31], v[92:95], v[36:39], a[16:31]
    ds_read_b64_tr_b16 v[178:179], v10 offset:62464
    ds_read_b64_tr_b16 v[180:181], v11 offset:61440
    ds_read_b64_tr_b16 v[182:183], v11 offset:62464
    v_mfma_f32_32x32x16_bf16 a[32:47], v[96:99], v[36:39], a[32:47]
    v_mfma_f32_32x32x16_bf16 a[48:63], v[100:103], v[36:39], a[48:63]
    s_waitcnt lgkmcnt(0)
    v_mfma_f32_32x32x16_bf16 a[0:15], v[120:123], v[104:107], a[0:15]
    s_add_u32 s69, s74, 15
    s_and_b32 s69, s69, 15
    s_lshl_b32 s69, s69, 7
    s_add_u32 s69, s69, s72
    s_add_u32 m0, s75, 12288
    s_add_u32 s68, s69, 0
    buffer_load_dwordx4 v1, s[60:63], s68 offen lds
    v_mfma_f32_32x32x16_bf16 a[16:31], v[124:127], v[104:107], a[16:31]
    s_add_u32 m0, s75, 13312
    s_add_u32 s68, s69, 16384
    buffer_load_dwordx4 v2, s[60:63], s68 offen lds
    s_waitcnt vmcnt(18)
    s_barrier
    v_mfma_f32_32x32x16_bf16 a[32:47], v[128:131], v[104:107], a[32:47]
    ds_read_b128 v[24:27], v4 offset:0
    ds_read_b64_tr_b16 v[40:41], v8 offset:0
    ds_read_b64_tr_b16 v[42:43], v8 offset:1024
    s_add_u32 m0, s75, 14336
    s_add_u32 s68, s69, 32768
    buffer_load_dwordx4 v1, s[60:63], s68 offen lds
    v_mfma_f32_32x32x16_bf16 a[48:63], v[132:135], v[104:107], a[48:63]
    ds_read_b64_tr_b16 v[44:45], v9 offset:0
    ds_read_b64_tr_b16 v[46:47], v9 offset:1024
    ds_read_b64_tr_b16 v[48:49], v10 offset:0
    s_add_u32 m0, s75, 15360
    s_add_u32 s68, s69, 49152
    buffer_load_dwordx4 v2, s[60:63], s68 offen lds
    v_mfma_f32_32x32x16_bf16 a[0:15], v[136:139], v[108:111], a[0:15]
    ds_read_b64_tr_b16 v[50:51], v10 offset:1024
    ds_read_b64_tr_b16 v[52:53], v11 offset:0
    ds_read_b64_tr_b16 v[54:55], v11 offset:1024
    s_add_u32 s69, s74, 15
    s_and_b32 s69, s69, 15
    s_lshl_b32 s69, s69, 19
    s_add_u32 s69, s69, s73
    s_add_u32 m0, s76, 49152
    s_add_u32 s68, s69, 0
    buffer_load_dwordx4 v3, s[64:67], s68 offen lds
    v_mfma_f32_32x32x16_bf16 a[16:31], v[140:143], v[108:111], a[16:31]
    ds_read_b128 v[28:31], v5 offset:0
    ds_read_b64_tr_b16 v[56:57], v8 offset:4096
    ds_read_b64_tr_b16 v[58:59], v8 offset:5120
    s_add_u32 m0, s76, 50176
    s_add_u32 s68, s69, 32768
    buffer_load_dwordx4 v3, s[64:67], s68 offen lds
    v_mfma_f32_32x32x16_bf16 a[32:47], v[144:147], v[108:111], a[32:47]
    ds_read_b64_tr_b16 v[60:61], v9 offset:4096
    ds_read_b64_tr_b16 v[62:63], v9 offset:5120
    ds_read_b64_tr_b16 v[64:65], v10 offset:4096
    s_add_u32 s69, s74, 15
    s_and_b32 s69, s69, 15
    s_lshl_b32 s69, s69, 19
    s_add_u32 s69, s69, s73
    s_add_u32 m0, s76, 57344
    s_add_u32 s68, s69, 262144
    buffer_load_dwordx4 v3, s[64:67], s68 offen lds
    v_mfma_f32_32x32x16_bf16 a[48:63], v[148:151], v[108:111], a[48:63]
    ds_read_b64_tr_b16 v[66:67], v10 offset:5120
    ds_read_b64_tr_b16 v[68:69], v11 offset:4096
    ds_read_b64_tr_b16 v[70:71], v11 offset:5120
    s_add_u32 m0, s76, 58368
    s_add_u32 s68, s69, 294912
    buffer_load_dwordx4 v3, s[64:67], s68 offen lds
    v_mfma_f32_32x32x16_bf16 a[0:15], v[152:155], v[112:115], a[0:15]
    ds_read_b128 v[32:35], v6 offset:0
    ds_read_b64_tr_b16 v[72:73], v8 offset:8192
    ds_read_b64_tr_b16 v[74:75], v8 offset:9216
    v_mfma_f32_32x32x16_bf16 a[16:31], v[156:159], v[112:115], a[16:31]
    ds_read_b64_tr_b16 v[76:77], v9 offset:8192
    ds_read_b64_tr_b16 v[78:79], v9 offset:9216
    ds_read_b64_tr_b16 v[80:81], v10 offset:8192
    v_mfma_f32_32x32x16_bf16 a[32:47], v[160:163], v[112:115], a[32:47]
    ds_read_b64_tr_b16 v[82:83], v10 offset:9216
    ds_read_b64_tr_b16 v[84:85], v11 offset:8192
    ds_read_b64_tr_b16 v[86:87], v11 offset:9216
    v_mfma_f32_32x32x16_bf16 a[48:63], v[164:167], v[112:115], a[48:63]
    ds_read_b128 v[36:39], v7 offset:0
    ds_read_b64_tr_b16 v[88:89], v8 offset:12288
    ds_read_b64_tr_b16 v[90:91], v8 offset:13312
    v_mfma_f32_32x32x16_bf16 a[0:15], v[168:171], v[116:119], a[0:15]
    ds_read_b64_tr_b16 v[92:93], v9 offset:12288
    ds_read_b64_tr_b16 v[94:95], v9 offset:13312
    ds_read_b64_tr_b16 v[96:97], v10 offset:12288
    v_mfma_f32_32x32x16_bf16 a[16:31], v[172:175], v[116:119], a[16:31]
    ds_read_b64_tr_b16 v[98:99], v10 offset:13312
    ds_read_b64_tr_b16 v[100:101], v11 offset:12288
    ds_read_b64_tr_b16 v[102:103], v11 offset:13312
    v_mfma_f32_32x32x16_bf16 a[32:47], v[176:179], v[116:119], a[32:47]
    v_mfma_f32_32x32x16_bf16 a[48:63], v[180:183], v[116:119], a[48:63]
    s_waitcnt lgkmcnt(0)
    v_mfma_f32_32x32x16_bf16 a[0:15], v[40:43], v[24:27], a[0:15]
    v_mfma_f32_32x32x16_bf16 a[16:31], v[44:47], v[24:27], a[16:31]
    s_waitcnt vmcnt(16)
    s_barrier
    v_mfma_f32_32x32x16_bf16 a[32:47], v[48:51], v[24:27], a[32:47]
    ds_read_b128 v[104:107], v4 offset:4096
    ds_read_b64_tr_b16 v[120:121], v8 offset:16384
    ds_read_b64_tr_b16 v[122:123], v8 offset:17408
    v_mfma_f32_32x32x16_bf16 a[48:63], v[52:55], v[24:27], a[48:63]
    ds_read_b64_tr_b16 v[124:125], v9 offset:16384
    ds_read_b64_tr_b16 v[126:127], v9 offset:17408
    ds_read_b64_tr_b16 v[128:129], v10 offset:16384
    v_mfma_f32_32x32x16_bf16 a[0:15], v[56:59], v[28:31], a[0:15]
    ds_read_b64_tr_b16 v[130:131], v10 offset:17408
    ds_read_b64_tr_b16 v[132:133], v11 offset:16384
    ds_read_b64_tr_b16 v[134:135], v11 offset:17408
    v_mfma_f32_32x32x16_bf16 a[16:31], v[60:63], v[28:31], a[16:31]
    ds_read_b128 v[108:111], v5 offset:4096
    ds_read_b64_tr_b16 v[136:137], v8 offset:20480
    ds_read_b64_tr_b16 v[138:139], v8 offset:21504
    v_mfma_f32_32x32x16_bf16 a[32:47], v[64:67], v[28:31], a[32:47]
    ds_read_b64_tr_b16 v[140:141], v9 offset:20480
    ds_read_b64_tr_b16 v[142:143], v9 offset:21504
    ds_read_b64_tr_b16 v[144:145], v10 offset:20480
    v_mfma_f32_32x32x16_bf16 a[48:63], v[68:71], v[28:31], a[48:63]
    ds_read_b64_tr_b16 v[146:147], v10 offset:21504
    ds_read_b64_tr_b16 v[148:149], v11 offset:20480
    ds_read_b64_tr_b16 v[150:151], v11 offset:21504
    v_mfma_f32_32x32x16_bf16 a[0:15], v[72:75], v[32:35], a[0:15]
    ds_read_b128 v[112:115], v6 offset:4096
    ds_read_b64_tr_b16 v[152:153], v8 offset:24576
    ds_read_b64_tr_b16 v[154:155], v8 offset:25600
    v_mfma_f32_32x32x16_bf16 a[16:31], v[76:79], v[32:35], a[16:31]
    ds_read_b64_tr_b16 v[156:157], v9 offset:24576
    ds_read_b64_tr_b16 v[158:159], v9 offset:25600
    ds_read_b64_tr_b16 v[160:161], v10 offset:24576
    v_mfma_f32_32x32x16_bf16 a[32:47], v[80:83], v[32:35], a[32:47]
    ds_read_b64_tr_b16 v[162:163], v10 offset:25600
    ds_read_b64_tr_b16 v[164:165], v11 offset:24576
    ds_read_b64_tr_b16 v[166:167], v11 offset:25600
    v_mfma_f32_32x32x16_bf16 a[48:63], v[84:87], v[32:35], a[48:63]
    ds_read_b128 v[116:119], v7 offset:4096
    ds_read_b64_tr_b16 v[168:169], v8 offset:28672
    ds_read_b64_tr_b16 v[170:171], v8 offset:29696
    v_mfma_f32_32x32x16_bf16 a[0:15], v[88:91], v[36:39], a[0:15]
    ds_read_b64_tr_b16 v[172:173], v9 offset:28672
    ds_read_b64_tr_b16 v[174:175], v9 offset:29696
    ds_read_b64_tr_b16 v[176:177], v10 offset:28672
    v_mfma_f32_32x32x16_bf16 a[16:31], v[92:95], v[36:39], a[16:31]
    ds_read_b64_tr_b16 v[178:179], v10 offset:29696
    ds_read_b64_tr_b16 v[180:181], v11 offset:28672
    ds_read_b64_tr_b16 v[182:183], v11 offset:29696
    v_mfma_f32_32x32x16_bf16 a[32:47], v[96:99], v[36:39], a[32:47]
    v_mfma_f32_32x32x16_bf16 a[48:63], v[100:103], v[36:39], a[48:63]
    s_waitcnt lgkmcnt(0)
    v_mfma_f32_32x32x16_bf16 a[0:15], v[120:123], v[104:107], a[0:15]
    v_mfma_f32_32x32x16_bf16 a[16:31], v[124:127], v[104:107], a[16:31]
    s_waitcnt vmcnt(8)
    s_barrier
    v_mfma_f32_32x32x16_bf16 a[32:47], v[128:131], v[104:107], a[32:47]
    ds_read_b128 v[24:27], v4 offset:8192
    ds_read_b64_tr_b16 v[40:41], v8 offset:32768
    ds_read_b64_tr_b16 v[42:43], v8 offset:33792
    v_mfma_f32_32x32x16_bf16 a[48:63], v[132:135], v[104:107], a[48:63]
    ds_read_b64_tr_b16 v[44:45], v9 offset:32768
    ds_read_b64_tr_b16 v[46:47], v9 offset:33792
    ds_read_b64_tr_b16 v[48:49], v10 offset:32768
    v_mfma_f32_32x32x16_bf16 a[0:15], v[136:139], v[108:111], a[0:15]
    ds_read_b64_tr_b16 v[50:51], v10 offset:33792
    ds_read_b64_tr_b16 v[52:53], v11 offset:32768
    ds_read_b64_tr_b16 v[54:55], v11 offset:33792
    v_mfma_f32_32x32x16_bf16 a[16:31], v[140:143], v[108:111], a[16:31]
    ds_read_b128 v[28:31], v5 offset:8192
    ds_read_b64_tr_b16 v[56:57], v8 offset:36864
    ds_read_b64_tr_b16 v[58:59], v8 offset:37888
    v_mfma_f32_32x32x16_bf16 a[32:47], v[144:147], v[108:111], a[32:47]
    ds_read_b64_tr_b16 v[60:61], v9 offset:36864
    ds_read_b64_tr_b16 v[62:63], v9 offset:37888
    ds_read_b64_tr_b16 v[64:65], v10 offset:36864
    v_mfma_f32_32x32x16_bf16 a[48:63], v[148:151], v[108:111], a[48:63]
    ds_read_b64_tr_b16 v[66:67], v10 offset:37888
    ds_read_b64_tr_b16 v[68:69], v11 offset:36864
    ds_read_b64_tr_b16 v[70:71], v11 offset:37888
    v_mfma_f32_32x32x16_bf16 a[0:15], v[152:155], v[112:115], a[0:15]
    ds_read_b128 v[32:35], v6 offset:8192
    ds_read_b64_tr_b16 v[72:73], v8 offset:40960
    ds_read_b64_tr_b16 v[74:75], v8 offset:41984
    v_mfma_f32_32x32x16_bf16 a[16:31], v[156:159], v[112:115], a[16:31]
    ds_read_b64_tr_b16 v[76:77], v9 offset:40960
    ds_read_b64_tr_b16 v[78:79], v9 offset:41984
    ds_read_b64_tr_b16 v[80:81], v10 offset:40960
    v_mfma_f32_32x32x16_bf16 a[32:47], v[160:163], v[112:115], a[32:47]
    ds_read_b64_tr_b16 v[82:83], v10 offset:41984
    ds_read_b64_tr_b16 v[84:85], v11 offset:40960
    ds_read_b64_tr_b16 v[86:87], v11 offset:41984
    v_mfma_f32_32x32x16_bf16 a[48:63], v[164:167], v[112:115], a[48:63]
    ds_read_b128 v[36:39], v7 offset:8192
    ds_read_b64_tr_b16 v[88:89], v8 offset:45056
    ds_read_b64_tr_b16 v[90:91], v8 offset:46080
    v_mfma_f32_32x32x16_bf16 a[0:15], v[168:171], v[116:119], a[0:15]
    ds_read_b64_tr_b16 v[92:93], v9 offset:45056
    ds_read_b64_tr_b16 v[94:95], v9 offset:46080
    ds_read_b64_tr_b16 v[96:97], v10 offset:45056
    v_mfma_f32_32x32x16_bf16 a[16:31], v[172:175], v[116:119], a[16:31]
    ds_read_b64_tr_b16 v[98:99], v10 offset:46080
    ds_read_b64_tr_b16 v[100:101], v11 offset:45056
    ds_read_b64_tr_b16 v[102:103], v11 offset:46080
    v_mfma_f32_32x32x16_bf16 a[32:47], v[176:179], v[116:119], a[32:47]
    v_mfma_f32_32x32x16_bf16 a[48:63], v[180:183], v[116:119], a[48:63]
    s_waitcnt lgkmcnt(0)
    v_mfma_f32_32x32x16_bf16 a[0:15], v[40:43], v[24:27], a[0:15]
    v_mfma_f32_32x32x16_bf16 a[16:31], v[44:47], v[24:27], a[16:31]
    s_waitcnt vmcnt(0)
    s_barrier
    v_mfma_f32_32x32x16_bf16 a[32:47], v[48:51], v[24:27], a[32:47]
    ds_read_b128 v[104:107], v4 offset:12288
    ds_read_b64_tr_b16 v[120:121], v8 offset:49152
    ds_read_b64_tr_b16 v[122:123], v8 offset:50176
    v_mfma_f32_32x32x16_bf16 a[48:63], v[52:55], v[24:27], a[48:63]
    ds_read_b64_tr_b16 v[124:125], v9 offset:49152
    ds_read_b64_tr_b16 v[126:127], v9 offset:50176
    ds_read_b64_tr_b16 v[128:129], v10 offset:49152
    v_mfma_f32_32x32x16_bf16 a[0:15], v[56:59], v[28:31], a[0:15]
    ds_read_b64_tr_b16 v[130:131], v10 offset:50176
    ds_read_b64_tr_b16 v[132:133], v11 offset:49152
    ds_read_b64_tr_b16 v[134:135], v11 offset:50176
    v_mfma_f32_32x32x16_bf16 a[16:31], v[60:63], v[28:31], a[16:31]
    ds_read_b128 v[108:111], v5 offset:12288
    ds_read_b64_tr_b16 v[136:137], v8 offset:53248
    ds_read_b64_tr_b16 v[138:139], v8 offset:54272
    v_mfma_f32_32x32x16_bf16 a[32:47], v[64:67], v[28:31], a[32:47]
    ds_read_b64_tr_b16 v[140:141], v9 offset:53248
    ds_read_b64_tr_b16 v[142:143], v9 offset:54272
    ds_read_b64_tr_b16 v[144:145], v10 offset:53248
    v_mfma_f32_32x32x16_bf16 a[48:63], v[68:71], v[28:31], a[48:63]
    ds_read_b64_tr_b16 v[146:147], v10 offset:54272
    ds_read_b64_tr_b16 v[148:149], v11 offset:53248
    ds_read_b64_tr_b16 v[150:151], v11 offset:54272
    v_mfma_f32_32x32x16_bf16 a[0:15], v[72:75], v[32:35], a[0:15]
    ds_read_b128 v[112:115], v6 offset:12288
    ds_read_b64_tr_b16 v[152:153], v8 offset:57344
    ds_read_b64_tr_b16 v[154:155], v8 offset:58368
    v_mfma_f32_32x32x16_bf16 a[16:31], v[76:79], v[32:35], a[16:31]
    ds_read_b64_tr_b16 v[156:157], v9 offset:57344
    ds_read_b64_tr_b16 v[158:159], v9 offset:58368
    ds_read_b64_tr_b16 v[160:161], v10 offset:57344
    v_mfma_f32_32x32x16_bf16 a[32:47], v[80:83], v[32:35], a[32:47]
    ds_read_b64_tr_b16 v[162:163], v10 offset:58368
    ds_read_b64_tr_b16 v[164:165], v11 offset:57344
    ds_read_b64_tr_b16 v[166:167], v11 offset:58368
    v_mfma_f32_32x32x16_bf16 a[48:63], v[84:87], v[32:35], a[48:63]
    ds_read_b128 v[116:119], v7 offset:12288
    ds_read_b64_tr_b16 v[168:169], v8 offset:61440
    ds_read_b64_tr_b16 v[170:171], v8 offset:62464
    v_mfma_f32_32x32x16_bf16 a[0:15], v[88:91], v[36:39], a[0:15]
    ds_read_b64_tr_b16 v[172:173], v9 offset:61440
    ds_read_b64_tr_b16 v[174:175], v9 offset:62464
    ds_read_b64_tr_b16 v[176:177], v10 offset:61440
    v_mfma_f32_32x32x16_bf16 a[16:31], v[92:95], v[36:39], a[16:31]
    ds_read_b64_tr_b16 v[178:179], v10 offset:62464
    ds_read_b64_tr_b16 v[180:181], v11 offset:61440
    ds_read_b64_tr_b16 v[182:183], v11 offset:62464
    v_mfma_f32_32x32x16_bf16 a[32:47], v[96:99], v[36:39], a[32:47]
    v_mfma_f32_32x32x16_bf16 a[48:63], v[100:103], v[36:39], a[48:63]
    s_waitcnt lgkmcnt(0)
    v_mfma_f32_32x32x16_bf16 a[0:15], v[120:123], v[104:107], a[0:15]
    v_mfma_f32_32x32x16_bf16 a[16:31], v[124:127], v[104:107], a[16:31]
    v_mfma_f32_32x32x16_bf16 a[32:47], v[128:131], v[104:107], a[32:47]
    v_mfma_f32_32x32x16_bf16 a[48:63], v[132:135], v[104:107], a[48:63]
    v_mfma_f32_32x32x16_bf16 a[0:15], v[136:139], v[108:111], a[0:15]
    v_mfma_f32_32x32x16_bf16 a[16:31], v[140:143], v[108:111], a[16:31]
    v_mfma_f32_32x32x16_bf16 a[32:47], v[144:147], v[108:111], a[32:47]
    v_mfma_f32_32x32x16_bf16 a[48:63], v[148:151], v[108:111], a[48:63]
    v_mfma_f32_32x32x16_bf16 a[0:15], v[152:155], v[112:115], a[0:15]
    v_mfma_f32_32x32x16_bf16 a[16:31], v[156:159], v[112:115], a[16:31]
    v_mfma_f32_32x32x16_bf16 a[32:47], v[160:163], v[112:115], a[32:47]
    v_mfma_f32_32x32x16_bf16 a[48:63], v[164:167], v[112:115], a[48:63]
    v_mfma_f32_32x32x16_bf16 a[0:15], v[168:171], v[116:119], a[0:15]
    v_mfma_f32_32x32x16_bf16 a[16:31], v[172:175], v[116:119], a[16:31]
    v_mfma_f32_32x32x16_bf16 a[32:47], v[176:179], v[116:119], a[32:47]
    v_mfma_f32_32x32x16_bf16 a[48:63], v[180:183], v[116:119], a[48:63]
    s_nop 15
    v_accvgpr_read_b32 v16, a0
    v_accvgpr_read_b32 v17, a1
    v_accvgpr_read_b32 v18, a2
    v_accvgpr_read_b32 v19, a3
    v_cvt_pk_bf16_f32 v192, v16, v17
    v_cvt_pk_bf16_f32 v193, v18, v19
    v_accvgpr_read_b32 v16, a4
    v_accvgpr_read_b32 v17, a5
    v_accvgpr_read_b32 v18, a6
    v_accvgpr_read_b32 v19, a7
    v_cvt_pk_bf16_f32 v194, v16, v17
    v_cvt_pk_bf16_f32 v195, v18, v19
    v_accvgpr_read_b32 v16, a8
    v_accvgpr_read_b32 v17, a9
    v_accvgpr_read_b32 v18, a10
    v_accvgpr_read_b32 v19, a11
    v_cvt_pk_bf16_f32 v196, v16, v17
    v_cvt_pk_bf16_f32 v197, v18, v19
    v_accvgpr_read_b32 v16, a12
    v_accvgpr_read_b32 v17, a13
    v_accvgpr_read_b32 v18, a14
    v_accvgpr_read_b32 v19, a15
    v_cvt_pk_bf16_f32 v198, v16, v17
    v_cvt_pk_bf16_f32 v199, v18, v19
    v_accvgpr_read_b32 v16, a16
    v_accvgpr_read_b32 v17, a17
    v_accvgpr_read_b32 v18, a18
    v_accvgpr_read_b32 v19, a19
    v_cvt_pk_bf16_f32 v200, v16, v17
    v_cvt_pk_bf16_f32 v201, v18, v19
    v_accvgpr_read_b32 v16, a20
    v_accvgpr_read_b32 v17, a21
    v_accvgpr_read_b32 v18, a22
    v_accvgpr_read_b32 v19, a23
    v_cvt_pk_bf16_f32 v202, v16, v17
    v_cvt_pk_bf16_f32 v203, v18, v19
    v_accvgpr_read_b32 v16, a24
    v_accvgpr_read_b32 v17, a25
    v_accvgpr_read_b32 v18, a26
    v_accvgpr_read_b32 v19, a27
    v_cvt_pk_bf16_f32 v204, v16, v17
    v_cvt_pk_bf16_f32 v205, v18, v19
    v_accvgpr_read_b32 v16, a28
    v_accvgpr_read_b32 v17, a29
    v_accvgpr_read_b32 v18, a30
    v_accvgpr_read_b32 v19, a31
    v_cvt_pk_bf16_f32 v206, v16, v17
    v_cvt_pk_bf16_f32 v207, v18, v19
    v_accvgpr_read_b32 v16, a32
    v_accvgpr_read_b32 v17, a33
    v_accvgpr_read_b32 v18, a34
    v_accvgpr_read_b32 v19, a35
    v_cvt_pk_bf16_f32 v208, v16, v17
    v_cvt_pk_bf16_f32 v209, v18, v19
    v_accvgpr_read_b32 v16, a36
    v_accvgpr_read_b32 v17, a37
    v_accvgpr_read_b32 v18, a38
    v_accvgpr_read_b32 v19, a39
    v_cvt_pk_bf16_f32 v210, v16, v17
    v_cvt_pk_bf16_f32 v211, v18, v19
    v_accvgpr_read_b32 v16, a40
    v_accvgpr_read_b32 v17, a41
    v_accvgpr_read_b32 v18, a42
    v_accvgpr_read_b32 v19, a43
    v_cvt_pk_bf16_f32 v212, v16, v17
    v_cvt_pk_bf16_f32 v213, v18, v19
    v_accvgpr_read_b32 v16, a44
    v_accvgpr_read_b32 v17, a45
    v_accvgpr_read_b32 v18, a46
    v_accvgpr_read_b32 v19, a47
    v_cvt_pk_bf16_f32 v214, v16, v17
    v_cvt_pk_bf16_f32 v215, v18, v19
    v_accvgpr_read_b32 v16, a48
    v_accvgpr_read_b32 v17, a49
    v_accvgpr_read_b32 v18, a50
    v_accvgpr_read_b32 v19, a51
    v_cvt_pk_bf16_f32 v216, v16, v17
    v_cvt_pk_bf16_f32 v217, v18, v19
    v_accvgpr_read_b32 v16, a52
    v_accvgpr_read_b32 v17, a53
    v_accvgpr_read_b32 v18, a54
    v_accvgpr_read_b32 v19, a55
    v_cvt_pk_bf16_f32 v218, v16, v17
    v_cvt_pk_bf16_f32 v219, v18, v19
    v_accvgpr_read_b32 v16, a56
    v_accvgpr_read_b32 v17, a57
    v_accvgpr_read_b32 v18, a58
    v_accvgpr_read_b32 v19, a59
    v_cvt_pk_bf16_f32 v220, v16, v17
    v_cvt_pk_bf16_f32 v221, v18, v19
    v_accvgpr_read_b32 v16, a60
    v_accvgpr_read_b32 v17, a61
    v_accvgpr_read_b32 v18, a62
    v_accvgpr_read_b32 v19, a63
    v_cvt_pk_bf16_f32 v222, v16, v17
    v_cvt_pk_bf16_f32 v223, v18, v19
    s_mov_b32 s68, 4096
    buffer_store_dwordx4 v[192:195], v12, s[92:95], 0 offen offset:0 sc1
    buffer_store_dwordx4 v[196:199], v12, s[92:95], 0 offen offset:1024 sc1
    buffer_store_dwordx4 v[200:203], v12, s[92:95], 0 offen offset:2048 sc1
    buffer_store_dwordx4 v[204:207], v12, s[92:95], 0 offen offset:3072 sc1
    buffer_store_dwordx4 v[208:211], v12, s[92:95], s68 offen offset:0 sc1
    buffer_store_dwordx4 v[212:215], v12, s[92:95], s68 offen offset:1024 sc1
    buffer_store_dwordx4 v[216:219], v12, s[92:95], s68 offen offset:2048 sc1
    buffer_store_dwordx4 v[220:223], v12, s[92:95], s68 offen offset:3072 sc1
    s_barrier
    s_lshr_b32 s6, s42, 2
    s_lshl_b32 s6, s6, 3
    s_lshr_b32 s68, s43, 1
    s_add_u32 s6, s6, s68
    s_and_b32 s68, s42, 3
    s_and_b32 s69, s43, 1
    s_lshl_b32 s13, s68, 1
    s_add_u32 s13, s13, s69
    s_lshl_b32 s10, s13, 2
    s_add_u32 s10, s10, s3
    s_lshl_b32 s7, s6, 2
    s_add_u32 s7, s7, s68
    s_lshl_b32 s9, s69, 3
    s_and_b32 s68, s6, 1
    s_lshl_b32 s68, s68, 3
    s_add_u32 s13, s13, s68

    s_lshl_b32 s68, s7, 17
    s_add_u32 s52, s18, s68
    s_addc_u32 s53, s19, 0
    s_mov_b32 s54, 0x20000
    s_mov_b32 s55, 0x00020000
    s_add_u32 s56, s20, s68
    s_addc_u32 s57, s21, 0
    s_mov_b32 s58, 0x20000
    s_mov_b32 s59, 0x00020000
    s_add_u32 s60, s40, 0xc00000
    s_addc_u32 s61, s41, 0
    s_mov_b32 s62, 0x400000
    s_mov_b32 s63, 0x00020000
    s_mov_b32 s64, s40
    s_mov_b32 s65, s41
    s_mov_b32 s66, 0x400000
    s_mov_b32 s67, 0x00020000
    s_lshl_b32 s72, s3, 11
    s_mov_b32 s73, s9
    s_mov_b32 s74, s9
    s_mov_b32 s76, 0x427af233
    v_lshrrev_b32 v32, 4, v0
    v_and_b32 v33, 15, v0
    v_lshlrev_b32 v36, 2, v32
    v_xor_b32 v36, v36, v33
    v_lshlrev_b32 v36, 4, v36
    v_lshl_add_u32 v8, v32, 8, v36
    v_xor_b32 v36, v33, v32
    v_lshlrev_b32 v36, 4, v36
    v_lshl_add_u32 v4, v32, 8, v36
    s_and_b32 s68, s3, 1
    s_lshl_b32 s68, s68, 7
    v_xor_b32 v4, s68, v4
    v_xor_b32 v5, 64, v4

    s_and_b32 s69, s73, 15
    s_lshl_b32 s69, s69, 13
    s_add_u32 s73, s73, 1
    s_add_u32 m0, s72, 0
    s_add_u32 s68, s69, s72
    buffer_load_dwordx4 v4, s[52:55], s68 offen lds
    buffer_load_dwordx4 v5, s[52:55], s68 offen offset:1024 lds
    s_and_b32 s69, s73, 15
    s_lshl_b32 s69, s69, 13
    s_add_u32 s73, s73, 1
    s_add_u32 m0, s72, 8192
    s_add_u32 s68, s69, s72
    buffer_load_dwordx4 v4, s[52:55], s68 offen lds
    buffer_load_dwordx4 v5, s[52:55], s68 offen offset:1024 lds
    s_and_b32 s69, s74, 15
    s_lshl_b32 s69, s69, 13
    s_add_u32 s74, s74, 1
    s_add_u32 m0, s72, 32768
    s_add_u32 s68, s69, s72
    buffer_load_dwordx4 v8, s[56:59], s68 offen lds
    buffer_load_dwordx4 v8, s[56:59], s68 offen offset:1024 lds
    s_and_b32 s69, s73, 15
    s_lshl_b32 s69, s69, 13
    s_add_u32 s73, s73, 1
    s_add_u32 m0, s72, 16384
    s_add_u32 s68, s69, s72
    buffer_load_dwordx4 v4, s[52:55], s68 offen lds
    buffer_load_dwordx4 v5, s[52:55], s68 offen offset:1024 lds
    s_and_b32 s69, s74, 15
    s_lshl_b32 s69, s69, 13
    s_add_u32 s74, s74, 1
    s_add_u32 m0, s72, 40960
    s_add_u32 s68, s69, s72
    buffer_load_dwordx4 v8, s[56:59], s68 offen lds
    buffer_load_dwordx4 v8, s[56:59], s68 offen offset:1024 lds
    s_and_b32 s69, s73, 15
    s_lshl_b32 s69, s69, 13
    s_add_u32 s73, s73, 1
    s_add_u32 m0, s72, 24576
    s_add_u32 s68, s69, s72
    buffer_load_dwordx4 v4, s[52:55], s68 offen lds
    buffer_load_dwordx4 v5, s[52:55], s68 offen offset:1024 lds
    s_and_b32 s69, s74, 15
    s_lshl_b32 s69, s69, 13
    s_add_u32 s74, s74, 1
    s_add_u32 m0, s72, 49152
    s_add_u32 s68, s69, s72
    buffer_load_dwordx4 v8, s[56:59], s68 offen lds
    buffer_load_dwordx4 v8, s[56:59], s68 offen offset:1024 lds
    v_and_b32 v32, 31, v0
    v_lshrrev_b32 v33, 5, v0
    v_and_b32 v34, 15, v32
    v_xor_b32 v34, v34, v33
    v_lshlrev_b32 v34, 4, v34
    v_lshl_add_u32 v34, v32, 8, v34

    v_xor_b32 v17, 0, v34
    v_xor_b32 v18, 32, v34
    v_xor_b32 v19, 64, v34
    v_xor_b32 v20, 96, v34
    v_xor_b32 v21, 128, v34
    v_xor_b32 v22, 160, v34
    v_xor_b32 v23, 192, v34
    v_xor_b32 v24, 224, v34
    v_bfe_u32 v32, v0, 4, 1
    v_bfe_u32 v34, v0, 2, 2
    v_and_b32 v35, 1, v0
    v_bfe_u32 v36, v0, 1, 1
    v_lshl_add_u32 v37, v33, 2, v34
    v_lshlrev_b32 v37, 8, v37
    v_lshl_add_u32 v37, v35, 5, v37
    v_lshl_add_u32 v37, v32, 4, v37
    v_lshl_add_u32 v37, v36, 3, v37
    v_lshl_add_u32 v37, v34, 6, v37

    v_xor_b32 v25, 0, v37
    v_xor_b32 v26, 64, v37
    v_xor_b32 v27, 128, v37
    v_xor_b32 v28, 192, v37
    s_lshl_b32 s68, s6, 5
    s_add_u32 s68, s68, s10
    s_lshl_b32 s68, s68, 13
    v_lshlrev_b32 v37, 4, v0
    v_add_u32 v30, s68, v37
    v_and_b32 v32, 31, v0
    v_lshlrev_b32 v32, 13, v32
    v_lshl_add_u32 v32, v33, 5, v32
    s_lshl_b32 s68, s6, 18
    s_lshl_b32 s69, s10, 8
    s_add_u32 s68, s68, s69
    v_add_u32 v31, s68, v32
    v_mov_b32 v248, 0xff7fffff
    v_mov_b32 v251, 0xff7fffff
    v_mov_b32 v250, 0
    v_mov_b32 v249, 0

    v_mov_b32 v72, 0
    v_mov_b32 v73, 0
    v_mov_b32 v74, 0
    v_mov_b32 v75, 0
    v_mov_b32 v76, 0
    v_mov_b32 v77, 0
    v_mov_b32 v78, 0
    v_mov_b32 v79, 0
    v_mov_b32 v80, 0
    v_mov_b32 v81, 0
    v_mov_b32 v82, 0
    v_mov_b32 v83, 0
    v_mov_b32 v84, 0
    v_mov_b32 v85, 0
    v_mov_b32 v86, 0
    v_mov_b32 v87, 0
    v_mov_b32 v88, 0
    v_mov_b32 v89, 0
    v_mov_b32 v90, 0
    v_mov_b32 v91, 0
    v_mov_b32 v92, 0
    v_mov_b32 v93, 0
    v_mov_b32 v94, 0
    v_mov_b32 v95, 0
    v_mov_b32 v96, 0
    v_mov_b32 v97, 0
    v_mov_b32 v98, 0
    v_mov_b32 v99, 0
    v_mov_b32 v100, 0
    v_mov_b32 v101, 0
    v_mov_b32 v102, 0
    v_mov_b32 v103, 0
    v_mov_b32 v104, 0
    v_mov_b32 v105, 0
    v_mov_b32 v106, 0
    v_mov_b32 v107, 0
    v_mov_b32 v108, 0
    v_mov_b32 v109, 0
    v_mov_b32 v110, 0
    v_mov_b32 v111, 0
    v_mov_b32 v112, 0
    v_mov_b32 v113, 0
    v_mov_b32 v114, 0
    v_mov_b32 v115, 0
    v_mov_b32 v116, 0
    v_mov_b32 v117, 0
    v_mov_b32 v118, 0
    v_mov_b32 v119, 0
    v_mov_b32 v120, 0
    v_mov_b32 v121, 0
    v_mov_b32 v122, 0
    v_mov_b32 v123, 0
    v_mov_b32 v124, 0
    v_mov_b32 v125, 0
    v_mov_b32 v126, 0
    v_mov_b32 v127, 0
    v_mov_b32 v128, 0
    v_mov_b32 v129, 0
    v_mov_b32 v130, 0
    v_mov_b32 v131, 0
    v_mov_b32 v132, 0
    v_mov_b32 v133, 0
    v_mov_b32 v134, 0
    v_mov_b32 v135, 0
    s_waitcnt vmcnt(14)
    v_mov_b32 v14, 1
    v_mov_b32 v15, 0
    s_mov_b64 exec, 1
    buffer_store_dword v14, v15, s[96:99], s15 offen sc1
    s_mov_b64 exec, -1

    v_mov_b32 v33, 0
    s_lshl_b32 s69, s2, 8
    s_lshl_b32 s68, s3, 2
    s_add_u32 s69, s69, s68

L_poll_14:
    buffer_load_dword v32, v33, s[96:99], s69 offen sc1
    s_waitcnt vmcnt(0)
    v_readfirstlane_b32 s68, v32
    s_cmp_eq_u32 s68, 1
    s_cbranch_scc1 L_polld_15
    s_sleep 8
    s_branch L_poll_14

L_polld_15:
    s_mov_b32 s68, 4096
    buffer_load_dwordx4 v[40:43], v30, s[60:63], 0 offen offset:0 sc1
    buffer_load_dwordx4 v[44:47], v30, s[60:63], 0 offen offset:1024 sc1
    buffer_load_dwordx4 v[48:51], v30, s[60:63], 0 offen offset:2048 sc1
    buffer_load_dwordx4 v[52:55], v30, s[60:63], 0 offen offset:3072 sc1
    buffer_load_dwordx4 v[56:59], v30, s[60:63], s68 offen offset:0 sc1
    buffer_load_dwordx4 v[60:63], v30, s[60:63], s68 offen offset:1024 sc1
    buffer_load_dwordx4 v[64:67], v30, s[60:63], s68 offen offset:2048 sc1
    buffer_load_dwordx4 v[68:71], v30, s[60:63], s68 offen offset:3072 sc1
    s_waitcnt vmcnt(0)
    s_barrier
    ds_read_b128 v[168:171], v17 offset:0
    ds_read_b128 v[172:175], v18 offset:0
    ds_read_b128 v[176:179], v19 offset:0
    ds_read_b128 v[180:183], v20 offset:0
    ds_read_b128 v[184:187], v21 offset:0
    ds_read_b128 v[188:191], v22 offset:0
    ds_read_b128 v[192:195], v23 offset:0
    ds_read_b128 v[196:199], v24 offset:0
    s_waitcnt lgkmcnt(0)
    v_mfma_f32_32x32x16_bf16 v[136:151], v[168:171], v[40:43], 0
    v_mfma_f32_32x32x16_bf16 v[136:151], v[172:175], v[44:47], v[136:151]
    v_mfma_f32_32x32x16_bf16 v[136:151], v[176:179], v[48:51], v[136:151]
    v_mfma_f32_32x32x16_bf16 v[136:151], v[180:183], v[52:55], v[136:151]
    v_mfma_f32_32x32x16_bf16 v[136:151], v[184:187], v[56:59], v[136:151]
    v_mfma_f32_32x32x16_bf16 v[136:151], v[188:191], v[60:63], v[136:151]
    v_mfma_f32_32x32x16_bf16 v[136:151], v[192:195], v[64:67], v[136:151]
    v_mfma_f32_32x32x16_bf16 v[136:151], v[196:199], v[68:71], v[136:151]
    ds_read_b128 v[168:171], v17 offset:8192
    ds_read_b128 v[172:175], v18 offset:8192
    ds_read_b128 v[176:179], v19 offset:8192
    ds_read_b128 v[180:183], v20 offset:8192
    ds_read_b128 v[184:187], v21 offset:8192
    ds_read_b128 v[188:191], v22 offset:8192
    ds_read_b128 v[192:195], v23 offset:8192
    ds_read_b128 v[196:199], v24 offset:8192
    s_barrier
    s_and_b32 s69, s73, 15
    s_lshl_b32 s69, s69, 13
    s_add_u32 s73, s73, 1
    s_add_u32 m0, s72, 0
    s_add_u32 s68, s69, s72
    buffer_load_dwordx4 v4, s[52:55], s68 offen lds
    buffer_load_dwordx4 v5, s[52:55], s68 offen offset:1024 lds
    s_mov_b32 s75, 4
L_flash:
    s_cmp_eq_u32 s75, 1
    s_cbranch_scc1 L_w0_18
    s_waitcnt vmcnt(8) lgkmcnt(0)
    s_branch L_w1_19

L_w0_18:
    s_waitcnt vmcnt(0) lgkmcnt(0)
L_w1_19:
    s_barrier
    s_nop 7
    v_max3_f32 v252, v136, v137, v138
    v_max3_f32 v252, v252, v139, v140
    v_max3_f32 v252, v252, v141, v142
    v_max3_f32 v252, v252, v143, v144
    v_max3_f32 v252, v252, v145, v146
    v_max3_f32 v252, v252, v147, v148
    v_max3_f32 v252, v252, v149, v150
    v_max_f32 v252, v252, v151
    v_mov_b32 v32, v252
    s_nop 1
    v_permlane32_swap_b32 v252, v32
    s_nop 1
    v_max_f32 v252, v252, v32
    v_cmp_gt_f32 vcc, v252, v251
    s_nop 1
    s_cbranch_vccz L_noresc_17
    v_max_f32 v252, v252, v248
    v_sub_f32 v32, v248, v252
    v_mul_f32 v32, s71, v32
    v_exp_f32 v32, v32
    v_mov_b32 v248, v252
    v_mul_f32 v250, s71, v252
    v_add_f32 v251, s76, v252
    v_mul_f32 v249, v249, v32

    v_mul_f32 v72, v72, v32
    v_mul_f32 v73, v73, v32
    v_mul_f32 v74, v74, v32
    v_mul_f32 v75, v75, v32
    v_mul_f32 v76, v76, v32
    v_mul_f32 v77, v77, v32
    v_mul_f32 v78, v78, v32
    v_mul_f32 v79, v79, v32
    v_mul_f32 v80, v80, v32
    v_mul_f32 v81, v81, v32
    v_mul_f32 v82, v82, v32
    v_mul_f32 v83, v83, v32
    v_mul_f32 v84, v84, v32
    v_mul_f32 v85, v85, v32
    v_mul_f32 v86, v86, v32
    v_mul_f32 v87, v87, v32
    v_mul_f32 v88, v88, v32
    v_mul_f32 v89, v89, v32
    v_mul_f32 v90, v90, v32
    v_mul_f32 v91, v91, v32
    v_mul_f32 v92, v92, v32
    v_mul_f32 v93, v93, v32
    v_mul_f32 v94, v94, v32
    v_mul_f32 v95, v95, v32
    v_mul_f32 v96, v96, v32
    v_mul_f32 v97, v97, v32
    v_mul_f32 v98, v98, v32
    v_mul_f32 v99, v99, v32
    v_mul_f32 v100, v100, v32
    v_mul_f32 v101, v101, v32
    v_mul_f32 v102, v102, v32
    v_mul_f32 v103, v103, v32
    v_mul_f32 v104, v104, v32
    v_mul_f32 v105, v105, v32
    v_mul_f32 v106, v106, v32
    v_mul_f32 v107, v107, v32
    v_mul_f32 v108, v108, v32
    v_mul_f32 v109, v109, v32
    v_mul_f32 v110, v110, v32
    v_mul_f32 v111, v111, v32
    v_mul_f32 v112, v112, v32
    v_mul_f32 v113, v113, v32
    v_mul_f32 v114, v114, v32
    v_mul_f32 v115, v115, v32
    v_mul_f32 v116, v116, v32
    v_mul_f32 v117, v117, v32
    v_mul_f32 v118, v118, v32
    v_mul_f32 v119, v119, v32
    v_mul_f32 v120, v120, v32
    v_mul_f32 v121, v121, v32
    v_mul_f32 v122, v122, v32
    v_mul_f32 v123, v123, v32
    v_mul_f32 v124, v124, v32
    v_mul_f32 v125, v125, v32
    v_mul_f32 v126, v126, v32
    v_mul_f32 v127, v127, v32
    v_mul_f32 v128, v128, v32
    v_mul_f32 v129, v129, v32
    v_mul_f32 v130, v130, v32
    v_mul_f32 v131, v131, v32
    v_mul_f32 v132, v132, v32
    v_mul_f32 v133, v133, v32
    v_mul_f32 v134, v134, v32
    v_mul_f32 v135, v135, v32
L_noresc_17:
    v_mfma_f32_32x32x16_bf16 v[152:167], v[168:171], v[40:43], 0
    ds_read_b64_tr_b16 v[200:201], v25 offset:32768
    ds_read_b64_tr_b16 v[202:203], v25 offset:34816
    v_fma_f32 v136, v136, s71, -v250
    v_fma_f32 v137, v137, s71, -v250
    v_fma_f32 v138, v138, s71, -v250
    s_and_b32 s69, s74, 15
    s_lshl_b32 s69, s69, 13
    s_add_u32 s74, s74, 1
    s_add_u32 m0, s72, 57344
    s_add_u32 s68, s69, s72
    buffer_load_dwordx4 v8, s[56:59], s68 offen lds
    buffer_load_dwordx4 v8, s[56:59], s68 offen offset:1024 lds
    v_mfma_f32_32x32x16_bf16 v[152:167], v[172:175], v[44:47], v[152:167]
    ds_read_b64_tr_b16 v[204:205], v26 offset:32768
    ds_read_b64_tr_b16 v[206:207], v26 offset:34816
    v_fma_f32 v139, v139, s71, -v250
    v_fma_f32 v140, v140, s71, -v250
    v_fma_f32 v141, v141, s71, -v250
    v_fma_f32 v142, v142, s71, -v250
    v_mfma_f32_32x32x16_bf16 v[152:167], v[176:179], v[48:51], v[152:167]
    ds_read_b64_tr_b16 v[208:209], v27 offset:32768
    ds_read_b64_tr_b16 v[210:211], v27 offset:34816
    v_fma_f32 v143, v143, s71, -v250
    v_exp_f32 v136, v136
    v_exp_f32 v137, v137
    s_cmp_eq_u32 s75, 1
    s_cbranch_scc1 L_nod_20
    s_and_b32 s69, s73, 15
    s_lshl_b32 s69, s69, 13
    s_add_u32 s73, s73, 1
    s_add_u32 m0, s72, 8192
    s_add_u32 s68, s69, s72
    buffer_load_dwordx4 v4, s[52:55], s68 offen lds
    buffer_load_dwordx4 v5, s[52:55], s68 offen offset:1024 lds
L_nod_20:
    v_mfma_f32_32x32x16_bf16 v[152:167], v[180:183], v[52:55], v[152:167]
    ds_read_b64_tr_b16 v[212:213], v28 offset:32768
    ds_read_b64_tr_b16 v[214:215], v28 offset:34816
    v_exp_f32 v138, v138
    v_exp_f32 v139, v139
    v_exp_f32 v140, v140
    v_exp_f32 v141, v141
    v_mfma_f32_32x32x16_bf16 v[152:167], v[184:187], v[56:59], v[152:167]
    ds_read_b64_tr_b16 v[216:217], v25 offset:36864
    ds_read_b64_tr_b16 v[218:219], v25 offset:38912
    v_exp_f32 v142, v142
    v_exp_f32 v143, v143
    v_fma_f32 v144, v144, s71, -v250
    v_mfma_f32_32x32x16_bf16 v[152:167], v[188:191], v[60:63], v[152:167]
    ds_read_b64_tr_b16 v[220:221], v26 offset:36864
    ds_read_b64_tr_b16 v[222:223], v26 offset:38912
    v_fma_f32 v145, v145, s71, -v250
    v_fma_f32 v146, v146, s71, -v250
    v_fma_f32 v147, v147, s71, -v250
    v_fma_f32 v148, v148, s71, -v250
    v_mfma_f32_32x32x16_bf16 v[152:167], v[192:195], v[64:67], v[152:167]
    ds_read_b64_tr_b16 v[224:225], v27 offset:36864
    ds_read_b64_tr_b16 v[226:227], v27 offset:38912
    v_fma_f32 v149, v149, s71, -v250
    v_fma_f32 v150, v150, s71, -v250
    v_fma_f32 v151, v151, s71, -v250
    v_mfma_f32_32x32x16_bf16 v[152:167], v[196:199], v[68:71], v[152:167]
    ds_read_b64_tr_b16 v[228:229], v28 offset:36864
    ds_read_b64_tr_b16 v[230:231], v28 offset:38912
    v_cvt_pk_bf16_f32 v232, v136, v137
    v_cvt_pk_bf16_f32 v233, v138, v139
    v_cvt_pk_bf16_f32 v234, v140, v141
    v_cvt_pk_bf16_f32 v235, v142, v143
    s_waitcnt lgkmcnt(0)
    s_nop 1
    v_mfma_f32_32x32x16_bf16 v[72:87], v[200:203], v[232:235], v[72:87]
    v_exp_f32 v144, v144
    v_exp_f32 v145, v145
    v_exp_f32 v146, v146
    v_mfma_f32_32x32x16_bf16 v[88:103], v[204:207], v[232:235], v[88:103]
    v_exp_f32 v147, v147
    v_exp_f32 v148, v148
    v_exp_f32 v149, v149
    v_mfma_f32_32x32x16_bf16 v[104:119], v[208:211], v[232:235], v[104:119]
    v_exp_f32 v150, v150
    v_exp_f32 v151, v151
    s_nop 0
    v_mfma_f32_32x32x16_bf16 v[120:135], v[212:215], v[232:235], v[120:135]
    v_cvt_pk_bf16_f32 v236, v144, v145
    v_cvt_pk_bf16_f32 v237, v146, v147
    v_cvt_pk_bf16_f32 v238, v148, v149
    v_cvt_pk_bf16_f32 v239, v150, v151
    s_nop 1
    v_mfma_f32_32x32x16_bf16 v[72:87], v[216:219], v[236:239], v[72:87]
    ds_read_b128 v[168:171], v17 offset:16384
    ds_read_b128 v[172:175], v18 offset:16384
    v_add_f32 v136, v136, v137
    v_add_f32 v138, v138, v139
    v_add_f32 v140, v140, v141
    v_add_f32 v142, v142, v143
    v_mfma_f32_32x32x16_bf16 v[88:103], v[220:223], v[236:239], v[88:103]
    ds_read_b128 v[176:179], v19 offset:16384
    ds_read_b128 v[180:183], v20 offset:16384
    v_add_f32 v144, v144, v145
    v_add_f32 v146, v146, v147
    v_add_f32 v148, v148, v149
    v_add_f32 v150, v150, v151
    v_mfma_f32_32x32x16_bf16 v[104:119], v[224:227], v[236:239], v[104:119]
    ds_read_b128 v[184:187], v21 offset:16384
    ds_read_b128 v[188:191], v22 offset:16384
    v_add_f32 v136, v136, v138
    v_add_f32 v140, v140, v142
    v_add_f32 v144, v144, v146
    v_add_f32 v148, v148, v150
    v_mfma_f32_32x32x16_bf16 v[120:135], v[228:231], v[236:239], v[120:135]
    ds_read_b128 v[192:195], v23 offset:16384
    ds_read_b128 v[196:199], v24 offset:16384
    v_add_f32 v136, v136, v140
    v_add_f32 v144, v144, v148
    v_add_f32 v136, v136, v144
    v_add_f32 v249, v249, v136
    s_cmp_eq_u32 s75, 1
    s_cbranch_scc1 L_w0_23
    s_waitcnt vmcnt(8) lgkmcnt(0)
    s_branch L_w1_24

L_w0_23:
    s_waitcnt vmcnt(0) lgkmcnt(0)
L_w1_24:
    s_barrier
    s_nop 7
    v_max3_f32 v252, v152, v153, v154
    v_max3_f32 v252, v252, v155, v156
    v_max3_f32 v252, v252, v157, v158
    v_max3_f32 v252, v252, v159, v160
    v_max3_f32 v252, v252, v161, v162
    v_max3_f32 v252, v252, v163, v164
    v_max3_f32 v252, v252, v165, v166
    v_max_f32 v252, v252, v167
    v_mov_b32 v32, v252
    s_nop 1
    v_permlane32_swap_b32 v252, v32
    s_nop 1
    v_max_f32 v252, v252, v32
    v_cmp_gt_f32 vcc, v252, v251
    s_nop 1
    s_cbranch_vccz L_noresc_22
    v_max_f32 v252, v252, v248
    v_sub_f32 v32, v248, v252
    v_mul_f32 v32, s71, v32
    v_exp_f32 v32, v32
    v_mov_b32 v248, v252
    v_mul_f32 v250, s71, v252
    v_add_f32 v251, s76, v252
    v_mul_f32 v249, v249, v32

    v_mul_f32 v72, v72, v32
    v_mul_f32 v73, v73, v32
    v_mul_f32 v74, v74, v32
    v_mul_f32 v75, v75, v32
    v_mul_f32 v76, v76, v32
    v_mul_f32 v77, v77, v32
    v_mul_f32 v78, v78, v32
    v_mul_f32 v79, v79, v32
    v_mul_f32 v80, v80, v32
    v_mul_f32 v81, v81, v32
    v_mul_f32 v82, v82, v32
    v_mul_f32 v83, v83, v32
    v_mul_f32 v84, v84, v32
    v_mul_f32 v85, v85, v32
    v_mul_f32 v86, v86, v32
    v_mul_f32 v87, v87, v32
    v_mul_f32 v88, v88, v32
    v_mul_f32 v89, v89, v32
    v_mul_f32 v90, v90, v32
    v_mul_f32 v91, v91, v32
    v_mul_f32 v92, v92, v32
    v_mul_f32 v93, v93, v32
    v_mul_f32 v94, v94, v32
    v_mul_f32 v95, v95, v32
    v_mul_f32 v96, v96, v32
    v_mul_f32 v97, v97, v32
    v_mul_f32 v98, v98, v32
    v_mul_f32 v99, v99, v32
    v_mul_f32 v100, v100, v32
    v_mul_f32 v101, v101, v32
    v_mul_f32 v102, v102, v32
    v_mul_f32 v103, v103, v32
    v_mul_f32 v104, v104, v32
    v_mul_f32 v105, v105, v32
    v_mul_f32 v106, v106, v32
    v_mul_f32 v107, v107, v32
    v_mul_f32 v108, v108, v32
    v_mul_f32 v109, v109, v32
    v_mul_f32 v110, v110, v32
    v_mul_f32 v111, v111, v32
    v_mul_f32 v112, v112, v32
    v_mul_f32 v113, v113, v32
    v_mul_f32 v114, v114, v32
    v_mul_f32 v115, v115, v32
    v_mul_f32 v116, v116, v32
    v_mul_f32 v117, v117, v32
    v_mul_f32 v118, v118, v32
    v_mul_f32 v119, v119, v32
    v_mul_f32 v120, v120, v32
    v_mul_f32 v121, v121, v32
    v_mul_f32 v122, v122, v32
    v_mul_f32 v123, v123, v32
    v_mul_f32 v124, v124, v32
    v_mul_f32 v125, v125, v32
    v_mul_f32 v126, v126, v32
    v_mul_f32 v127, v127, v32
    v_mul_f32 v128, v128, v32
    v_mul_f32 v129, v129, v32
    v_mul_f32 v130, v130, v32
    v_mul_f32 v131, v131, v32
    v_mul_f32 v132, v132, v32
    v_mul_f32 v133, v133, v32
    v_mul_f32 v134, v134, v32
    v_mul_f32 v135, v135, v32
L_noresc_22:
    v_mfma_f32_32x32x16_bf16 v[136:151], v[168:171], v[40:43], 0
    ds_read_b64_tr_b16 v[200:201], v25 offset:40960
    ds_read_b64_tr_b16 v[202:203], v25 offset:43008
    v_fma_f32 v152, v152, s71, -v250
    v_fma_f32 v153, v153, s71, -v250
    v_fma_f32 v154, v154, s71, -v250
    s_cmp_eq_u32 s75, 1
    s_cbranch_scc1 L_nod_25
    s_and_b32 s69, s74, 15
    s_lshl_b32 s69, s69, 13
    s_add_u32 s74, s74, 1
    s_add_u32 m0, s72, 32768
    s_add_u32 s68, s69, s72
    buffer_load_dwordx4 v8, s[56:59], s68 offen lds
    buffer_load_dwordx4 v8, s[56:59], s68 offen offset:1024 lds
L_nod_25:
    v_mfma_f32_32x32x16_bf16 v[136:151], v[172:175], v[44:47], v[136:151]
    ds_read_b64_tr_b16 v[204:205], v26 offset:40960
    ds_read_b64_tr_b16 v[206:207], v26 offset:43008
    v_fma_f32 v155, v155, s71, -v250
    v_fma_f32 v156, v156, s71, -v250
    v_fma_f32 v157, v157, s71, -v250
    v_fma_f32 v158, v158, s71, -v250
    v_mfma_f32_32x32x16_bf16 v[136:151], v[176:179], v[48:51], v[136:151]
    ds_read_b64_tr_b16 v[208:209], v27 offset:40960
    ds_read_b64_tr_b16 v[210:211], v27 offset:43008
    v_fma_f32 v159, v159, s71, -v250
    v_exp_f32 v152, v152
    v_exp_f32 v153, v153
    s_cmp_eq_u32 s75, 1
    s_cbranch_scc1 L_nod_26
    s_and_b32 s69, s73, 15
    s_lshl_b32 s69, s69, 13
    s_add_u32 s73, s73, 1
    s_add_u32 m0, s72, 16384
    s_add_u32 s68, s69, s72
    buffer_load_dwordx4 v4, s[52:55], s68 offen lds
    buffer_load_dwordx4 v5, s[52:55], s68 offen offset:1024 lds
L_nod_26:
    v_mfma_f32_32x32x16_bf16 v[136:151], v[180:183], v[52:55], v[136:151]
    ds_read_b64_tr_b16 v[212:213], v28 offset:40960
    ds_read_b64_tr_b16 v[214:215], v28 offset:43008
    v_exp_f32 v154, v154
    v_exp_f32 v155, v155
    v_exp_f32 v156, v156
    v_exp_f32 v157, v157
    v_mfma_f32_32x32x16_bf16 v[136:151], v[184:187], v[56:59], v[136:151]
    ds_read_b64_tr_b16 v[216:217], v25 offset:45056
    ds_read_b64_tr_b16 v[218:219], v25 offset:47104
    v_exp_f32 v158, v158
    v_exp_f32 v159, v159
    v_fma_f32 v160, v160, s71, -v250
    v_mfma_f32_32x32x16_bf16 v[136:151], v[188:191], v[60:63], v[136:151]
    ds_read_b64_tr_b16 v[220:221], v26 offset:45056
    ds_read_b64_tr_b16 v[222:223], v26 offset:47104
    v_fma_f32 v161, v161, s71, -v250
    v_fma_f32 v162, v162, s71, -v250
    v_fma_f32 v163, v163, s71, -v250
    v_fma_f32 v164, v164, s71, -v250
    v_mfma_f32_32x32x16_bf16 v[136:151], v[192:195], v[64:67], v[136:151]
    ds_read_b64_tr_b16 v[224:225], v27 offset:45056
    ds_read_b64_tr_b16 v[226:227], v27 offset:47104
    v_fma_f32 v165, v165, s71, -v250
    v_fma_f32 v166, v166, s71, -v250
    v_fma_f32 v167, v167, s71, -v250
    v_mfma_f32_32x32x16_bf16 v[136:151], v[196:199], v[68:71], v[136:151]
    ds_read_b64_tr_b16 v[228:229], v28 offset:45056
    ds_read_b64_tr_b16 v[230:231], v28 offset:47104
    v_cvt_pk_bf16_f32 v232, v152, v153
    v_cvt_pk_bf16_f32 v233, v154, v155
    v_cvt_pk_bf16_f32 v234, v156, v157
    v_cvt_pk_bf16_f32 v235, v158, v159
    s_waitcnt lgkmcnt(0)
    s_nop 1
    v_mfma_f32_32x32x16_bf16 v[72:87], v[200:203], v[232:235], v[72:87]
    v_exp_f32 v160, v160
    v_exp_f32 v161, v161
    v_exp_f32 v162, v162
    v_mfma_f32_32x32x16_bf16 v[88:103], v[204:207], v[232:235], v[88:103]
    v_exp_f32 v163, v163
    v_exp_f32 v164, v164
    v_exp_f32 v165, v165
    v_mfma_f32_32x32x16_bf16 v[104:119], v[208:211], v[232:235], v[104:119]
    v_exp_f32 v166, v166
    v_exp_f32 v167, v167
    s_nop 0
    v_mfma_f32_32x32x16_bf16 v[120:135], v[212:215], v[232:235], v[120:135]
    v_cvt_pk_bf16_f32 v236, v160, v161
    v_cvt_pk_bf16_f32 v237, v162, v163
    v_cvt_pk_bf16_f32 v238, v164, v165
    v_cvt_pk_bf16_f32 v239, v166, v167
    s_nop 1
    v_mfma_f32_32x32x16_bf16 v[72:87], v[216:219], v[236:239], v[72:87]
    ds_read_b128 v[168:171], v17 offset:24576
    ds_read_b128 v[172:175], v18 offset:24576
    v_add_f32 v152, v152, v153
    v_add_f32 v154, v154, v155
    v_add_f32 v156, v156, v157
    v_add_f32 v158, v158, v159
    v_mfma_f32_32x32x16_bf16 v[88:103], v[220:223], v[236:239], v[88:103]
    ds_read_b128 v[176:179], v19 offset:24576
    ds_read_b128 v[180:183], v20 offset:24576
    v_add_f32 v160, v160, v161
    v_add_f32 v162, v162, v163
    v_add_f32 v164, v164, v165
    v_add_f32 v166, v166, v167
    v_mfma_f32_32x32x16_bf16 v[104:119], v[224:227], v[236:239], v[104:119]
    ds_read_b128 v[184:187], v21 offset:24576
    ds_read_b128 v[188:191], v22 offset:24576
    v_add_f32 v152, v152, v154
    v_add_f32 v156, v156, v158
    v_add_f32 v160, v160, v162
    v_add_f32 v164, v164, v166
    v_mfma_f32_32x32x16_bf16 v[120:135], v[228:231], v[236:239], v[120:135]
    ds_read_b128 v[192:195], v23 offset:24576
    ds_read_b128 v[196:199], v24 offset:24576
    v_add_f32 v152, v152, v156
    v_add_f32 v160, v160, v164
    v_add_f32 v152, v152, v160
    v_add_f32 v249, v249, v152
    s_cmp_eq_u32 s75, 1
    s_cbranch_scc1 L_w0_29
    s_waitcnt vmcnt(8) lgkmcnt(0)
    s_branch L_w1_30

L_w0_29:
    s_waitcnt vmcnt(0) lgkmcnt(0)
L_w1_30:
    s_barrier
    s_nop 7
    v_max3_f32 v252, v136, v137, v138
    v_max3_f32 v252, v252, v139, v140
    v_max3_f32 v252, v252, v141, v142
    v_max3_f32 v252, v252, v143, v144
    v_max3_f32 v252, v252, v145, v146
    v_max3_f32 v252, v252, v147, v148
    v_max3_f32 v252, v252, v149, v150
    v_max_f32 v252, v252, v151
    v_mov_b32 v32, v252
    s_nop 1
    v_permlane32_swap_b32 v252, v32
    s_nop 1
    v_max_f32 v252, v252, v32
    v_cmp_gt_f32 vcc, v252, v251
    s_nop 1
    s_cbranch_vccz L_noresc_28
    v_max_f32 v252, v252, v248
    v_sub_f32 v32, v248, v252
    v_mul_f32 v32, s71, v32
    v_exp_f32 v32, v32
    v_mov_b32 v248, v252
    v_mul_f32 v250, s71, v252
    v_add_f32 v251, s76, v252
    v_mul_f32 v249, v249, v32

    v_mul_f32 v72, v72, v32
    v_mul_f32 v73, v73, v32
    v_mul_f32 v74, v74, v32
    v_mul_f32 v75, v75, v32
    v_mul_f32 v76, v76, v32
    v_mul_f32 v77, v77, v32
    v_mul_f32 v78, v78, v32
    v_mul_f32 v79, v79, v32
    v_mul_f32 v80, v80, v32
    v_mul_f32 v81, v81, v32
    v_mul_f32 v82, v82, v32
    v_mul_f32 v83, v83, v32
    v_mul_f32 v84, v84, v32
    v_mul_f32 v85, v85, v32
    v_mul_f32 v86, v86, v32
    v_mul_f32 v87, v87, v32
    v_mul_f32 v88, v88, v32
    v_mul_f32 v89, v89, v32
    v_mul_f32 v90, v90, v32
    v_mul_f32 v91, v91, v32
    v_mul_f32 v92, v92, v32
    v_mul_f32 v93, v93, v32
    v_mul_f32 v94, v94, v32
    v_mul_f32 v95, v95, v32
    v_mul_f32 v96, v96, v32
    v_mul_f32 v97, v97, v32
    v_mul_f32 v98, v98, v32
    v_mul_f32 v99, v99, v32
    v_mul_f32 v100, v100, v32
    v_mul_f32 v101, v101, v32
    v_mul_f32 v102, v102, v32
    v_mul_f32 v103, v103, v32
    v_mul_f32 v104, v104, v32
    v_mul_f32 v105, v105, v32
    v_mul_f32 v106, v106, v32
    v_mul_f32 v107, v107, v32
    v_mul_f32 v108, v108, v32
    v_mul_f32 v109, v109, v32
    v_mul_f32 v110, v110, v32
    v_mul_f32 v111, v111, v32
    v_mul_f32 v112, v112, v32
    v_mul_f32 v113, v113, v32
    v_mul_f32 v114, v114, v32
    v_mul_f32 v115, v115, v32
    v_mul_f32 v116, v116, v32
    v_mul_f32 v117, v117, v32
    v_mul_f32 v118, v118, v32
    v_mul_f32 v119, v119, v32
    v_mul_f32 v120, v120, v32
    v_mul_f32 v121, v121, v32
    v_mul_f32 v122, v122, v32
    v_mul_f32 v123, v123, v32
    v_mul_f32 v124, v124, v32
    v_mul_f32 v125, v125, v32
    v_mul_f32 v126, v126, v32
    v_mul_f32 v127, v127, v32
    v_mul_f32 v128, v128, v32
    v_mul_f32 v129, v129, v32
    v_mul_f32 v130, v130, v32
    v_mul_f32 v131, v131, v32
    v_mul_f32 v132, v132, v32
    v_mul_f32 v133, v133, v32
    v_mul_f32 v134, v134, v32
    v_mul_f32 v135, v135, v32
L_noresc_28:
    v_mfma_f32_32x32x16_bf16 v[152:167], v[168:171], v[40:43], 0
    ds_read_b64_tr_b16 v[200:201], v25 offset:49152
    ds_read_b64_tr_b16 v[202:203], v25 offset:51200
    v_fma_f32 v136, v136, s71, -v250
    v_fma_f32 v137, v137, s71, -v250
    v_fma_f32 v138, v138, s71, -v250
    s_cmp_eq_u32 s75, 1
    s_cbranch_scc1 L_nod_31
    s_and_b32 s69, s74, 15
    s_lshl_b32 s69, s69, 13
    s_add_u32 s74, s74, 1
    s_add_u32 m0, s72, 40960
    s_add_u32 s68, s69, s72
    buffer_load_dwordx4 v8, s[56:59], s68 offen lds
    buffer_load_dwordx4 v8, s[56:59], s68 offen offset:1024 lds
L_nod_31:
    v_mfma_f32_32x32x16_bf16 v[152:167], v[172:175], v[44:47], v[152:167]
    ds_read_b64_tr_b16 v[204:205], v26 offset:49152
    ds_read_b64_tr_b16 v[206:207], v26 offset:51200
    v_fma_f32 v139, v139, s71, -v250
    v_fma_f32 v140, v140, s71, -v250
    v_fma_f32 v141, v141, s71, -v250
    v_fma_f32 v142, v142, s71, -v250
    v_mfma_f32_32x32x16_bf16 v[152:167], v[176:179], v[48:51], v[152:167]
    ds_read_b64_tr_b16 v[208:209], v27 offset:49152
    ds_read_b64_tr_b16 v[210:211], v27 offset:51200
    v_fma_f32 v143, v143, s71, -v250
    v_exp_f32 v136, v136
    v_exp_f32 v137, v137
    s_cmp_eq_u32 s75, 1
    s_cbranch_scc1 L_nod_32
    s_and_b32 s69, s73, 15
    s_lshl_b32 s69, s69, 13
    s_add_u32 s73, s73, 1
    s_add_u32 m0, s72, 24576
    s_add_u32 s68, s69, s72
    buffer_load_dwordx4 v4, s[52:55], s68 offen lds
    buffer_load_dwordx4 v5, s[52:55], s68 offen offset:1024 lds
L_nod_32:
    v_mfma_f32_32x32x16_bf16 v[152:167], v[180:183], v[52:55], v[152:167]
    ds_read_b64_tr_b16 v[212:213], v28 offset:49152
    ds_read_b64_tr_b16 v[214:215], v28 offset:51200
    v_exp_f32 v138, v138
    v_exp_f32 v139, v139
    v_exp_f32 v140, v140
    v_exp_f32 v141, v141
    v_mfma_f32_32x32x16_bf16 v[152:167], v[184:187], v[56:59], v[152:167]
    ds_read_b64_tr_b16 v[216:217], v25 offset:53248
    ds_read_b64_tr_b16 v[218:219], v25 offset:55296
    v_exp_f32 v142, v142
    v_exp_f32 v143, v143
    v_fma_f32 v144, v144, s71, -v250
    v_mfma_f32_32x32x16_bf16 v[152:167], v[188:191], v[60:63], v[152:167]
    ds_read_b64_tr_b16 v[220:221], v26 offset:53248
    ds_read_b64_tr_b16 v[222:223], v26 offset:55296
    v_fma_f32 v145, v145, s71, -v250
    v_fma_f32 v146, v146, s71, -v250
    v_fma_f32 v147, v147, s71, -v250
    v_fma_f32 v148, v148, s71, -v250
    v_mfma_f32_32x32x16_bf16 v[152:167], v[192:195], v[64:67], v[152:167]
    ds_read_b64_tr_b16 v[224:225], v27 offset:53248
    ds_read_b64_tr_b16 v[226:227], v27 offset:55296
    v_fma_f32 v149, v149, s71, -v250
    v_fma_f32 v150, v150, s71, -v250
    v_fma_f32 v151, v151, s71, -v250
    v_mfma_f32_32x32x16_bf16 v[152:167], v[196:199], v[68:71], v[152:167]
    ds_read_b64_tr_b16 v[228:229], v28 offset:53248
    ds_read_b64_tr_b16 v[230:231], v28 offset:55296
    v_cvt_pk_bf16_f32 v232, v136, v137
    v_cvt_pk_bf16_f32 v233, v138, v139
    v_cvt_pk_bf16_f32 v234, v140, v141
    v_cvt_pk_bf16_f32 v235, v142, v143
    s_waitcnt lgkmcnt(0)
    s_nop 1
    v_mfma_f32_32x32x16_bf16 v[72:87], v[200:203], v[232:235], v[72:87]
    v_exp_f32 v144, v144
    v_exp_f32 v145, v145
    v_exp_f32 v146, v146
    v_mfma_f32_32x32x16_bf16 v[88:103], v[204:207], v[232:235], v[88:103]
    v_exp_f32 v147, v147
    v_exp_f32 v148, v148
    v_exp_f32 v149, v149
    v_mfma_f32_32x32x16_bf16 v[104:119], v[208:211], v[232:235], v[104:119]
    v_exp_f32 v150, v150
    v_exp_f32 v151, v151
    s_nop 0
    v_mfma_f32_32x32x16_bf16 v[120:135], v[212:215], v[232:235], v[120:135]
    v_cvt_pk_bf16_f32 v236, v144, v145
    v_cvt_pk_bf16_f32 v237, v146, v147
    v_cvt_pk_bf16_f32 v238, v148, v149
    v_cvt_pk_bf16_f32 v239, v150, v151
    s_nop 1
    v_mfma_f32_32x32x16_bf16 v[72:87], v[216:219], v[236:239], v[72:87]
    ds_read_b128 v[168:171], v17 offset:0
    ds_read_b128 v[172:175], v18 offset:0
    v_add_f32 v136, v136, v137
    v_add_f32 v138, v138, v139
    v_add_f32 v140, v140, v141
    v_add_f32 v142, v142, v143
    v_mfma_f32_32x32x16_bf16 v[88:103], v[220:223], v[236:239], v[88:103]
    ds_read_b128 v[176:179], v19 offset:0
    ds_read_b128 v[180:183], v20 offset:0
    v_add_f32 v144, v144, v145
    v_add_f32 v146, v146, v147
    v_add_f32 v148, v148, v149
    v_add_f32 v150, v150, v151
    v_mfma_f32_32x32x16_bf16 v[104:119], v[224:227], v[236:239], v[104:119]
    ds_read_b128 v[184:187], v21 offset:0
    ds_read_b128 v[188:191], v22 offset:0
    v_add_f32 v136, v136, v138
    v_add_f32 v140, v140, v142
    v_add_f32 v144, v144, v146
    v_add_f32 v148, v148, v150
    v_mfma_f32_32x32x16_bf16 v[120:135], v[228:231], v[236:239], v[120:135]
    ds_read_b128 v[192:195], v23 offset:0
    ds_read_b128 v[196:199], v24 offset:0
    v_add_f32 v136, v136, v140
    v_add_f32 v144, v144, v148
    v_add_f32 v136, v136, v144
    v_add_f32 v249, v249, v136
    s_cmp_eq_u32 s75, 1
    s_cbranch_scc1 L_w0_35
    s_waitcnt vmcnt(8) lgkmcnt(0)
    s_branch L_w1_36

L_w0_35:
    s_waitcnt vmcnt(0) lgkmcnt(0)
L_w1_36:
    s_barrier
    s_nop 7
    v_max3_f32 v252, v152, v153, v154
    v_max3_f32 v252, v252, v155, v156
    v_max3_f32 v252, v252, v157, v158
    v_max3_f32 v252, v252, v159, v160
    v_max3_f32 v252, v252, v161, v162
    v_max3_f32 v252, v252, v163, v164
    v_max3_f32 v252, v252, v165, v166
    v_max_f32 v252, v252, v167
    v_mov_b32 v32, v252
    s_nop 1
    v_permlane32_swap_b32 v252, v32
    s_nop 1
    v_max_f32 v252, v252, v32
    v_cmp_gt_f32 vcc, v252, v251
    s_nop 1
    s_cbranch_vccz L_noresc_34
    v_max_f32 v252, v252, v248
    v_sub_f32 v32, v248, v252
    v_mul_f32 v32, s71, v32
    v_exp_f32 v32, v32
    v_mov_b32 v248, v252
    v_mul_f32 v250, s71, v252
    v_add_f32 v251, s76, v252
    v_mul_f32 v249, v249, v32

    v_mul_f32 v72, v72, v32
    v_mul_f32 v73, v73, v32
    v_mul_f32 v74, v74, v32
    v_mul_f32 v75, v75, v32
    v_mul_f32 v76, v76, v32
    v_mul_f32 v77, v77, v32
    v_mul_f32 v78, v78, v32
    v_mul_f32 v79, v79, v32
    v_mul_f32 v80, v80, v32
    v_mul_f32 v81, v81, v32
    v_mul_f32 v82, v82, v32
    v_mul_f32 v83, v83, v32
    v_mul_f32 v84, v84, v32
    v_mul_f32 v85, v85, v32
    v_mul_f32 v86, v86, v32
    v_mul_f32 v87, v87, v32
    v_mul_f32 v88, v88, v32
    v_mul_f32 v89, v89, v32
    v_mul_f32 v90, v90, v32
    v_mul_f32 v91, v91, v32
    v_mul_f32 v92, v92, v32
    v_mul_f32 v93, v93, v32
    v_mul_f32 v94, v94, v32
    v_mul_f32 v95, v95, v32
    v_mul_f32 v96, v96, v32
    v_mul_f32 v97, v97, v32
    v_mul_f32 v98, v98, v32
    v_mul_f32 v99, v99, v32
    v_mul_f32 v100, v100, v32
    v_mul_f32 v101, v101, v32
    v_mul_f32 v102, v102, v32
    v_mul_f32 v103, v103, v32
    v_mul_f32 v104, v104, v32
    v_mul_f32 v105, v105, v32
    v_mul_f32 v106, v106, v32
    v_mul_f32 v107, v107, v32
    v_mul_f32 v108, v108, v32
    v_mul_f32 v109, v109, v32
    v_mul_f32 v110, v110, v32
    v_mul_f32 v111, v111, v32
    v_mul_f32 v112, v112, v32
    v_mul_f32 v113, v113, v32
    v_mul_f32 v114, v114, v32
    v_mul_f32 v115, v115, v32
    v_mul_f32 v116, v116, v32
    v_mul_f32 v117, v117, v32
    v_mul_f32 v118, v118, v32
    v_mul_f32 v119, v119, v32
    v_mul_f32 v120, v120, v32
    v_mul_f32 v121, v121, v32
    v_mul_f32 v122, v122, v32
    v_mul_f32 v123, v123, v32
    v_mul_f32 v124, v124, v32
    v_mul_f32 v125, v125, v32
    v_mul_f32 v126, v126, v32
    v_mul_f32 v127, v127, v32
    v_mul_f32 v128, v128, v32
    v_mul_f32 v129, v129, v32
    v_mul_f32 v130, v130, v32
    v_mul_f32 v131, v131, v32
    v_mul_f32 v132, v132, v32
    v_mul_f32 v133, v133, v32
    v_mul_f32 v134, v134, v32
    v_mul_f32 v135, v135, v32
L_noresc_34:
    v_mfma_f32_32x32x16_bf16 v[136:151], v[168:171], v[40:43], 0
    ds_read_b64_tr_b16 v[200:201], v25 offset:57344
    ds_read_b64_tr_b16 v[202:203], v25 offset:59392
    v_fma_f32 v152, v152, s71, -v250
    v_fma_f32 v153, v153, s71, -v250
    v_fma_f32 v154, v154, s71, -v250
    s_cmp_eq_u32 s75, 1
    s_cbranch_scc1 L_nod_37
    s_and_b32 s69, s74, 15
    s_lshl_b32 s69, s69, 13
    s_add_u32 s74, s74, 1
    s_add_u32 m0, s72, 49152
    s_add_u32 s68, s69, s72
    buffer_load_dwordx4 v8, s[56:59], s68 offen lds
    buffer_load_dwordx4 v8, s[56:59], s68 offen offset:1024 lds
L_nod_37:
    v_mfma_f32_32x32x16_bf16 v[136:151], v[172:175], v[44:47], v[136:151]
    ds_read_b64_tr_b16 v[204:205], v26 offset:57344
    ds_read_b64_tr_b16 v[206:207], v26 offset:59392
    v_fma_f32 v155, v155, s71, -v250
    v_fma_f32 v156, v156, s71, -v250
    v_fma_f32 v157, v157, s71, -v250
    v_fma_f32 v158, v158, s71, -v250
    v_mfma_f32_32x32x16_bf16 v[136:151], v[176:179], v[48:51], v[136:151]
    ds_read_b64_tr_b16 v[208:209], v27 offset:57344
    ds_read_b64_tr_b16 v[210:211], v27 offset:59392
    v_fma_f32 v159, v159, s71, -v250
    v_exp_f32 v152, v152
    v_exp_f32 v153, v153
    s_cmp_eq_u32 s75, 1
    s_cbranch_scc1 L_nod_38
    s_and_b32 s69, s73, 15
    s_lshl_b32 s69, s69, 13
    s_add_u32 s73, s73, 1
    s_add_u32 m0, s72, 0
    s_add_u32 s68, s69, s72
    buffer_load_dwordx4 v4, s[52:55], s68 offen lds
    buffer_load_dwordx4 v5, s[52:55], s68 offen offset:1024 lds
L_nod_38:
    v_mfma_f32_32x32x16_bf16 v[136:151], v[180:183], v[52:55], v[136:151]
    ds_read_b64_tr_b16 v[212:213], v28 offset:57344
    ds_read_b64_tr_b16 v[214:215], v28 offset:59392
    v_exp_f32 v154, v154
    v_exp_f32 v155, v155
    v_exp_f32 v156, v156
    v_exp_f32 v157, v157
    v_mfma_f32_32x32x16_bf16 v[136:151], v[184:187], v[56:59], v[136:151]
    ds_read_b64_tr_b16 v[216:217], v25 offset:61440
    ds_read_b64_tr_b16 v[218:219], v25 offset:63488
    v_exp_f32 v158, v158
    v_exp_f32 v159, v159
    v_fma_f32 v160, v160, s71, -v250
    v_mfma_f32_32x32x16_bf16 v[136:151], v[188:191], v[60:63], v[136:151]
    ds_read_b64_tr_b16 v[220:221], v26 offset:61440
    ds_read_b64_tr_b16 v[222:223], v26 offset:63488
    v_fma_f32 v161, v161, s71, -v250
    v_fma_f32 v162, v162, s71, -v250
    v_fma_f32 v163, v163, s71, -v250
    v_fma_f32 v164, v164, s71, -v250
    v_mfma_f32_32x32x16_bf16 v[136:151], v[192:195], v[64:67], v[136:151]
    ds_read_b64_tr_b16 v[224:225], v27 offset:61440
    ds_read_b64_tr_b16 v[226:227], v27 offset:63488
    v_fma_f32 v165, v165, s71, -v250
    v_fma_f32 v166, v166, s71, -v250
    v_fma_f32 v167, v167, s71, -v250
    v_mfma_f32_32x32x16_bf16 v[136:151], v[196:199], v[68:71], v[136:151]
    ds_read_b64_tr_b16 v[228:229], v28 offset:61440
    ds_read_b64_tr_b16 v[230:231], v28 offset:63488
    v_cvt_pk_bf16_f32 v232, v152, v153
    v_cvt_pk_bf16_f32 v233, v154, v155
    v_cvt_pk_bf16_f32 v234, v156, v157
    v_cvt_pk_bf16_f32 v235, v158, v159
    s_waitcnt lgkmcnt(0)
    s_nop 1
    v_mfma_f32_32x32x16_bf16 v[72:87], v[200:203], v[232:235], v[72:87]
    v_exp_f32 v160, v160
    v_exp_f32 v161, v161
    v_exp_f32 v162, v162
    v_mfma_f32_32x32x16_bf16 v[88:103], v[204:207], v[232:235], v[88:103]
    v_exp_f32 v163, v163
    v_exp_f32 v164, v164
    v_exp_f32 v165, v165
    v_mfma_f32_32x32x16_bf16 v[104:119], v[208:211], v[232:235], v[104:119]
    v_exp_f32 v166, v166
    v_exp_f32 v167, v167
    s_nop 0
    v_mfma_f32_32x32x16_bf16 v[120:135], v[212:215], v[232:235], v[120:135]
    v_cvt_pk_bf16_f32 v236, v160, v161
    v_cvt_pk_bf16_f32 v237, v162, v163
    v_cvt_pk_bf16_f32 v238, v164, v165
    v_cvt_pk_bf16_f32 v239, v166, v167
    s_nop 1
    v_mfma_f32_32x32x16_bf16 v[72:87], v[216:219], v[236:239], v[72:87]
    ds_read_b128 v[168:171], v17 offset:8192
    ds_read_b128 v[172:175], v18 offset:8192
    v_add_f32 v152, v152, v153
    v_add_f32 v154, v154, v155
    v_add_f32 v156, v156, v157
    v_add_f32 v158, v158, v159
    v_mfma_f32_32x32x16_bf16 v[88:103], v[220:223], v[236:239], v[88:103]
    ds_read_b128 v[176:179], v19 offset:8192
    ds_read_b128 v[180:183], v20 offset:8192
    v_add_f32 v160, v160, v161
    v_add_f32 v162, v162, v163
    v_add_f32 v164, v164, v165
    v_add_f32 v166, v166, v167
    v_mfma_f32_32x32x16_bf16 v[104:119], v[224:227], v[236:239], v[104:119]
    ds_read_b128 v[184:187], v21 offset:8192
    ds_read_b128 v[188:191], v22 offset:8192
    v_add_f32 v152, v152, v154
    v_add_f32 v156, v156, v158
    v_add_f32 v160, v160, v162
    v_add_f32 v164, v164, v166
    v_mfma_f32_32x32x16_bf16 v[120:135], v[228:231], v[236:239], v[120:135]
    ds_read_b128 v[192:195], v23 offset:8192
    ds_read_b128 v[196:199], v24 offset:8192
    v_add_f32 v152, v152, v156
    v_add_f32 v160, v160, v164
    v_add_f32 v152, v152, v160
    v_add_f32 v249, v249, v152
    s_sub_u32 s75, s75, 1
    s_cmp_lg_u32 s75, 0
    s_cbranch_scc1 L_flash
    s_waitcnt vmcnt(0) lgkmcnt(0)
    s_barrier

    v_mov_b32 v32, v249
    v_mov_b32 v33, v249
    s_nop 1
    v_permlane32_swap_b32 v32, v33
    s_nop 1
    v_add_f32 v249, v32, v33
    v_rcp_f32 v249, v249
    s_nop 15

    v_and_b32 v32, 31, v0
    v_lshrrev_b32 v33, 5, v0
    v_lshlrev_b32 v33, 1, v33
    v_and_b32 v34, 15, v0
    v_xor_b32 v33, v33, v34
    v_lshlrev_b32 v33, 4, v33
    v_lshl_add_u32 v32, v32, 8, v33
    v_add_u32 v32, s45, v32

    v_mul_f32 v72, v72, v249
    v_mul_f32 v73, v73, v249
    v_mul_f32 v74, v74, v249
    v_mul_f32 v75, v75, v249
    v_mul_f32 v76, v76, v249
    v_mul_f32 v77, v77, v249
    v_mul_f32 v78, v78, v249
    v_mul_f32 v79, v79, v249
    v_mul_f32 v80, v80, v249
    v_mul_f32 v81, v81, v249
    v_mul_f32 v82, v82, v249
    v_mul_f32 v83, v83, v249
    v_mul_f32 v84, v84, v249
    v_mul_f32 v85, v85, v249
    v_mul_f32 v86, v86, v249
    v_mul_f32 v87, v87, v249
    v_cvt_pk_bf16_f32 v168, v72, v73
    v_cvt_pk_bf16_f32 v169, v74, v75
    v_cvt_pk_bf16_f32 v170, v76, v77
    v_cvt_pk_bf16_f32 v171, v78, v79
    v_cvt_pk_bf16_f32 v172, v80, v81
    v_cvt_pk_bf16_f32 v173, v82, v83
    v_cvt_pk_bf16_f32 v174, v84, v85
    v_cvt_pk_bf16_f32 v175, v86, v87
    v_xor_b32 v33, 0, v32
    ds_write_b128 v33, v[168:171]
    v_xor_b32 v33, 16, v32
    ds_write_b128 v33, v[172:175]
    v_mul_f32 v88, v88, v249
    v_mul_f32 v89, v89, v249
    v_mul_f32 v90, v90, v249
    v_mul_f32 v91, v91, v249
    v_mul_f32 v92, v92, v249
    v_mul_f32 v93, v93, v249
    v_mul_f32 v94, v94, v249
    v_mul_f32 v95, v95, v249
    v_mul_f32 v96, v96, v249
    v_mul_f32 v97, v97, v249
    v_mul_f32 v98, v98, v249
    v_mul_f32 v99, v99, v249
    v_mul_f32 v100, v100, v249
    v_mul_f32 v101, v101, v249
    v_mul_f32 v102, v102, v249
    v_mul_f32 v103, v103, v249
    v_cvt_pk_bf16_f32 v176, v88, v89
    v_cvt_pk_bf16_f32 v177, v90, v91
    v_cvt_pk_bf16_f32 v178, v92, v93
    v_cvt_pk_bf16_f32 v179, v94, v95
    v_cvt_pk_bf16_f32 v180, v96, v97
    v_cvt_pk_bf16_f32 v181, v98, v99
    v_cvt_pk_bf16_f32 v182, v100, v101
    v_cvt_pk_bf16_f32 v183, v102, v103
    v_xor_b32 v33, 64, v32
    ds_write_b128 v33, v[176:179]
    v_xor_b32 v33, 80, v32
    ds_write_b128 v33, v[180:183]
    v_mul_f32 v104, v104, v249
    v_mul_f32 v105, v105, v249
    v_mul_f32 v106, v106, v249
    v_mul_f32 v107, v107, v249
    v_mul_f32 v108, v108, v249
    v_mul_f32 v109, v109, v249
    v_mul_f32 v110, v110, v249
    v_mul_f32 v111, v111, v249
    v_mul_f32 v112, v112, v249
    v_mul_f32 v113, v113, v249
    v_mul_f32 v114, v114, v249
    v_mul_f32 v115, v115, v249
    v_mul_f32 v116, v116, v249
    v_mul_f32 v117, v117, v249
    v_mul_f32 v118, v118, v249
    v_mul_f32 v119, v119, v249
    v_cvt_pk_bf16_f32 v184, v104, v105
    v_cvt_pk_bf16_f32 v185, v106, v107
    v_cvt_pk_bf16_f32 v186, v108, v109
    v_cvt_pk_bf16_f32 v187, v110, v111
    v_cvt_pk_bf16_f32 v188, v112, v113
    v_cvt_pk_bf16_f32 v189, v114, v115
    v_cvt_pk_bf16_f32 v190, v116, v117
    v_cvt_pk_bf16_f32 v191, v118, v119
    v_xor_b32 v33, 128, v32
    ds_write_b128 v33, v[184:187]
    v_xor_b32 v33, 144, v32
    ds_write_b128 v33, v[188:191]
    v_mul_f32 v120, v120, v249
    v_mul_f32 v121, v121, v249
    v_mul_f32 v122, v122, v249
    v_mul_f32 v123, v123, v249
    v_mul_f32 v124, v124, v249
    v_mul_f32 v125, v125, v249
    v_mul_f32 v126, v126, v249
    v_mul_f32 v127, v127, v249
    v_mul_f32 v128, v128, v249
    v_mul_f32 v129, v129, v249
    v_mul_f32 v130, v130, v249
    v_mul_f32 v131, v131, v249
    v_mul_f32 v132, v132, v249
    v_mul_f32 v133, v133, v249
    v_mul_f32 v134, v134, v249
    v_mul_f32 v135, v135, v249
    v_cvt_pk_bf16_f32 v192, v120, v121
    v_cvt_pk_bf16_f32 v193, v122, v123
    v_cvt_pk_bf16_f32 v194, v124, v125
    v_cvt_pk_bf16_f32 v195, v126, v127
    v_cvt_pk_bf16_f32 v196, v128, v129
    v_cvt_pk_bf16_f32 v197, v130, v131
    v_cvt_pk_bf16_f32 v198, v132, v133
    v_cvt_pk_bf16_f32 v199, v134, v135
    v_xor_b32 v33, 192, v32
    ds_write_b128 v33, v[192:195]
    v_xor_b32 v33, 208, v32
    ds_write_b128 v33, v[196:199]
    v_lshrrev_b32 v33, 4, v0
    v_xor_b32 v35, v34, v33
    v_lshlrev_b32 v35, 4, v35
    v_lshl_add_u32 v35, v33, 8, v35
    v_add_u32 v35, s45, v35
    v_lshlrev_b32 v34, 4, v34
    v_lshl_add_u32 v34, v33, 13, v34
    s_lshl_b32 s68, s6, 18
    s_lshl_b32 s69, s10, 8
    s_add_u32 s69, s68, s69
    s_waitcnt lgkmcnt(0)

    v_xor_b32 v33, 0, v35
    ds_read_b128 v[72:75], v33 offset:0
    v_xor_b32 v33, 64, v35
    ds_read_b128 v[76:79], v33 offset:1024
    v_xor_b32 v33, 128, v35
    ds_read_b128 v[80:83], v33 offset:2048
    v_xor_b32 v33, 192, v35
    ds_read_b128 v[84:87], v33 offset:3072
    v_xor_b32 v33, 0, v35
    ds_read_b128 v[88:91], v33 offset:4096
    v_xor_b32 v33, 64, v35
    ds_read_b128 v[92:95], v33 offset:5120
    v_xor_b32 v33, 128, v35
    ds_read_b128 v[96:99], v33 offset:6144
    v_xor_b32 v33, 192, v35
    ds_read_b128 v[100:103], v33 offset:7168
    s_waitcnt lgkmcnt(7)
    s_add_u32 s68, s69, 0
    buffer_store_dwordx4 v[72:75], v34, s[64:67], s68 offen sc1
    s_waitcnt lgkmcnt(6)
    s_add_u32 s68, s69, 32768
    buffer_store_dwordx4 v[76:79], v34, s[64:67], s68 offen sc1
    s_waitcnt lgkmcnt(5)
    s_add_u32 s68, s69, 65536
    buffer_store_dwordx4 v[80:83], v34, s[64:67], s68 offen sc1
    s_waitcnt lgkmcnt(4)
    s_add_u32 s68, s69, 98304
    buffer_store_dwordx4 v[84:87], v34, s[64:67], s68 offen sc1
    s_waitcnt lgkmcnt(3)
    s_add_u32 s68, s69, 131072
    buffer_store_dwordx4 v[88:91], v34, s[64:67], s68 offen sc1
    s_waitcnt lgkmcnt(2)
    s_add_u32 s68, s69, 163840
    buffer_store_dwordx4 v[92:95], v34, s[64:67], s68 offen sc1
    s_waitcnt lgkmcnt(1)
    s_add_u32 s68, s69, 196608
    buffer_store_dwordx4 v[96:99], v34, s[64:67], s68 offen sc1
    s_waitcnt lgkmcnt(0)
    s_add_u32 s68, s69, 229376
    buffer_store_dwordx4 v[100:103], v34, s[64:67], s68 offen sc1
    s_lshr_b32 s75, s42, 2
    s_lshr_b32 s77, s2, 3
    s_cmp_eq_u32 s75, 0
    s_cselect_b32 s56, s24, s34
    s_cselect_b32 s57, s25, s35
    s_cselect_b32 s68, 0x0, 0x400000
    s_cselect_b32 s76, 0xffff, -1
    s_mov_b32 s58, 0x800000
    s_mov_b32 s59, 0x00020000

    s_add_u32 s52, s40, s68
    s_addc_u32 s53, s41, 0
    s_mov_b32 s54, 0x400000
    s_mov_b32 s55, 0x00020000
    s_mov_b32 s60, s36
    s_mov_b32 s61, s37
    s_mov_b32 s62, 0x200000
    s_mov_b32 s63, 0x00020000
    s_and_b32 s11, s42, 1
    s_lshl_b32 s11, s11, 2
    s_and_b32 s68, s77, 3
    s_add_u32 s11, s11, s68
    s_bfe_u32 s12, s42, 0x10001
    s_lshl_b32 s12, s12, 3
    s_lshr_b32 s68, s77, 2
    s_add_u32 s12, s12, s68

    s_lshl_b32 s68, s11, 19
    s_lshl_b32 s69, s3, 11
    s_add_u32 s72, s68, s69
    s_lshl_b32 s68, s3, 21
    s_lshl_b32 s69, s12, 7
    s_add_u32 s73, s68, s69
    s_and_b32 s68, s77, 3
    s_lshl_b32 s68, s68, 1
    s_lshr_b32 s69, s77, 2
    s_add_u32 s68, s68, s69
    s_and_b32 s74, s68, 7

    v_lshrrev_b32 v12, 4, v0
    v_lshrrev_b32 v14, 3, v0
    v_and_b32 v15, 7, v0
    v_xor_b32 v16, v15, v12
    v_lshlrev_b32 v16, 4, v16
    v_lshl_add_u32 v1, v14, 13, v16
    v_xor_b32 v2, 64, v1
    v_and_b32 v16, 1, v12
    v_lshlrev_b32 v16, 2, v16
    v_xor_b32 v16, v16, v15
    v_lshlrev_b32 v16, 4, v16
    v_lshl_add_u32 v3, v14, 11, v16

    s_add_u32 s69, s74, 0
    s_and_b32 s69, s69, 7
    s_add_u32 s69, s69, 0
    s_lshl_b32 s69, s69, 17
    s_add_u32 s69, s69, s73
    s_add_u32 m0, s45, 0
    s_add_u32 s68, s69, 0
    buffer_load_dwordx4 v3, s[56:59], s68 offen lds
    s_add_u32 m0, s45, 1024
    s_add_u32 s68, s69, 16384
    buffer_load_dwordx4 v3, s[56:59], s68 offen lds
    s_add_u32 m0, s45, 2048
    s_add_u32 s68, s69, 32768
    buffer_load_dwordx4 v3, s[56:59], s68 offen lds
    s_add_u32 m0, s45, 3072
    s_add_u32 s68, s69, 49152
    buffer_load_dwordx4 v3, s[56:59], s68 offen lds
    s_add_u32 m0, s45, 4096
    s_add_u32 s68, s69, 65536
    buffer_load_dwordx4 v3, s[56:59], s68 offen lds
    s_add_u32 m0, s45, 5120
    s_add_u32 s68, s69, 81920
    buffer_load_dwordx4 v3, s[56:59], s68 offen lds
    s_add_u32 m0, s45, 6144
    s_add_u32 s68, s69, 98304
    buffer_load_dwordx4 v3, s[56:59], s68 offen lds
    s_add_u32 m0, s45, 7168
    s_add_u32 s68, s69, 114688
    buffer_load_dwordx4 v3, s[56:59], s68 offen lds
    s_add_u32 s69, s74, 1
    s_and_b32 s69, s69, 7
    s_add_u32 s69, s69, 0
    s_lshl_b32 s69, s69, 17
    s_add_u32 s69, s69, s73
    s_add_u32 m0, s45, 8192
    s_add_u32 s68, s69, 0
    buffer_load_dwordx4 v3, s[56:59], s68 offen lds
    s_add_u32 m0, s45, 9216
    s_add_u32 s68, s69, 16384
    buffer_load_dwordx4 v3, s[56:59], s68 offen lds
    s_add_u32 m0, s45, 10240
    s_add_u32 s68, s69, 32768
    buffer_load_dwordx4 v3, s[56:59], s68 offen lds
    s_add_u32 m0, s45, 11264
    s_add_u32 s68, s69, 49152
    buffer_load_dwordx4 v3, s[56:59], s68 offen lds
    s_add_u32 m0, s45, 12288
    s_add_u32 s68, s69, 65536
    buffer_load_dwordx4 v3, s[56:59], s68 offen lds
    s_add_u32 m0, s45, 13312
    s_add_u32 s68, s69, 81920
    buffer_load_dwordx4 v3, s[56:59], s68 offen lds
    s_add_u32 m0, s45, 14336
    s_add_u32 s68, s69, 98304
    buffer_load_dwordx4 v3, s[56:59], s68 offen lds
    s_add_u32 m0, s45, 15360
    s_add_u32 s68, s69, 114688
    buffer_load_dwordx4 v3, s[56:59], s68 offen lds
    s_waitcnt vmcnt(16)
    s_barrier
    s_cmp_lg_u32 s3, 0
    s_cbranch_scc1 L_pub_39
    s_cmp_eq_u32 s46, 1
    s_cbranch_scc1 L_gated_41
    v_mov_b32 v13, 0

L_gate_40:
    buffer_load_dword v12, v13, s[48:51], 0 offen sc1
    s_waitcnt vmcnt(0)
    v_readfirstlane_b32 s68, v12
    s_cmp_ge_u32 s68, 256
    s_cbranch_scc1 L_gated_41
    s_sleep 32
    s_branch L_gate_40

L_gated_41:
    s_mov_b32 s46, 1
    s_lshr_b32 s68, s6, 1
    v_mov_b32 v14, s68
    v_lshrrev_b32 v12, 2, v14
    v_bfe_u32 v15, v0, 3, 1
    v_lshl_add_u32 v12, v15, 1, v12
    v_and_b32 v14, 3, v14
    v_and_b32 v15, 7, v0
    v_lshl_add_u32 v14, v15, 2, v14
    v_lshl_add_u32 v12, v14, 3, v12
    v_add_u32 v12, 0, v12

    v_lshlrev_b32 v12, 8, v12
    s_lshl_b32 s68, s13, 2
    s_add_u32 s68, s68, 128
    v_add_u32 v12, s68, v12

    v_mov_b32 v13, 1
    s_mov_b32 exec_lo, 0xffff
    s_mov_b32 exec_hi, 0
    buffer_store_dword v13, v12, s[96:99], 0 offen sc1
    s_mov_b64 exec, -1

L_pub_39:
L_oproj:
    s_add_u32 s69, s74, 2
    s_and_b32 s69, s69, 7
    s_add_u32 s69, s69, 0
    s_lshl_b32 s69, s69, 17
    s_add_u32 s69, s69, s73
    s_add_u32 m0, s45, 16384
    s_add_u32 s68, s69, 0
    buffer_load_dwordx4 v3, s[56:59], s68 offen lds
    s_add_u32 m0, s45, 17408
    s_add_u32 s68, s69, 16384
    buffer_load_dwordx4 v3, s[56:59], s68 offen lds
    s_add_u32 m0, s45, 18432
    s_add_u32 s68, s69, 32768
    buffer_load_dwordx4 v3, s[56:59], s68 offen lds
    s_add_u32 m0, s45, 19456
    s_add_u32 s68, s69, 49152
    buffer_load_dwordx4 v3, s[56:59], s68 offen lds
    s_add_u32 m0, s45, 20480
    s_add_u32 s68, s69, 65536
    buffer_load_dwordx4 v3, s[56:59], s68 offen lds
    s_add_u32 m0, s45, 21504
    s_add_u32 s68, s69, 81920
    buffer_load_dwordx4 v3, s[56:59], s68 offen lds
    s_add_u32 m0, s45, 22528
    s_add_u32 s68, s69, 98304
    buffer_load_dwordx4 v3, s[56:59], s68 offen lds
    s_add_u32 m0, s45, 23552
    s_add_u32 s68, s69, 114688
    buffer_load_dwordx4 v3, s[56:59], s68 offen lds
    s_add_u32 s69, s74, 3
    s_and_b32 s69, s69, 7
    s_add_u32 s69, s69, 0
    s_lshl_b32 s69, s69, 17
    s_add_u32 s69, s69, s73
    s_add_u32 m0, s45, 24576
    s_add_u32 s68, s69, 0
    buffer_load_dwordx4 v3, s[56:59], s68 offen lds
    s_add_u32 m0, s45, 25600
    s_add_u32 s68, s69, 16384
    buffer_load_dwordx4 v3, s[56:59], s68 offen lds
    s_add_u32 m0, s45, 26624
    s_add_u32 s68, s69, 32768
    buffer_load_dwordx4 v3, s[56:59], s68 offen lds
    s_add_u32 m0, s45, 27648
    s_add_u32 s68, s69, 49152
    buffer_load_dwordx4 v3, s[56:59], s68 offen lds
    s_add_u32 m0, s45, 28672
    s_add_u32 s68, s69, 65536
    buffer_load_dwordx4 v3, s[56:59], s68 offen lds
    s_add_u32 m0, s45, 29696
    s_add_u32 s68, s69, 81920
    buffer_load_dwordx4 v3, s[56:59], s68 offen lds
    s_add_u32 m0, s45, 30720
    s_add_u32 s68, s69, 98304
    buffer_load_dwordx4 v3, s[56:59], s68 offen lds
    s_add_u32 m0, s45, 31744
    s_add_u32 s68, s69, 114688
    buffer_load_dwordx4 v3, s[56:59], s68 offen lds
    s_add_u32 s69, s74, 4
    s_and_b32 s69, s69, 7
    s_add_u32 s69, s69, 0
    s_lshl_b32 s69, s69, 17
    s_add_u32 s69, s69, s73
    s_add_u32 m0, s45, 32768
    s_add_u32 s68, s69, 0
    buffer_load_dwordx4 v3, s[56:59], s68 offen lds
    s_add_u32 m0, s45, 33792
    s_add_u32 s68, s69, 16384
    buffer_load_dwordx4 v3, s[56:59], s68 offen lds
    s_add_u32 m0, s45, 34816
    s_add_u32 s68, s69, 32768
    buffer_load_dwordx4 v3, s[56:59], s68 offen lds
    s_add_u32 m0, s45, 35840
    s_add_u32 s68, s69, 49152
    buffer_load_dwordx4 v3, s[56:59], s68 offen lds
    s_add_u32 m0, s45, 36864
    s_add_u32 s68, s69, 65536
    buffer_load_dwordx4 v3, s[56:59], s68 offen lds
    s_add_u32 m0, s45, 37888
    s_add_u32 s68, s69, 81920
    buffer_load_dwordx4 v3, s[56:59], s68 offen lds
    s_add_u32 m0, s45, 38912
    s_add_u32 s68, s69, 98304
    buffer_load_dwordx4 v3, s[56:59], s68 offen lds
    s_add_u32 m0, s45, 39936
    s_add_u32 s68, s69, 114688
    buffer_load_dwordx4 v3, s[56:59], s68 offen lds
    v_and_b32 v12, 31, v0
    v_lshrrev_b32 v13, 5, v0
    v_lshrrev_b32 v14, 1, v12
    v_and_b32 v14, 7, v14
    v_xor_b32 v14, v14, v13
    v_lshlrev_b32 v14, 4, v14
    v_lshl_add_u32 v14, v12, 7, v14

    v_xor_b32 v15, 0, v14
    v_add_u32 v4, s45, v15
    v_xor_b32 v15, 32, v14
    v_add_u32 v5, s45, v15
    v_xor_b32 v15, 64, v14
    v_add_u32 v6, s45, v15
    v_xor_b32 v15, 96, v14
    v_add_u32 v7, s45, v15
    v_bfe_u32 v12, v0, 4, 1
    v_bfe_u32 v14, v0, 2, 2
    v_and_b32 v15, 1, v0
    v_bfe_u32 v16, v0, 1, 1
    v_lshl_add_u32 v17, v13, 3, v14
    v_lshlrev_b32 v17, 7, v17
    v_lshl_add_u32 v17, v15, 5, v17
    v_lshl_add_u32 v17, v12, 4, v17
    v_lshl_add_u32 v17, v16, 3, v17
    v_lshrrev_b32 v14, 1, v14
    v_lshl_add_u32 v17, v14, 6, v17
    v_add_u32 v8, s45, v17
    v_xor_b32 v9, 64, v8
    v_lshlrev_b32 v10, 4, v0
    v_and_b32 v12, 31, v0
    v_lshlrev_b32 v12, 12, v12
    v_lshl_add_u32 v12, v13, 5, v12
    s_lshl_b32 s68, s11, 18
    s_lshr_b32 s69, s3, 1
    s_lshl_b32 s69, s69, 17
    s_add_u32 s68, s68, s69
    s_lshl_b32 s69, s75, 11
    s_add_u32 s68, s68, s69
    s_lshl_b32 s69, s12, 7
    s_add_u32 s68, s68, s69
    s_and_b32 s69, s3, 1
    s_lshl_b32 s69, s69, 6
    s_add_u32 s68, s68, s69
    v_add_u32 v11, s68, v12

    s_waitcnt vmcnt(32)
    ds_read_b64_tr_b16 a[0:1], v8 offset:0
    ds_read_b64_tr_b16 a[2:3], v8 offset:512
    ds_read_b64_tr_b16 a[4:5], v9 offset:0
    ds_read_b64_tr_b16 a[6:7], v9 offset:512
    ds_read_b64_tr_b16 a[8:9], v8 offset:2048
    ds_read_b64_tr_b16 a[10:11], v8 offset:2560
    ds_read_b64_tr_b16 a[12:13], v9 offset:2048
    ds_read_b64_tr_b16 a[14:15], v9 offset:2560
    ds_read_b64_tr_b16 a[16:17], v8 offset:4096
    ds_read_b64_tr_b16 a[18:19], v8 offset:4608
    ds_read_b64_tr_b16 a[20:21], v9 offset:4096
    ds_read_b64_tr_b16 a[22:23], v9 offset:4608
    ds_read_b64_tr_b16 a[24:25], v8 offset:6144
    ds_read_b64_tr_b16 a[26:27], v8 offset:6656
    ds_read_b64_tr_b16 a[28:29], v9 offset:6144
    ds_read_b64_tr_b16 a[30:31], v9 offset:6656
    s_waitcnt lgkmcnt(0)
    s_add_u32 s69, s74, 5
    s_and_b32 s69, s69, 7
    s_add_u32 s69, s69, 0
    s_lshl_b32 s69, s69, 17
    s_add_u32 s69, s69, s73
    s_add_u32 m0, s45, 0
    s_add_u32 s68, s69, 0
    buffer_load_dwordx4 v3, s[56:59], s68 offen lds
    s_add_u32 m0, s45, 1024
    s_add_u32 s68, s69, 16384
    buffer_load_dwordx4 v3, s[56:59], s68 offen lds
    s_add_u32 m0, s45, 2048
    s_add_u32 s68, s69, 32768
    buffer_load_dwordx4 v3, s[56:59], s68 offen lds
    s_add_u32 m0, s45, 3072
    s_add_u32 s68, s69, 49152
    buffer_load_dwordx4 v3, s[56:59], s68 offen lds
    s_add_u32 m0, s45, 4096
    s_add_u32 s68, s69, 65536
    buffer_load_dwordx4 v3, s[56:59], s68 offen lds
    s_add_u32 m0, s45, 5120
    s_add_u32 s68, s69, 81920
    buffer_load_dwordx4 v3, s[56:59], s68 offen lds
    s_add_u32 m0, s45, 6144
    s_add_u32 s68, s69, 98304
    buffer_load_dwordx4 v3, s[56:59], s68 offen lds
    s_add_u32 m0, s45, 7168
    s_add_u32 s68, s69, 114688
    buffer_load_dwordx4 v3, s[56:59], s68 offen lds
    s_waitcnt vmcnt(32)
    ds_read_b64_tr_b16 a[32:33], v8 offset:8192
    ds_read_b64_tr_b16 a[34:35], v8 offset:8704
    ds_read_b64_tr_b16 a[36:37], v9 offset:8192
    ds_read_b64_tr_b16 a[38:39], v9 offset:8704
    ds_read_b64_tr_b16 a[40:41], v8 offset:10240
    ds_read_b64_tr_b16 a[42:43], v8 offset:10752
    ds_read_b64_tr_b16 a[44:45], v9 offset:10240
    ds_read_b64_tr_b16 a[46:47], v9 offset:10752
    ds_read_b64_tr_b16 a[48:49], v8 offset:12288
    ds_read_b64_tr_b16 a[50:51], v8 offset:12800
    ds_read_b64_tr_b16 a[52:53], v9 offset:12288
    ds_read_b64_tr_b16 a[54:55], v9 offset:12800
    ds_read_b64_tr_b16 a[56:57], v8 offset:14336
    ds_read_b64_tr_b16 a[58:59], v8 offset:14848
    ds_read_b64_tr_b16 a[60:61], v9 offset:14336
    ds_read_b64_tr_b16 a[62:63], v9 offset:14848
    s_waitcnt lgkmcnt(0)
    s_add_u32 s69, s74, 6
    s_and_b32 s69, s69, 7
    s_add_u32 s69, s69, 0
    s_lshl_b32 s69, s69, 17
    s_add_u32 s69, s69, s73
    s_add_u32 m0, s45, 8192
    s_add_u32 s68, s69, 0
    buffer_load_dwordx4 v3, s[56:59], s68 offen lds
    s_add_u32 m0, s45, 9216
    s_add_u32 s68, s69, 16384
    buffer_load_dwordx4 v3, s[56:59], s68 offen lds
    s_add_u32 m0, s45, 10240
    s_add_u32 s68, s69, 32768
    buffer_load_dwordx4 v3, s[56:59], s68 offen lds
    s_add_u32 m0, s45, 11264
    s_add_u32 s68, s69, 49152
    buffer_load_dwordx4 v3, s[56:59], s68 offen lds
    s_add_u32 m0, s45, 12288
    s_add_u32 s68, s69, 65536
    buffer_load_dwordx4 v3, s[56:59], s68 offen lds
    s_add_u32 m0, s45, 13312
    s_add_u32 s68, s69, 81920
    buffer_load_dwordx4 v3, s[56:59], s68 offen lds
    s_add_u32 m0, s45, 14336
    s_add_u32 s68, s69, 98304
    buffer_load_dwordx4 v3, s[56:59], s68 offen lds
    s_add_u32 m0, s45, 15360
    s_add_u32 s68, s69, 114688
    buffer_load_dwordx4 v3, s[56:59], s68 offen lds
    s_waitcnt vmcnt(32)
    ds_read_b64_tr_b16 a[64:65], v8 offset:16384
    ds_read_b64_tr_b16 a[66:67], v8 offset:16896
    ds_read_b64_tr_b16 a[68:69], v9 offset:16384
    ds_read_b64_tr_b16 a[70:71], v9 offset:16896
    ds_read_b64_tr_b16 a[72:73], v8 offset:18432
    ds_read_b64_tr_b16 a[74:75], v8 offset:18944
    ds_read_b64_tr_b16 a[76:77], v9 offset:18432
    ds_read_b64_tr_b16 a[78:79], v9 offset:18944
    ds_read_b64_tr_b16 a[80:81], v8 offset:20480
    ds_read_b64_tr_b16 a[82:83], v8 offset:20992
    ds_read_b64_tr_b16 a[84:85], v9 offset:20480
    ds_read_b64_tr_b16 a[86:87], v9 offset:20992
    ds_read_b64_tr_b16 a[88:89], v8 offset:22528
    ds_read_b64_tr_b16 a[90:91], v8 offset:23040
    ds_read_b64_tr_b16 a[92:93], v9 offset:22528
    ds_read_b64_tr_b16 a[94:95], v9 offset:23040
    s_waitcnt lgkmcnt(0)
    s_add_u32 s69, s74, 7
    s_and_b32 s69, s69, 7
    s_add_u32 s69, s69, 0
    s_lshl_b32 s69, s69, 17
    s_add_u32 s69, s69, s73
    s_add_u32 m0, s45, 16384
    s_add_u32 s68, s69, 0
    buffer_load_dwordx4 v3, s[56:59], s68 offen lds
    s_add_u32 m0, s45, 17408
    s_add_u32 s68, s69, 16384
    buffer_load_dwordx4 v3, s[56:59], s68 offen lds
    s_add_u32 m0, s45, 18432
    s_add_u32 s68, s69, 32768
    buffer_load_dwordx4 v3, s[56:59], s68 offen lds
    s_add_u32 m0, s45, 19456
    s_add_u32 s68, s69, 49152
    buffer_load_dwordx4 v3, s[56:59], s68 offen lds
    s_add_u32 m0, s45, 20480
    s_add_u32 s68, s69, 65536
    buffer_load_dwordx4 v3, s[56:59], s68 offen lds
    s_add_u32 m0, s45, 21504
    s_add_u32 s68, s69, 81920
    buffer_load_dwordx4 v3, s[56:59], s68 offen lds
    s_add_u32 m0, s45, 22528
    s_add_u32 s68, s69, 98304
    buffer_load_dwordx4 v3, s[56:59], s68 offen lds
    s_add_u32 m0, s45, 23552
    s_add_u32 s68, s69, 114688
    buffer_load_dwordx4 v3, s[56:59], s68 offen lds
    s_waitcnt vmcnt(32)
    ds_read_b64_tr_b16 a[96:97], v8 offset:24576
    ds_read_b64_tr_b16 a[98:99], v8 offset:25088
    ds_read_b64_tr_b16 a[100:101], v9 offset:24576
    ds_read_b64_tr_b16 a[102:103], v9 offset:25088
    ds_read_b64_tr_b16 a[104:105], v8 offset:26624
    ds_read_b64_tr_b16 a[106:107], v8 offset:27136
    ds_read_b64_tr_b16 a[108:109], v9 offset:26624
    ds_read_b64_tr_b16 a[110:111], v9 offset:27136
    ds_read_b64_tr_b16 a[112:113], v8 offset:28672
    ds_read_b64_tr_b16 a[114:115], v8 offset:29184
    ds_read_b64_tr_b16 a[116:117], v9 offset:28672
    ds_read_b64_tr_b16 a[118:119], v9 offset:29184
    ds_read_b64_tr_b16 a[120:121], v8 offset:30720
    ds_read_b64_tr_b16 a[122:123], v8 offset:31232
    ds_read_b64_tr_b16 a[124:125], v9 offset:30720
    ds_read_b64_tr_b16 a[126:127], v9 offset:31232
    s_waitcnt lgkmcnt(0)
    s_add_u32 s69, s74, 0
    s_and_b32 s69, s69, 7
    s_add_u32 s69, s69, 8
    s_lshl_b32 s69, s69, 17
    s_add_u32 s69, s69, s73
    s_add_u32 m0, s45, 24576
    s_add_u32 s68, s69, 0
    buffer_load_dwordx4 v3, s[56:59], s68 offen lds
    s_add_u32 m0, s45, 25600
    s_add_u32 s68, s69, 16384
    buffer_load_dwordx4 v3, s[56:59], s68 offen lds
    s_add_u32 m0, s45, 26624
    s_add_u32 s68, s69, 32768
    buffer_load_dwordx4 v3, s[56:59], s68 offen lds
    s_add_u32 m0, s45, 27648
    s_add_u32 s68, s69, 49152
    buffer_load_dwordx4 v3, s[56:59], s68 offen lds
    s_add_u32 m0, s45, 28672
    s_add_u32 s68, s69, 65536
    buffer_load_dwordx4 v3, s[56:59], s68 offen lds
    s_add_u32 m0, s45, 29696
    s_add_u32 s68, s69, 81920
    buffer_load_dwordx4 v3, s[56:59], s68 offen lds
    s_add_u32 m0, s45, 30720
    s_add_u32 s68, s69, 98304
    buffer_load_dwordx4 v3, s[56:59], s68 offen lds
    s_add_u32 m0, s45, 31744
    s_add_u32 s68, s69, 114688
    buffer_load_dwordx4 v3, s[56:59], s68 offen lds
    s_waitcnt vmcnt(32)
    ds_read_b64_tr_b16 a[128:129], v8 offset:32768
    ds_read_b64_tr_b16 a[130:131], v8 offset:33280
    ds_read_b64_tr_b16 a[132:133], v9 offset:32768
    ds_read_b64_tr_b16 a[134:135], v9 offset:33280
    ds_read_b64_tr_b16 a[136:137], v8 offset:34816
    ds_read_b64_tr_b16 a[138:139], v8 offset:35328
    ds_read_b64_tr_b16 a[140:141], v9 offset:34816
    ds_read_b64_tr_b16 a[142:143], v9 offset:35328
    ds_read_b64_tr_b16 a[144:145], v8 offset:36864
    ds_read_b64_tr_b16 a[146:147], v8 offset:37376
    ds_read_b64_tr_b16 a[148:149], v9 offset:36864
    ds_read_b64_tr_b16 a[150:151], v9 offset:37376
    ds_read_b64_tr_b16 a[152:153], v8 offset:38912
    ds_read_b64_tr_b16 a[154:155], v8 offset:39424
    ds_read_b64_tr_b16 a[156:157], v9 offset:38912
    ds_read_b64_tr_b16 a[158:159], v9 offset:39424
    s_waitcnt lgkmcnt(0)
    s_add_u32 s69, s74, 1
    s_and_b32 s69, s69, 7
    s_add_u32 s69, s69, 8
    s_lshl_b32 s69, s69, 17
    s_add_u32 s69, s69, s73
    s_add_u32 m0, s45, 32768
    s_add_u32 s68, s69, 0
    buffer_load_dwordx4 v3, s[56:59], s68 offen lds
    s_add_u32 m0, s45, 33792
    s_add_u32 s68, s69, 16384
    buffer_load_dwordx4 v3, s[56:59], s68 offen lds
    s_add_u32 m0, s45, 34816
    s_add_u32 s68, s69, 32768
    buffer_load_dwordx4 v3, s[56:59], s68 offen lds
    s_add_u32 m0, s45, 35840
    s_add_u32 s68, s69, 49152
    buffer_load_dwordx4 v3, s[56:59], s68 offen lds
    s_add_u32 m0, s45, 36864
    s_add_u32 s68, s69, 65536
    buffer_load_dwordx4 v3, s[56:59], s68 offen lds
    s_add_u32 m0, s45, 37888
    s_add_u32 s68, s69, 81920
    buffer_load_dwordx4 v3, s[56:59], s68 offen lds
    s_add_u32 m0, s45, 38912
    s_add_u32 s68, s69, 98304
    buffer_load_dwordx4 v3, s[56:59], s68 offen lds
    s_add_u32 m0, s45, 39936
    s_add_u32 s68, s69, 114688
    buffer_load_dwordx4 v3, s[56:59], s68 offen lds
    s_waitcnt vmcnt(32)
    ds_read_b64_tr_b16 a[160:161], v8 offset:0
    ds_read_b64_tr_b16 a[162:163], v8 offset:512
    ds_read_b64_tr_b16 a[164:165], v9 offset:0
    ds_read_b64_tr_b16 a[166:167], v9 offset:512
    ds_read_b64_tr_b16 a[168:169], v8 offset:2048
    ds_read_b64_tr_b16 a[170:171], v8 offset:2560
    ds_read_b64_tr_b16 a[172:173], v9 offset:2048
    ds_read_b64_tr_b16 a[174:175], v9 offset:2560
    ds_read_b64_tr_b16 a[176:177], v8 offset:4096
    ds_read_b64_tr_b16 a[178:179], v8 offset:4608
    ds_read_b64_tr_b16 a[180:181], v9 offset:4096
    ds_read_b64_tr_b16 a[182:183], v9 offset:4608
    ds_read_b64_tr_b16 a[184:185], v8 offset:6144
    ds_read_b64_tr_b16 a[186:187], v8 offset:6656
    ds_read_b64_tr_b16 a[188:189], v9 offset:6144
    ds_read_b64_tr_b16 a[190:191], v9 offset:6656
    s_waitcnt lgkmcnt(0)
    s_add_u32 s69, s74, 2
    s_and_b32 s69, s69, 7
    s_add_u32 s69, s69, 8
    s_lshl_b32 s69, s69, 17
    s_add_u32 s69, s69, s73
    s_add_u32 m0, s45, 0
    s_add_u32 s68, s69, 0
    buffer_load_dwordx4 v3, s[56:59], s68 offen lds
    s_add_u32 m0, s45, 1024
    s_add_u32 s68, s69, 16384
    buffer_load_dwordx4 v3, s[56:59], s68 offen lds
    s_add_u32 m0, s45, 2048
    s_add_u32 s68, s69, 32768
    buffer_load_dwordx4 v3, s[56:59], s68 offen lds
    s_add_u32 m0, s45, 3072
    s_add_u32 s68, s69, 49152
    buffer_load_dwordx4 v3, s[56:59], s68 offen lds
    s_add_u32 m0, s45, 4096
    s_add_u32 s68, s69, 65536
    buffer_load_dwordx4 v3, s[56:59], s68 offen lds
    s_add_u32 m0, s45, 5120
    s_add_u32 s68, s69, 81920
    buffer_load_dwordx4 v3, s[56:59], s68 offen lds
    s_add_u32 m0, s45, 6144
    s_add_u32 s68, s69, 98304
    buffer_load_dwordx4 v3, s[56:59], s68 offen lds
    s_add_u32 m0, s45, 7168
    s_add_u32 s68, s69, 114688
    buffer_load_dwordx4 v3, s[56:59], s68 offen lds
    s_waitcnt vmcnt(32)
    ds_read_b64_tr_b16 a[192:193], v8 offset:8192
    ds_read_b64_tr_b16 a[194:195], v8 offset:8704
    ds_read_b64_tr_b16 a[196:197], v9 offset:8192
    ds_read_b64_tr_b16 a[198:199], v9 offset:8704
    ds_read_b64_tr_b16 a[200:201], v8 offset:10240
    ds_read_b64_tr_b16 a[202:203], v8 offset:10752
    ds_read_b64_tr_b16 a[204:205], v9 offset:10240
    ds_read_b64_tr_b16 a[206:207], v9 offset:10752
    ds_read_b64_tr_b16 a[208:209], v8 offset:12288
    ds_read_b64_tr_b16 a[210:211], v8 offset:12800
    ds_read_b64_tr_b16 a[212:213], v9 offset:12288
    ds_read_b64_tr_b16 a[214:215], v9 offset:12800
    ds_read_b64_tr_b16 a[216:217], v8 offset:14336
    ds_read_b64_tr_b16 a[218:219], v8 offset:14848
    ds_read_b64_tr_b16 a[220:221], v9 offset:14336
    ds_read_b64_tr_b16 a[222:223], v9 offset:14848
    s_waitcnt lgkmcnt(0)
    s_waitcnt vmcnt(24)
    ds_read_b64_tr_b16 a[224:225], v8 offset:16384
    ds_read_b64_tr_b16 a[226:227], v8 offset:16896
    ds_read_b64_tr_b16 a[228:229], v9 offset:16384
    ds_read_b64_tr_b16 a[230:231], v9 offset:16896
    ds_read_b64_tr_b16 a[232:233], v8 offset:18432
    ds_read_b64_tr_b16 a[234:235], v8 offset:18944
    ds_read_b64_tr_b16 a[236:237], v9 offset:18432
    ds_read_b64_tr_b16 a[238:239], v9 offset:18944
    ds_read_b64_tr_b16 a[240:241], v8 offset:20480
    ds_read_b64_tr_b16 a[242:243], v8 offset:20992
    ds_read_b64_tr_b16 a[244:245], v9 offset:20480
    ds_read_b64_tr_b16 a[246:247], v9 offset:20992
    ds_read_b64_tr_b16 a[248:249], v8 offset:22528
    ds_read_b64_tr_b16 a[250:251], v8 offset:23040
    ds_read_b64_tr_b16 a[252:253], v9 offset:22528
    ds_read_b64_tr_b16 a[254:255], v9 offset:23040
    s_waitcnt lgkmcnt(0)
    s_lshl_b32 s68, s3, 1
    s_lshl_b32 s69, 0x303, s68
    s_lshl_b32 s68, s3, 3
    s_lshl_b32 s70, 0xff, s68
    s_cmp_eq_u32 s75, 0
    s_cselect_b32 s76, s69, s70

    v_and_b32 v13, 31, v0
    v_lshlrev_b32 v13, 2, v13
    s_lshl_b32 s69, s2, 8

L_poll_42:
    buffer_load_dword v12, v13, s[96:99], s69 offen offset:128 sc1
    s_waitcnt vmcnt(0)
    v_cmp_eq_u32 vcc, 1, v12
    s_nop 1
    s_and_b32 s68, vcc_lo, s76
    s_cmp_eq_u32 s68, s76
    s_cbranch_scc1 L_polld_43
    s_sleep 8
    s_branch L_poll_42

L_polld_43:
    s_add_u32 s69, s74, 0
    s_and_b32 s69, s69, 7
    s_add_u32 s69, s69, 0
    s_lshl_b32 s69, s69, 7
    s_add_u32 s69, s69, s72
    s_add_u32 m0, s45, 8192
    s_add_u32 s68, s69, 0
    buffer_load_dwordx4 v1, s[52:55], s68 offen lds
    s_add_u32 m0, s45, 9216
    s_add_u32 s68, s69, 65536
    buffer_load_dwordx4 v2, s[52:55], s68 offen lds
    s_add_u32 m0, s45, 10240
    s_add_u32 s68, s69, 131072
    buffer_load_dwordx4 v1, s[52:55], s68 offen lds
    s_add_u32 m0, s45, 11264
    s_add_u32 s68, s69, 196608
    buffer_load_dwordx4 v2, s[52:55], s68 offen lds
    s_add_u32 m0, s45, 12288
    s_add_u32 s68, s69, 262144
    buffer_load_dwordx4 v1, s[52:55], s68 offen lds
    s_add_u32 m0, s45, 13312
    s_add_u32 s68, s69, 327680
    buffer_load_dwordx4 v2, s[52:55], s68 offen lds
    s_add_u32 m0, s45, 14336
    s_add_u32 s68, s69, 393216
    buffer_load_dwordx4 v1, s[52:55], s68 offen lds
    s_add_u32 m0, s45, 15360
    s_add_u32 s68, s69, 458752
    buffer_load_dwordx4 v2, s[52:55], s68 offen lds
    s_add_u32 s69, s74, 1
    s_and_b32 s69, s69, 7
    s_add_u32 s69, s69, 0
    s_lshl_b32 s69, s69, 7
    s_add_u32 s69, s69, s72
    s_add_u32 m0, s45, 16384
    s_add_u32 s68, s69, 0
    buffer_load_dwordx4 v1, s[52:55], s68 offen lds
    s_add_u32 m0, s45, 17408
    s_add_u32 s68, s69, 65536
    buffer_load_dwordx4 v2, s[52:55], s68 offen lds
    s_add_u32 m0, s45, 18432
    s_add_u32 s68, s69, 131072
    buffer_load_dwordx4 v1, s[52:55], s68 offen lds
    s_add_u32 m0, s45, 19456
    s_add_u32 s68, s69, 196608
    buffer_load_dwordx4 v2, s[52:55], s68 offen lds
    s_add_u32 m0, s45, 20480
    s_add_u32 s68, s69, 262144
    buffer_load_dwordx4 v1, s[52:55], s68 offen lds
    s_add_u32 m0, s45, 21504
    s_add_u32 s68, s69, 327680
    buffer_load_dwordx4 v2, s[52:55], s68 offen lds
    s_add_u32 m0, s45, 22528
    s_add_u32 s68, s69, 393216
    buffer_load_dwordx4 v1, s[52:55], s68 offen lds
    s_add_u32 m0, s45, 23552
    s_add_u32 s68, s69, 458752
    buffer_load_dwordx4 v2, s[52:55], s68 offen lds
    s_waitcnt vmcnt(8)
    ds_read_b128 v[24:27], v4 offset:8192
    ds_read_b128 v[28:31], v4 offset:12288
    ds_read_b128 v[40:43], v5 offset:8192
    ds_read_b128 v[44:47], v5 offset:12288
    s_waitcnt lgkmcnt(2)
    v_mfma_f32_32x32x16_bf16 v[96:111], a[0:3], v[24:27], 0
    v_mfma_f32_32x32x16_bf16 v[128:143], a[0:3], v[28:31], 0
    v_mfma_f32_32x32x16_bf16 v[112:127], a[4:7], v[24:27], 0
    v_mfma_f32_32x32x16_bf16 v[144:159], a[4:7], v[28:31], 0
    ds_read_b128 v[24:27], v6 offset:8192
    ds_read_b128 v[28:31], v6 offset:12288
    s_waitcnt lgkmcnt(2)
    v_mfma_f32_32x32x16_bf16 v[96:111], a[8:11], v[40:43], v[96:111]
    v_mfma_f32_32x32x16_bf16 v[128:143], a[8:11], v[44:47], v[128:143]
    v_mfma_f32_32x32x16_bf16 v[112:127], a[12:15], v[40:43], v[112:127]
    v_mfma_f32_32x32x16_bf16 v[144:159], a[12:15], v[44:47], v[144:159]
    ds_read_b128 v[40:43], v7 offset:8192
    ds_read_b128 v[44:47], v7 offset:12288
    s_waitcnt lgkmcnt(2)
    v_mfma_f32_32x32x16_bf16 v[96:111], a[16:19], v[24:27], v[96:111]
    v_mfma_f32_32x32x16_bf16 v[128:143], a[16:19], v[28:31], v[128:143]
    v_mfma_f32_32x32x16_bf16 v[112:127], a[20:23], v[24:27], v[112:127]
    v_mfma_f32_32x32x16_bf16 v[144:159], a[20:23], v[28:31], v[144:159]
    s_waitcnt vmcnt(0)
    ds_read_b128 v[24:27], v4 offset:16384
    ds_read_b128 v[28:31], v4 offset:20480
    s_waitcnt lgkmcnt(2)
    v_mfma_f32_32x32x16_bf16 v[96:111], a[24:27], v[40:43], v[96:111]
    s_add_u32 s69, s74, 2
    s_and_b32 s69, s69, 7
    s_add_u32 s69, s69, 0
    s_lshl_b32 s69, s69, 7
    s_add_u32 s69, s69, s72
    s_add_u32 m0, s45, 8192
    s_add_u32 s68, s69, 0
    buffer_load_dwordx4 v1, s[52:55], s68 offen lds
    v_mfma_f32_32x32x16_bf16 v[128:143], a[24:27], v[44:47], v[128:143]
    s_add_u32 m0, s45, 9216
    s_add_u32 s68, s69, 65536
    buffer_load_dwordx4 v2, s[52:55], s68 offen lds
    v_mfma_f32_32x32x16_bf16 v[112:127], a[28:31], v[40:43], v[112:127]
    s_add_u32 m0, s45, 10240
    s_add_u32 s68, s69, 131072
    buffer_load_dwordx4 v1, s[52:55], s68 offen lds
    v_mfma_f32_32x32x16_bf16 v[144:159], a[28:31], v[44:47], v[144:159]
    s_add_u32 m0, s45, 11264
    s_add_u32 s68, s69, 196608
    buffer_load_dwordx4 v2, s[52:55], s68 offen lds
    ds_read_b128 v[40:43], v5 offset:16384
    ds_read_b128 v[44:47], v5 offset:20480
    s_waitcnt lgkmcnt(2)
    v_mfma_f32_32x32x16_bf16 v[96:111], a[32:35], v[24:27], v[96:111]
    s_add_u32 m0, s45, 12288
    s_add_u32 s68, s69, 262144
    buffer_load_dwordx4 v1, s[52:55], s68 offen lds
    v_mfma_f32_32x32x16_bf16 v[128:143], a[32:35], v[28:31], v[128:143]
    s_add_u32 m0, s45, 13312
    s_add_u32 s68, s69, 327680
    buffer_load_dwordx4 v2, s[52:55], s68 offen lds
    v_mfma_f32_32x32x16_bf16 v[112:127], a[36:39], v[24:27], v[112:127]
    s_add_u32 m0, s45, 14336
    s_add_u32 s68, s69, 393216
    buffer_load_dwordx4 v1, s[52:55], s68 offen lds
    v_mfma_f32_32x32x16_bf16 v[144:159], a[36:39], v[28:31], v[144:159]
    s_add_u32 m0, s45, 15360
    s_add_u32 s68, s69, 458752
    buffer_load_dwordx4 v2, s[52:55], s68 offen lds
    ds_read_b128 v[24:27], v6 offset:16384
    ds_read_b128 v[28:31], v6 offset:20480
    s_waitcnt lgkmcnt(2)
    v_mfma_f32_32x32x16_bf16 v[96:111], a[40:43], v[40:43], v[96:111]
    v_mfma_f32_32x32x16_bf16 v[128:143], a[40:43], v[44:47], v[128:143]
    v_mfma_f32_32x32x16_bf16 v[112:127], a[44:47], v[40:43], v[112:127]
    v_mfma_f32_32x32x16_bf16 v[144:159], a[44:47], v[44:47], v[144:159]
    ds_read_b128 v[40:43], v7 offset:16384
    ds_read_b128 v[44:47], v7 offset:20480
    s_waitcnt lgkmcnt(2)
    v_mfma_f32_32x32x16_bf16 v[96:111], a[48:51], v[24:27], v[96:111]
    v_mfma_f32_32x32x16_bf16 v[128:143], a[48:51], v[28:31], v[128:143]
    v_mfma_f32_32x32x16_bf16 v[112:127], a[52:55], v[24:27], v[112:127]
    v_mfma_f32_32x32x16_bf16 v[144:159], a[52:55], v[28:31], v[144:159]
    s_waitcnt vmcnt(0)
    ds_read_b128 v[24:27], v4 offset:8192
    ds_read_b128 v[28:31], v4 offset:12288
    s_waitcnt lgkmcnt(2)
    v_mfma_f32_32x32x16_bf16 v[96:111], a[56:59], v[40:43], v[96:111]
    s_add_u32 s69, s74, 3
    s_and_b32 s69, s69, 7
    s_add_u32 s69, s69, 0
    s_lshl_b32 s69, s69, 7
    s_add_u32 s69, s69, s72
    s_add_u32 m0, s45, 16384
    s_add_u32 s68, s69, 0
    buffer_load_dwordx4 v1, s[52:55], s68 offen lds
    v_mfma_f32_32x32x16_bf16 v[128:143], a[56:59], v[44:47], v[128:143]
    s_add_u32 m0, s45, 17408
    s_add_u32 s68, s69, 65536
    buffer_load_dwordx4 v2, s[52:55], s68 offen lds
    v_mfma_f32_32x32x16_bf16 v[112:127], a[60:63], v[40:43], v[112:127]
    s_add_u32 m0, s45, 18432
    s_add_u32 s68, s69, 131072
    buffer_load_dwordx4 v1, s[52:55], s68 offen lds
    v_mfma_f32_32x32x16_bf16 v[144:159], a[60:63], v[44:47], v[144:159]
    s_add_u32 m0, s45, 19456
    s_add_u32 s68, s69, 196608
    buffer_load_dwordx4 v2, s[52:55], s68 offen lds
    ds_read_b128 v[40:43], v5 offset:8192
    ds_read_b128 v[44:47], v5 offset:12288
    s_waitcnt lgkmcnt(2)
    v_mfma_f32_32x32x16_bf16 v[96:111], a[64:67], v[24:27], v[96:111]
    s_add_u32 m0, s45, 20480
    s_add_u32 s68, s69, 262144
    buffer_load_dwordx4 v1, s[52:55], s68 offen lds
    v_mfma_f32_32x32x16_bf16 v[128:143], a[64:67], v[28:31], v[128:143]
    s_add_u32 m0, s45, 21504
    s_add_u32 s68, s69, 327680
    buffer_load_dwordx4 v2, s[52:55], s68 offen lds
    v_mfma_f32_32x32x16_bf16 v[112:127], a[68:71], v[24:27], v[112:127]
    s_add_u32 m0, s45, 22528
    s_add_u32 s68, s69, 393216
    buffer_load_dwordx4 v1, s[52:55], s68 offen lds
    v_mfma_f32_32x32x16_bf16 v[144:159], a[68:71], v[28:31], v[144:159]
    s_add_u32 m0, s45, 23552
    s_add_u32 s68, s69, 458752
    buffer_load_dwordx4 v2, s[52:55], s68 offen lds
    ds_read_b128 v[24:27], v6 offset:8192
    ds_read_b128 v[28:31], v6 offset:12288
    s_waitcnt lgkmcnt(2)
    v_mfma_f32_32x32x16_bf16 v[96:111], a[72:75], v[40:43], v[96:111]
    v_mfma_f32_32x32x16_bf16 v[128:143], a[72:75], v[44:47], v[128:143]
    v_mfma_f32_32x32x16_bf16 v[112:127], a[76:79], v[40:43], v[112:127]
    v_mfma_f32_32x32x16_bf16 v[144:159], a[76:79], v[44:47], v[144:159]
    ds_read_b128 v[40:43], v7 offset:8192
    ds_read_b128 v[44:47], v7 offset:12288
    s_waitcnt lgkmcnt(2)
    v_mfma_f32_32x32x16_bf16 v[96:111], a[80:83], v[24:27], v[96:111]
    v_mfma_f32_32x32x16_bf16 v[128:143], a[80:83], v[28:31], v[128:143]
    v_mfma_f32_32x32x16_bf16 v[112:127], a[84:87], v[24:27], v[112:127]
    v_mfma_f32_32x32x16_bf16 v[144:159], a[84:87], v[28:31], v[144:159]
    s_waitcnt vmcnt(0)
    ds_read_b128 v[24:27], v4 offset:16384
    ds_read_b128 v[28:31], v4 offset:20480
    s_waitcnt lgkmcnt(2)
    v_mfma_f32_32x32x16_bf16 v[96:111], a[88:91], v[40:43], v[96:111]
    s_add_u32 s69, s74, 4
    s_and_b32 s69, s69, 7
    s_add_u32 s69, s69, 0
    s_lshl_b32 s69, s69, 7
    s_add_u32 s69, s69, s72
    s_add_u32 m0, s45, 8192
    s_add_u32 s68, s69, 0
    buffer_load_dwordx4 v1, s[52:55], s68 offen lds
    v_mfma_f32_32x32x16_bf16 v[128:143], a[88:91], v[44:47], v[128:143]
    s_add_u32 m0, s45, 9216
    s_add_u32 s68, s69, 65536
    buffer_load_dwordx4 v2, s[52:55], s68 offen lds
    v_mfma_f32_32x32x16_bf16 v[112:127], a[92:95], v[40:43], v[112:127]
    s_add_u32 m0, s45, 10240
    s_add_u32 s68, s69, 131072
    buffer_load_dwordx4 v1, s[52:55], s68 offen lds
    v_mfma_f32_32x32x16_bf16 v[144:159], a[92:95], v[44:47], v[144:159]
    s_add_u32 m0, s45, 11264
    s_add_u32 s68, s69, 196608
    buffer_load_dwordx4 v2, s[52:55], s68 offen lds
    ds_read_b128 v[40:43], v5 offset:16384
    ds_read_b128 v[44:47], v5 offset:20480
    s_waitcnt lgkmcnt(2)
    v_mfma_f32_32x32x16_bf16 v[96:111], a[96:99], v[24:27], v[96:111]
    s_add_u32 m0, s45, 12288
    s_add_u32 s68, s69, 262144
    buffer_load_dwordx4 v1, s[52:55], s68 offen lds
    v_mfma_f32_32x32x16_bf16 v[128:143], a[96:99], v[28:31], v[128:143]
    s_add_u32 m0, s45, 13312
    s_add_u32 s68, s69, 327680
    buffer_load_dwordx4 v2, s[52:55], s68 offen lds
    v_mfma_f32_32x32x16_bf16 v[112:127], a[100:103], v[24:27], v[112:127]
    s_add_u32 m0, s45, 14336
    s_add_u32 s68, s69, 393216
    buffer_load_dwordx4 v1, s[52:55], s68 offen lds
    v_mfma_f32_32x32x16_bf16 v[144:159], a[100:103], v[28:31], v[144:159]
    s_add_u32 m0, s45, 15360
    s_add_u32 s68, s69, 458752
    buffer_load_dwordx4 v2, s[52:55], s68 offen lds
    ds_read_b128 v[24:27], v6 offset:16384
    ds_read_b128 v[28:31], v6 offset:20480
    s_waitcnt lgkmcnt(2)
    v_mfma_f32_32x32x16_bf16 v[96:111], a[104:107], v[40:43], v[96:111]
    v_mfma_f32_32x32x16_bf16 v[128:143], a[104:107], v[44:47], v[128:143]
    v_mfma_f32_32x32x16_bf16 v[112:127], a[108:111], v[40:43], v[112:127]
    v_mfma_f32_32x32x16_bf16 v[144:159], a[108:111], v[44:47], v[144:159]
    ds_read_b128 v[40:43], v7 offset:16384
    ds_read_b128 v[44:47], v7 offset:20480
    s_waitcnt lgkmcnt(2)
    v_mfma_f32_32x32x16_bf16 v[96:111], a[112:115], v[24:27], v[96:111]
    v_mfma_f32_32x32x16_bf16 v[128:143], a[112:115], v[28:31], v[128:143]
    v_mfma_f32_32x32x16_bf16 v[112:127], a[116:119], v[24:27], v[112:127]
    v_mfma_f32_32x32x16_bf16 v[144:159], a[116:119], v[28:31], v[144:159]
    s_waitcnt vmcnt(0)
    ds_read_b128 v[24:27], v4 offset:8192
    ds_read_b128 v[28:31], v4 offset:12288
    s_waitcnt lgkmcnt(2)
    v_mfma_f32_32x32x16_bf16 v[96:111], a[120:123], v[40:43], v[96:111]
    s_add_u32 s69, s74, 5
    s_and_b32 s69, s69, 7
    s_add_u32 s69, s69, 0
    s_lshl_b32 s69, s69, 7
    s_add_u32 s69, s69, s72
    s_add_u32 m0, s45, 16384
    s_add_u32 s68, s69, 0
    buffer_load_dwordx4 v1, s[52:55], s68 offen lds
    v_mfma_f32_32x32x16_bf16 v[128:143], a[120:123], v[44:47], v[128:143]
    s_add_u32 m0, s45, 17408
    s_add_u32 s68, s69, 65536
    buffer_load_dwordx4 v2, s[52:55], s68 offen lds
    v_mfma_f32_32x32x16_bf16 v[112:127], a[124:127], v[40:43], v[112:127]
    s_add_u32 m0, s45, 18432
    s_add_u32 s68, s69, 131072
    buffer_load_dwordx4 v1, s[52:55], s68 offen lds
    v_mfma_f32_32x32x16_bf16 v[144:159], a[124:127], v[44:47], v[144:159]
    s_add_u32 m0, s45, 19456
    s_add_u32 s68, s69, 196608
    buffer_load_dwordx4 v2, s[52:55], s68 offen lds
    ds_read_b128 v[40:43], v5 offset:8192
    ds_read_b128 v[44:47], v5 offset:12288
    s_waitcnt lgkmcnt(2)
    v_mfma_f32_32x32x16_bf16 v[96:111], a[128:131], v[24:27], v[96:111]
    s_add_u32 m0, s45, 20480
    s_add_u32 s68, s69, 262144
    buffer_load_dwordx4 v1, s[52:55], s68 offen lds
    v_mfma_f32_32x32x16_bf16 v[128:143], a[128:131], v[28:31], v[128:143]
    s_add_u32 m0, s45, 21504
    s_add_u32 s68, s69, 327680
    buffer_load_dwordx4 v2, s[52:55], s68 offen lds
    v_mfma_f32_32x32x16_bf16 v[112:127], a[132:135], v[24:27], v[112:127]
    s_add_u32 m0, s45, 22528
    s_add_u32 s68, s69, 393216
    buffer_load_dwordx4 v1, s[52:55], s68 offen lds
    v_mfma_f32_32x32x16_bf16 v[144:159], a[132:135], v[28:31], v[144:159]
    s_add_u32 m0, s45, 23552
    s_add_u32 s68, s69, 458752
    buffer_load_dwordx4 v2, s[52:55], s68 offen lds
    ds_read_b128 v[24:27], v6 offset:8192
    ds_read_b128 v[28:31], v6 offset:12288
    s_waitcnt lgkmcnt(2)
    v_mfma_f32_32x32x16_bf16 v[96:111], a[136:139], v[40:43], v[96:111]
    v_mfma_f32_32x32x16_bf16 v[128:143], a[136:139], v[44:47], v[128:143]
    v_mfma_f32_32x32x16_bf16 v[112:127], a[140:143], v[40:43], v[112:127]
    v_mfma_f32_32x32x16_bf16 v[144:159], a[140:143], v[44:47], v[144:159]
    ds_read_b128 v[40:43], v7 offset:8192
    ds_read_b128 v[44:47], v7 offset:12288
    s_waitcnt lgkmcnt(2)
    v_mfma_f32_32x32x16_bf16 v[96:111], a[144:147], v[24:27], v[96:111]
    v_mfma_f32_32x32x16_bf16 v[128:143], a[144:147], v[28:31], v[128:143]
    v_mfma_f32_32x32x16_bf16 v[112:127], a[148:151], v[24:27], v[112:127]
    v_mfma_f32_32x32x16_bf16 v[144:159], a[148:151], v[28:31], v[144:159]
    s_waitcnt vmcnt(0)
    ds_read_b128 v[24:27], v4 offset:16384
    ds_read_b128 v[28:31], v4 offset:20480
    s_waitcnt lgkmcnt(2)
    v_mfma_f32_32x32x16_bf16 v[96:111], a[152:155], v[40:43], v[96:111]
    s_add_u32 s69, s74, 6
    s_and_b32 s69, s69, 7
    s_add_u32 s69, s69, 0
    s_lshl_b32 s69, s69, 7
    s_add_u32 s69, s69, s72
    s_add_u32 m0, s45, 8192
    s_add_u32 s68, s69, 0
    buffer_load_dwordx4 v1, s[52:55], s68 offen lds
    v_mfma_f32_32x32x16_bf16 v[128:143], a[152:155], v[44:47], v[128:143]
    s_add_u32 m0, s45, 9216
    s_add_u32 s68, s69, 65536
    buffer_load_dwordx4 v2, s[52:55], s68 offen lds
    v_mfma_f32_32x32x16_bf16 v[112:127], a[156:159], v[40:43], v[112:127]
    s_add_u32 m0, s45, 10240
    s_add_u32 s68, s69, 131072
    buffer_load_dwordx4 v1, s[52:55], s68 offen lds
    v_mfma_f32_32x32x16_bf16 v[144:159], a[156:159], v[44:47], v[144:159]
    s_add_u32 m0, s45, 11264
    s_add_u32 s68, s69, 196608
    buffer_load_dwordx4 v2, s[52:55], s68 offen lds
    ds_read_b128 v[40:43], v5 offset:16384
    ds_read_b128 v[44:47], v5 offset:20480
    s_waitcnt lgkmcnt(2)
    v_mfma_f32_32x32x16_bf16 v[96:111], a[160:163], v[24:27], v[96:111]
    s_add_u32 m0, s45, 12288
    s_add_u32 s68, s69, 262144
    buffer_load_dwordx4 v1, s[52:55], s68 offen lds
    v_mfma_f32_32x32x16_bf16 v[128:143], a[160:163], v[28:31], v[128:143]
    s_add_u32 m0, s45, 13312
    s_add_u32 s68, s69, 327680
    buffer_load_dwordx4 v2, s[52:55], s68 offen lds
    v_mfma_f32_32x32x16_bf16 v[112:127], a[164:167], v[24:27], v[112:127]
    s_add_u32 m0, s45, 14336
    s_add_u32 s68, s69, 393216
    buffer_load_dwordx4 v1, s[52:55], s68 offen lds
    v_mfma_f32_32x32x16_bf16 v[144:159], a[164:167], v[28:31], v[144:159]
    s_add_u32 m0, s45, 15360
    s_add_u32 s68, s69, 458752
    buffer_load_dwordx4 v2, s[52:55], s68 offen lds
    ds_read_b128 v[24:27], v6 offset:16384
    ds_read_b128 v[28:31], v6 offset:20480
    s_waitcnt lgkmcnt(2)
    v_mfma_f32_32x32x16_bf16 v[96:111], a[168:171], v[40:43], v[96:111]
    v_mfma_f32_32x32x16_bf16 v[128:143], a[168:171], v[44:47], v[128:143]
    v_mfma_f32_32x32x16_bf16 v[112:127], a[172:175], v[40:43], v[112:127]
    v_mfma_f32_32x32x16_bf16 v[144:159], a[172:175], v[44:47], v[144:159]
    ds_read_b128 v[40:43], v7 offset:16384
    ds_read_b128 v[44:47], v7 offset:20480
    s_waitcnt lgkmcnt(2)
    v_mfma_f32_32x32x16_bf16 v[96:111], a[176:179], v[24:27], v[96:111]
    v_mfma_f32_32x32x16_bf16 v[128:143], a[176:179], v[28:31], v[128:143]
    v_mfma_f32_32x32x16_bf16 v[112:127], a[180:183], v[24:27], v[112:127]
    v_mfma_f32_32x32x16_bf16 v[144:159], a[180:183], v[28:31], v[144:159]
    s_waitcnt vmcnt(0)
    ds_read_b128 v[24:27], v4 offset:8192
    ds_read_b128 v[28:31], v4 offset:12288
    s_waitcnt lgkmcnt(2)
    v_mfma_f32_32x32x16_bf16 v[96:111], a[184:187], v[40:43], v[96:111]
    s_add_u32 s69, s74, 7
    s_and_b32 s69, s69, 7
    s_add_u32 s69, s69, 0
    s_lshl_b32 s69, s69, 7
    s_add_u32 s69, s69, s72
    s_add_u32 m0, s45, 16384
    s_add_u32 s68, s69, 0
    buffer_load_dwordx4 v1, s[52:55], s68 offen lds
    v_mfma_f32_32x32x16_bf16 v[128:143], a[184:187], v[44:47], v[128:143]
    s_add_u32 m0, s45, 17408
    s_add_u32 s68, s69, 65536
    buffer_load_dwordx4 v2, s[52:55], s68 offen lds
    v_mfma_f32_32x32x16_bf16 v[112:127], a[188:191], v[40:43], v[112:127]
    s_add_u32 m0, s45, 18432
    s_add_u32 s68, s69, 131072
    buffer_load_dwordx4 v1, s[52:55], s68 offen lds
    v_mfma_f32_32x32x16_bf16 v[144:159], a[188:191], v[44:47], v[144:159]
    s_add_u32 m0, s45, 19456
    s_add_u32 s68, s69, 196608
    buffer_load_dwordx4 v2, s[52:55], s68 offen lds
    ds_read_b128 v[40:43], v5 offset:8192
    ds_read_b128 v[44:47], v5 offset:12288
    s_waitcnt lgkmcnt(2)
    v_mfma_f32_32x32x16_bf16 v[96:111], a[192:195], v[24:27], v[96:111]
    s_add_u32 m0, s45, 20480
    s_add_u32 s68, s69, 262144
    buffer_load_dwordx4 v1, s[52:55], s68 offen lds
    v_mfma_f32_32x32x16_bf16 v[128:143], a[192:195], v[28:31], v[128:143]
    s_add_u32 m0, s45, 21504
    s_add_u32 s68, s69, 327680
    buffer_load_dwordx4 v2, s[52:55], s68 offen lds
    v_mfma_f32_32x32x16_bf16 v[112:127], a[196:199], v[24:27], v[112:127]
    s_add_u32 m0, s45, 22528
    s_add_u32 s68, s69, 393216
    buffer_load_dwordx4 v1, s[52:55], s68 offen lds
    v_mfma_f32_32x32x16_bf16 v[144:159], a[196:199], v[28:31], v[144:159]
    s_add_u32 m0, s45, 23552
    s_add_u32 s68, s69, 458752
    buffer_load_dwordx4 v2, s[52:55], s68 offen lds
    ds_read_b128 v[24:27], v6 offset:8192
    ds_read_b128 v[28:31], v6 offset:12288
    s_waitcnt lgkmcnt(2)
    v_mfma_f32_32x32x16_bf16 v[96:111], a[200:203], v[40:43], v[96:111]
    v_mfma_f32_32x32x16_bf16 v[128:143], a[200:203], v[44:47], v[128:143]
    v_mfma_f32_32x32x16_bf16 v[112:127], a[204:207], v[40:43], v[112:127]
    v_mfma_f32_32x32x16_bf16 v[144:159], a[204:207], v[44:47], v[144:159]
    ds_read_b128 v[40:43], v7 offset:8192
    ds_read_b128 v[44:47], v7 offset:12288
    s_waitcnt lgkmcnt(2)
    v_mfma_f32_32x32x16_bf16 v[96:111], a[208:211], v[24:27], v[96:111]
    v_mfma_f32_32x32x16_bf16 v[128:143], a[208:211], v[28:31], v[128:143]
    v_mfma_f32_32x32x16_bf16 v[112:127], a[212:215], v[24:27], v[112:127]
    v_mfma_f32_32x32x16_bf16 v[144:159], a[212:215], v[28:31], v[144:159]
    s_waitcnt vmcnt(0)
    ds_read_b128 v[24:27], v4 offset:16384
    ds_read_b128 v[28:31], v4 offset:20480
    s_waitcnt lgkmcnt(2)
    v_mfma_f32_32x32x16_bf16 v[96:111], a[216:219], v[40:43], v[96:111]
    s_add_u32 s69, s74, 0
    s_and_b32 s69, s69, 7
    s_add_u32 s69, s69, 8
    s_lshl_b32 s69, s69, 7
    s_add_u32 s69, s69, s72
    s_add_u32 m0, s45, 8192
    s_add_u32 s68, s69, 0
    buffer_load_dwordx4 v1, s[52:55], s68 offen lds
    v_mfma_f32_32x32x16_bf16 v[128:143], a[216:219], v[44:47], v[128:143]
    s_add_u32 m0, s45, 9216
    s_add_u32 s68, s69, 65536
    buffer_load_dwordx4 v2, s[52:55], s68 offen lds
    v_mfma_f32_32x32x16_bf16 v[112:127], a[220:223], v[40:43], v[112:127]
    s_add_u32 m0, s45, 10240
    s_add_u32 s68, s69, 131072
    buffer_load_dwordx4 v1, s[52:55], s68 offen lds
    v_mfma_f32_32x32x16_bf16 v[144:159], a[220:223], v[44:47], v[144:159]
    s_add_u32 m0, s45, 11264
    s_add_u32 s68, s69, 196608
    buffer_load_dwordx4 v2, s[52:55], s68 offen lds
    ds_read_b128 v[40:43], v5 offset:16384
    ds_read_b128 v[44:47], v5 offset:20480
    s_waitcnt lgkmcnt(2)
    v_mfma_f32_32x32x16_bf16 v[96:111], a[224:227], v[24:27], v[96:111]
    s_add_u32 m0, s45, 12288
    s_add_u32 s68, s69, 262144
    buffer_load_dwordx4 v1, s[52:55], s68 offen lds
    v_mfma_f32_32x32x16_bf16 v[128:143], a[224:227], v[28:31], v[128:143]
    s_add_u32 m0, s45, 13312
    s_add_u32 s68, s69, 327680
    buffer_load_dwordx4 v2, s[52:55], s68 offen lds
    v_mfma_f32_32x32x16_bf16 v[112:127], a[228:231], v[24:27], v[112:127]
    s_add_u32 m0, s45, 14336
    s_add_u32 s68, s69, 393216
    buffer_load_dwordx4 v1, s[52:55], s68 offen lds
    v_mfma_f32_32x32x16_bf16 v[144:159], a[228:231], v[28:31], v[144:159]
    s_add_u32 m0, s45, 15360
    s_add_u32 s68, s69, 458752
    buffer_load_dwordx4 v2, s[52:55], s68 offen lds
    ds_read_b128 v[24:27], v6 offset:16384
    ds_read_b128 v[28:31], v6 offset:20480
    s_waitcnt lgkmcnt(2)
    v_mfma_f32_32x32x16_bf16 v[96:111], a[232:235], v[40:43], v[96:111]
    v_mfma_f32_32x32x16_bf16 v[128:143], a[232:235], v[44:47], v[128:143]
    v_mfma_f32_32x32x16_bf16 v[112:127], a[236:239], v[40:43], v[112:127]
    v_mfma_f32_32x32x16_bf16 v[144:159], a[236:239], v[44:47], v[144:159]
    ds_read_b128 v[40:43], v7 offset:16384
    ds_read_b128 v[44:47], v7 offset:20480
    s_waitcnt lgkmcnt(2)
    v_mfma_f32_32x32x16_bf16 v[96:111], a[240:243], v[24:27], v[96:111]
    v_mfma_f32_32x32x16_bf16 v[128:143], a[240:243], v[28:31], v[128:143]
    v_mfma_f32_32x32x16_bf16 v[112:127], a[244:247], v[24:27], v[112:127]
    v_mfma_f32_32x32x16_bf16 v[144:159], a[244:247], v[28:31], v[144:159]
    s_waitcnt vmcnt(0)
    ds_read_b128 v[24:27], v4 offset:8192
    ds_read_b128 v[28:31], v4 offset:12288
    ds_read_b64_tr_b16 v[32:33], v8 offset:24576
    ds_read_b64_tr_b16 v[34:35], v8 offset:25088
    ds_read_b64_tr_b16 v[36:37], v9 offset:24576
    ds_read_b64_tr_b16 v[38:39], v9 offset:25088
    s_waitcnt lgkmcnt(6)
    v_mfma_f32_32x32x16_bf16 v[96:111], a[248:251], v[40:43], v[96:111]
    s_add_u32 s69, s74, 3
    s_and_b32 s69, s69, 7
    s_add_u32 s69, s69, 8
    s_lshl_b32 s69, s69, 17
    s_add_u32 s69, s69, s73
    s_add_u32 m0, s45, 16384
    s_add_u32 s68, s69, 0
    buffer_load_dwordx4 v3, s[56:59], s68 offen lds
    v_mfma_f32_32x32x16_bf16 v[128:143], a[248:251], v[44:47], v[128:143]
    s_add_u32 m0, s45, 17408
    s_add_u32 s68, s69, 16384
    buffer_load_dwordx4 v3, s[56:59], s68 offen lds
    v_mfma_f32_32x32x16_bf16 v[112:127], a[252:255], v[40:43], v[112:127]
    s_add_u32 m0, s45, 18432
    s_add_u32 s68, s69, 32768
    buffer_load_dwordx4 v3, s[56:59], s68 offen lds
    v_mfma_f32_32x32x16_bf16 v[144:159], a[252:255], v[44:47], v[144:159]
    s_add_u32 m0, s45, 19456
    s_add_u32 s68, s69, 49152
    buffer_load_dwordx4 v3, s[56:59], s68 offen lds
    ds_read_b128 v[40:43], v5 offset:8192
    ds_read_b128 v[44:47], v5 offset:12288
    ds_read_b64_tr_b16 v[48:49], v8 offset:26624
    ds_read_b64_tr_b16 v[50:51], v8 offset:27136
    ds_read_b64_tr_b16 v[52:53], v9 offset:26624
    ds_read_b64_tr_b16 v[54:55], v9 offset:27136
    s_waitcnt lgkmcnt(6)
    v_mfma_f32_32x32x16_bf16 v[96:111], v[32:35], v[24:27], v[96:111]
    s_add_u32 m0, s45, 20480
    s_add_u32 s68, s69, 65536
    buffer_load_dwordx4 v3, s[56:59], s68 offen lds
    v_mfma_f32_32x32x16_bf16 v[128:143], v[32:35], v[28:31], v[128:143]
    s_add_u32 m0, s45, 21504
    s_add_u32 s68, s69, 81920
    buffer_load_dwordx4 v3, s[56:59], s68 offen lds
    v_mfma_f32_32x32x16_bf16 v[112:127], v[36:39], v[24:27], v[112:127]
    s_add_u32 m0, s45, 22528
    s_add_u32 s68, s69, 98304
    buffer_load_dwordx4 v3, s[56:59], s68 offen lds
    v_mfma_f32_32x32x16_bf16 v[144:159], v[36:39], v[28:31], v[144:159]
    s_add_u32 m0, s45, 23552
    s_add_u32 s68, s69, 114688
    buffer_load_dwordx4 v3, s[56:59], s68 offen lds
    ds_read_b128 v[24:27], v6 offset:8192
    ds_read_b128 v[28:31], v6 offset:12288
    ds_read_b64_tr_b16 v[32:33], v8 offset:28672
    ds_read_b64_tr_b16 v[34:35], v8 offset:29184
    ds_read_b64_tr_b16 v[36:37], v9 offset:28672
    ds_read_b64_tr_b16 v[38:39], v9 offset:29184
    s_waitcnt lgkmcnt(6)
    v_mfma_f32_32x32x16_bf16 v[96:111], v[48:51], v[40:43], v[96:111]
    v_mfma_f32_32x32x16_bf16 v[128:143], v[48:51], v[44:47], v[128:143]
    v_mfma_f32_32x32x16_bf16 v[112:127], v[52:55], v[40:43], v[112:127]
    v_mfma_f32_32x32x16_bf16 v[144:159], v[52:55], v[44:47], v[144:159]
    ds_read_b128 v[40:43], v7 offset:8192
    ds_read_b128 v[44:47], v7 offset:12288
    ds_read_b64_tr_b16 v[48:49], v8 offset:30720
    ds_read_b64_tr_b16 v[50:51], v8 offset:31232
    ds_read_b64_tr_b16 v[52:53], v9 offset:30720
    ds_read_b64_tr_b16 v[54:55], v9 offset:31232
    s_waitcnt lgkmcnt(6)
    v_mfma_f32_32x32x16_bf16 v[96:111], v[32:35], v[24:27], v[96:111]
    v_mfma_f32_32x32x16_bf16 v[128:143], v[32:35], v[28:31], v[128:143]
    v_mfma_f32_32x32x16_bf16 v[112:127], v[36:39], v[24:27], v[112:127]
    v_mfma_f32_32x32x16_bf16 v[144:159], v[36:39], v[28:31], v[144:159]
    s_waitcnt lgkmcnt(0)
    v_mfma_f32_32x32x16_bf16 v[96:111], v[48:51], v[40:43], v[96:111]
    s_add_u32 s69, s74, 1
    s_and_b32 s69, s69, 7
    s_add_u32 s69, s69, 8
    s_lshl_b32 s69, s69, 7
    s_add_u32 s69, s69, s72
    s_add_u32 m0, s45, 8192
    s_add_u32 s68, s69, 0
    buffer_load_dwordx4 v1, s[52:55], s68 offen lds
    v_mfma_f32_32x32x16_bf16 v[128:143], v[48:51], v[44:47], v[128:143]
    s_add_u32 m0, s45, 9216
    s_add_u32 s68, s69, 65536
    buffer_load_dwordx4 v2, s[52:55], s68 offen lds
    v_mfma_f32_32x32x16_bf16 v[112:127], v[52:55], v[40:43], v[112:127]
    s_add_u32 m0, s45, 10240
    s_add_u32 s68, s69, 131072
    buffer_load_dwordx4 v1, s[52:55], s68 offen lds
    v_mfma_f32_32x32x16_bf16 v[144:159], v[52:55], v[44:47], v[144:159]
    s_add_u32 m0, s45, 11264
    s_add_u32 s68, s69, 196608
    buffer_load_dwordx4 v2, s[52:55], s68 offen lds
    s_add_u32 m0, s45, 12288
    s_add_u32 s68, s69, 262144
    buffer_load_dwordx4 v1, s[52:55], s68 offen lds
    s_add_u32 m0, s45, 13312
    s_add_u32 s68, s69, 327680
    buffer_load_dwordx4 v2, s[52:55], s68 offen lds
    s_add_u32 m0, s45, 14336
    s_add_u32 s68, s69, 393216
    buffer_load_dwordx4 v1, s[52:55], s68 offen lds
    s_add_u32 m0, s45, 15360
    s_add_u32 s68, s69, 458752
    buffer_load_dwordx4 v2, s[52:55], s68 offen lds
    s_waitcnt vmcnt(0)
    ds_read_b128 v[24:27], v4 offset:8192
    ds_read_b128 v[28:31], v4 offset:12288
    ds_read_b64_tr_b16 v[32:33], v8 offset:32768
    ds_read_b64_tr_b16 v[34:35], v8 offset:33280
    ds_read_b64_tr_b16 v[36:37], v9 offset:32768
    ds_read_b64_tr_b16 v[38:39], v9 offset:33280
    ds_read_b128 v[40:43], v5 offset:8192
    ds_read_b128 v[44:47], v5 offset:12288
    ds_read_b64_tr_b16 v[48:49], v8 offset:34816
    ds_read_b64_tr_b16 v[50:51], v8 offset:35328
    ds_read_b64_tr_b16 v[52:53], v9 offset:34816
    ds_read_b64_tr_b16 v[54:55], v9 offset:35328
    s_waitcnt lgkmcnt(6)
    v_mfma_f32_32x32x16_bf16 v[96:111], v[32:35], v[24:27], v[96:111]
    s_add_u32 s69, s74, 4
    s_and_b32 s69, s69, 7
    s_add_u32 s69, s69, 8
    s_lshl_b32 s69, s69, 17
    s_add_u32 s69, s69, s73
    s_add_u32 m0, s45, 24576
    s_add_u32 s68, s69, 0
    buffer_load_dwordx4 v3, s[56:59], s68 offen lds
    v_mfma_f32_32x32x16_bf16 v[128:143], v[32:35], v[28:31], v[128:143]
    s_add_u32 m0, s45, 25600
    s_add_u32 s68, s69, 16384
    buffer_load_dwordx4 v3, s[56:59], s68 offen lds
    v_mfma_f32_32x32x16_bf16 v[112:127], v[36:39], v[24:27], v[112:127]
    s_add_u32 m0, s45, 26624
    s_add_u32 s68, s69, 32768
    buffer_load_dwordx4 v3, s[56:59], s68 offen lds
    v_mfma_f32_32x32x16_bf16 v[144:159], v[36:39], v[28:31], v[144:159]
    s_add_u32 m0, s45, 27648
    s_add_u32 s68, s69, 49152
    buffer_load_dwordx4 v3, s[56:59], s68 offen lds
    ds_read_b128 v[24:27], v6 offset:8192
    ds_read_b128 v[28:31], v6 offset:12288
    ds_read_b64_tr_b16 v[32:33], v8 offset:36864
    ds_read_b64_tr_b16 v[34:35], v8 offset:37376
    ds_read_b64_tr_b16 v[36:37], v9 offset:36864
    ds_read_b64_tr_b16 v[38:39], v9 offset:37376
    s_waitcnt lgkmcnt(6)
    v_mfma_f32_32x32x16_bf16 v[96:111], v[48:51], v[40:43], v[96:111]
    s_add_u32 m0, s45, 28672
    s_add_u32 s68, s69, 65536
    buffer_load_dwordx4 v3, s[56:59], s68 offen lds
    v_mfma_f32_32x32x16_bf16 v[128:143], v[48:51], v[44:47], v[128:143]
    s_add_u32 m0, s45, 29696
    s_add_u32 s68, s69, 81920
    buffer_load_dwordx4 v3, s[56:59], s68 offen lds
    v_mfma_f32_32x32x16_bf16 v[112:127], v[52:55], v[40:43], v[112:127]
    s_add_u32 m0, s45, 30720
    s_add_u32 s68, s69, 98304
    buffer_load_dwordx4 v3, s[56:59], s68 offen lds
    v_mfma_f32_32x32x16_bf16 v[144:159], v[52:55], v[44:47], v[144:159]
    s_add_u32 m0, s45, 31744
    s_add_u32 s68, s69, 114688
    buffer_load_dwordx4 v3, s[56:59], s68 offen lds
    ds_read_b128 v[40:43], v7 offset:8192
    ds_read_b128 v[44:47], v7 offset:12288
    ds_read_b64_tr_b16 v[48:49], v8 offset:38912
    ds_read_b64_tr_b16 v[50:51], v8 offset:39424
    ds_read_b64_tr_b16 v[52:53], v9 offset:38912
    ds_read_b64_tr_b16 v[54:55], v9 offset:39424
    s_waitcnt lgkmcnt(6)
    v_mfma_f32_32x32x16_bf16 v[96:111], v[32:35], v[24:27], v[96:111]
    v_mfma_f32_32x32x16_bf16 v[128:143], v[32:35], v[28:31], v[128:143]
    v_mfma_f32_32x32x16_bf16 v[112:127], v[36:39], v[24:27], v[112:127]
    v_mfma_f32_32x32x16_bf16 v[144:159], v[36:39], v[28:31], v[144:159]
    s_waitcnt lgkmcnt(0)
    v_mfma_f32_32x32x16_bf16 v[96:111], v[48:51], v[40:43], v[96:111]
    s_add_u32 s69, s74, 2
    s_and_b32 s69, s69, 7
    s_add_u32 s69, s69, 8
    s_lshl_b32 s69, s69, 7
    s_add_u32 s69, s69, s72
    s_add_u32 m0, s45, 8192
    s_add_u32 s68, s69, 0
    buffer_load_dwordx4 v1, s[52:55], s68 offen lds
    v_mfma_f32_32x32x16_bf16 v[128:143], v[48:51], v[44:47], v[128:143]
    s_add_u32 m0, s45, 9216
    s_add_u32 s68, s69, 65536
    buffer_load_dwordx4 v2, s[52:55], s68 offen lds
    v_mfma_f32_32x32x16_bf16 v[112:127], v[52:55], v[40:43], v[112:127]
    s_add_u32 m0, s45, 10240
    s_add_u32 s68, s69, 131072
    buffer_load_dwordx4 v1, s[52:55], s68 offen lds
    v_mfma_f32_32x32x16_bf16 v[144:159], v[52:55], v[44:47], v[144:159]
    s_add_u32 m0, s45, 11264
    s_add_u32 s68, s69, 196608
    buffer_load_dwordx4 v2, s[52:55], s68 offen lds
    s_add_u32 m0, s45, 12288
    s_add_u32 s68, s69, 262144
    buffer_load_dwordx4 v1, s[52:55], s68 offen lds
    s_add_u32 m0, s45, 13312
    s_add_u32 s68, s69, 327680
    buffer_load_dwordx4 v2, s[52:55], s68 offen lds
    s_add_u32 m0, s45, 14336
    s_add_u32 s68, s69, 393216
    buffer_load_dwordx4 v1, s[52:55], s68 offen lds
    s_add_u32 m0, s45, 15360
    s_add_u32 s68, s69, 458752
    buffer_load_dwordx4 v2, s[52:55], s68 offen lds
    s_waitcnt vmcnt(0)
    ds_read_b128 v[24:27], v4 offset:8192
    ds_read_b128 v[28:31], v4 offset:12288
    ds_read_b64_tr_b16 v[32:33], v8 offset:0
    ds_read_b64_tr_b16 v[34:35], v8 offset:512
    ds_read_b64_tr_b16 v[36:37], v9 offset:0
    ds_read_b64_tr_b16 v[38:39], v9 offset:512
    ds_read_b128 v[40:43], v5 offset:8192
    ds_read_b128 v[44:47], v5 offset:12288
    ds_read_b64_tr_b16 v[48:49], v8 offset:2048
    ds_read_b64_tr_b16 v[50:51], v8 offset:2560
    ds_read_b64_tr_b16 v[52:53], v9 offset:2048
    ds_read_b64_tr_b16 v[54:55], v9 offset:2560
    s_waitcnt lgkmcnt(6)
    v_mfma_f32_32x32x16_bf16 v[96:111], v[32:35], v[24:27], v[96:111]
    s_add_u32 s69, s74, 5
    s_and_b32 s69, s69, 7
    s_add_u32 s69, s69, 8
    s_lshl_b32 s69, s69, 17
    s_add_u32 s69, s69, s73
    s_add_u32 m0, s45, 32768
    s_add_u32 s68, s69, 0
    buffer_load_dwordx4 v3, s[56:59], s68 offen lds
    v_mfma_f32_32x32x16_bf16 v[128:143], v[32:35], v[28:31], v[128:143]
    s_add_u32 m0, s45, 33792
    s_add_u32 s68, s69, 16384
    buffer_load_dwordx4 v3, s[56:59], s68 offen lds
    v_mfma_f32_32x32x16_bf16 v[112:127], v[36:39], v[24:27], v[112:127]
    s_add_u32 m0, s45, 34816
    s_add_u32 s68, s69, 32768
    buffer_load_dwordx4 v3, s[56:59], s68 offen lds
    v_mfma_f32_32x32x16_bf16 v[144:159], v[36:39], v[28:31], v[144:159]
    s_add_u32 m0, s45, 35840
    s_add_u32 s68, s69, 49152
    buffer_load_dwordx4 v3, s[56:59], s68 offen lds
    ds_read_b128 v[24:27], v6 offset:8192
    ds_read_b128 v[28:31], v6 offset:12288
    ds_read_b64_tr_b16 v[32:33], v8 offset:4096
    ds_read_b64_tr_b16 v[34:35], v8 offset:4608
    ds_read_b64_tr_b16 v[36:37], v9 offset:4096
    ds_read_b64_tr_b16 v[38:39], v9 offset:4608
    s_waitcnt lgkmcnt(6)
    v_mfma_f32_32x32x16_bf16 v[96:111], v[48:51], v[40:43], v[96:111]
    s_add_u32 m0, s45, 36864
    s_add_u32 s68, s69, 65536
    buffer_load_dwordx4 v3, s[56:59], s68 offen lds
    v_mfma_f32_32x32x16_bf16 v[128:143], v[48:51], v[44:47], v[128:143]
    s_add_u32 m0, s45, 37888
    s_add_u32 s68, s69, 81920
    buffer_load_dwordx4 v3, s[56:59], s68 offen lds
    v_mfma_f32_32x32x16_bf16 v[112:127], v[52:55], v[40:43], v[112:127]
    s_add_u32 m0, s45, 38912
    s_add_u32 s68, s69, 98304
    buffer_load_dwordx4 v3, s[56:59], s68 offen lds
    v_mfma_f32_32x32x16_bf16 v[144:159], v[52:55], v[44:47], v[144:159]
    s_add_u32 m0, s45, 39936
    s_add_u32 s68, s69, 114688
    buffer_load_dwordx4 v3, s[56:59], s68 offen lds
    ds_read_b128 v[40:43], v7 offset:8192
    ds_read_b128 v[44:47], v7 offset:12288
    ds_read_b64_tr_b16 v[48:49], v8 offset:6144
    ds_read_b64_tr_b16 v[50:51], v8 offset:6656
    ds_read_b64_tr_b16 v[52:53], v9 offset:6144
    ds_read_b64_tr_b16 v[54:55], v9 offset:6656
    s_waitcnt lgkmcnt(6)
    v_mfma_f32_32x32x16_bf16 v[96:111], v[32:35], v[24:27], v[96:111]
    v_mfma_f32_32x32x16_bf16 v[128:143], v[32:35], v[28:31], v[128:143]
    v_mfma_f32_32x32x16_bf16 v[112:127], v[36:39], v[24:27], v[112:127]
    v_mfma_f32_32x32x16_bf16 v[144:159], v[36:39], v[28:31], v[144:159]
    s_waitcnt lgkmcnt(0)
    v_mfma_f32_32x32x16_bf16 v[96:111], v[48:51], v[40:43], v[96:111]
    s_add_u32 s69, s74, 3
    s_and_b32 s69, s69, 7
    s_add_u32 s69, s69, 8
    s_lshl_b32 s69, s69, 7
    s_add_u32 s69, s69, s72
    s_add_u32 m0, s45, 8192
    s_add_u32 s68, s69, 0
    buffer_load_dwordx4 v1, s[52:55], s68 offen lds
    v_mfma_f32_32x32x16_bf16 v[128:143], v[48:51], v[44:47], v[128:143]
    s_add_u32 m0, s45, 9216
    s_add_u32 s68, s69, 65536
    buffer_load_dwordx4 v2, s[52:55], s68 offen lds
    v_mfma_f32_32x32x16_bf16 v[112:127], v[52:55], v[40:43], v[112:127]
    s_add_u32 m0, s45, 10240
    s_add_u32 s68, s69, 131072
    buffer_load_dwordx4 v1, s[52:55], s68 offen lds
    v_mfma_f32_32x32x16_bf16 v[144:159], v[52:55], v[44:47], v[144:159]
    s_add_u32 m0, s45, 11264
    s_add_u32 s68, s69, 196608
    buffer_load_dwordx4 v2, s[52:55], s68 offen lds
    s_add_u32 m0, s45, 12288
    s_add_u32 s68, s69, 262144
    buffer_load_dwordx4 v1, s[52:55], s68 offen lds
    s_add_u32 m0, s45, 13312
    s_add_u32 s68, s69, 327680
    buffer_load_dwordx4 v2, s[52:55], s68 offen lds
    s_add_u32 m0, s45, 14336
    s_add_u32 s68, s69, 393216
    buffer_load_dwordx4 v1, s[52:55], s68 offen lds
    s_add_u32 m0, s45, 15360
    s_add_u32 s68, s69, 458752
    buffer_load_dwordx4 v2, s[52:55], s68 offen lds
    s_waitcnt vmcnt(0)
    ds_read_b128 v[24:27], v4 offset:8192
    ds_read_b128 v[28:31], v4 offset:12288
    ds_read_b64_tr_b16 v[32:33], v8 offset:16384
    ds_read_b64_tr_b16 v[34:35], v8 offset:16896
    ds_read_b64_tr_b16 v[36:37], v9 offset:16384
    ds_read_b64_tr_b16 v[38:39], v9 offset:16896
    ds_read_b128 v[40:43], v5 offset:8192
    ds_read_b128 v[44:47], v5 offset:12288
    ds_read_b64_tr_b16 v[48:49], v8 offset:18432
    ds_read_b64_tr_b16 v[50:51], v8 offset:18944
    ds_read_b64_tr_b16 v[52:53], v9 offset:18432
    ds_read_b64_tr_b16 v[54:55], v9 offset:18944
    s_waitcnt lgkmcnt(6)
    v_mfma_f32_32x32x16_bf16 v[96:111], v[32:35], v[24:27], v[96:111]
    s_add_u32 s69, s74, 6
    s_and_b32 s69, s69, 7
    s_add_u32 s69, s69, 8
    s_lshl_b32 s69, s69, 17
    s_add_u32 s69, s69, s73
    s_add_u32 m0, s45, 0
    s_add_u32 s68, s69, 0
    buffer_load_dwordx4 v3, s[56:59], s68 offen lds
    v_mfma_f32_32x32x16_bf16 v[128:143], v[32:35], v[28:31], v[128:143]
    s_add_u32 m0, s45, 1024
    s_add_u32 s68, s69, 16384
    buffer_load_dwordx4 v3, s[56:59], s68 offen lds
    v_mfma_f32_32x32x16_bf16 v[112:127], v[36:39], v[24:27], v[112:127]
    s_add_u32 m0, s45, 2048
    s_add_u32 s68, s69, 32768
    buffer_load_dwordx4 v3, s[56:59], s68 offen lds
    v_mfma_f32_32x32x16_bf16 v[144:159], v[36:39], v[28:31], v[144:159]
    s_add_u32 m0, s45, 3072
    s_add_u32 s68, s69, 49152
    buffer_load_dwordx4 v3, s[56:59], s68 offen lds
    ds_read_b128 v[24:27], v6 offset:8192
    ds_read_b128 v[28:31], v6 offset:12288
    ds_read_b64_tr_b16 v[32:33], v8 offset:20480
    ds_read_b64_tr_b16 v[34:35], v8 offset:20992
    ds_read_b64_tr_b16 v[36:37], v9 offset:20480
    ds_read_b64_tr_b16 v[38:39], v9 offset:20992
    s_waitcnt lgkmcnt(6)
    v_mfma_f32_32x32x16_bf16 v[96:111], v[48:51], v[40:43], v[96:111]
    s_add_u32 m0, s45, 4096
    s_add_u32 s68, s69, 65536
    buffer_load_dwordx4 v3, s[56:59], s68 offen lds
    v_mfma_f32_32x32x16_bf16 v[128:143], v[48:51], v[44:47], v[128:143]
    s_add_u32 m0, s45, 5120
    s_add_u32 s68, s69, 81920
    buffer_load_dwordx4 v3, s[56:59], s68 offen lds
    v_mfma_f32_32x32x16_bf16 v[112:127], v[52:55], v[40:43], v[112:127]
    s_add_u32 m0, s45, 6144
    s_add_u32 s68, s69, 98304
    buffer_load_dwordx4 v3, s[56:59], s68 offen lds
    v_mfma_f32_32x32x16_bf16 v[144:159], v[52:55], v[44:47], v[144:159]
    s_add_u32 m0, s45, 7168
    s_add_u32 s68, s69, 114688
    buffer_load_dwordx4 v3, s[56:59], s68 offen lds
    ds_read_b128 v[40:43], v7 offset:8192
    ds_read_b128 v[44:47], v7 offset:12288
    ds_read_b64_tr_b16 v[48:49], v8 offset:22528
    ds_read_b64_tr_b16 v[50:51], v8 offset:23040
    ds_read_b64_tr_b16 v[52:53], v9 offset:22528
    ds_read_b64_tr_b16 v[54:55], v9 offset:23040
    s_waitcnt lgkmcnt(6)
    v_mfma_f32_32x32x16_bf16 v[96:111], v[32:35], v[24:27], v[96:111]
    v_mfma_f32_32x32x16_bf16 v[128:143], v[32:35], v[28:31], v[128:143]
    v_mfma_f32_32x32x16_bf16 v[112:127], v[36:39], v[24:27], v[112:127]
    v_mfma_f32_32x32x16_bf16 v[144:159], v[36:39], v[28:31], v[144:159]
    s_waitcnt lgkmcnt(0)
    v_mfma_f32_32x32x16_bf16 v[96:111], v[48:51], v[40:43], v[96:111]
    s_add_u32 s69, s74, 4
    s_and_b32 s69, s69, 7
    s_add_u32 s69, s69, 8
    s_lshl_b32 s69, s69, 7
    s_add_u32 s69, s69, s72
    s_add_u32 m0, s45, 8192
    s_add_u32 s68, s69, 0
    buffer_load_dwordx4 v1, s[52:55], s68 offen lds
    v_mfma_f32_32x32x16_bf16 v[128:143], v[48:51], v[44:47], v[128:143]
    s_add_u32 m0, s45, 9216
    s_add_u32 s68, s69, 65536
    buffer_load_dwordx4 v2, s[52:55], s68 offen lds
    v_mfma_f32_32x32x16_bf16 v[112:127], v[52:55], v[40:43], v[112:127]
    s_add_u32 m0, s45, 10240
    s_add_u32 s68, s69, 131072
    buffer_load_dwordx4 v1, s[52:55], s68 offen lds
    v_mfma_f32_32x32x16_bf16 v[144:159], v[52:55], v[44:47], v[144:159]
    s_add_u32 m0, s45, 11264
    s_add_u32 s68, s69, 196608
    buffer_load_dwordx4 v2, s[52:55], s68 offen lds
    s_add_u32 m0, s45, 12288
    s_add_u32 s68, s69, 262144
    buffer_load_dwordx4 v1, s[52:55], s68 offen lds
    s_add_u32 m0, s45, 13312
    s_add_u32 s68, s69, 327680
    buffer_load_dwordx4 v2, s[52:55], s68 offen lds
    s_add_u32 m0, s45, 14336
    s_add_u32 s68, s69, 393216
    buffer_load_dwordx4 v1, s[52:55], s68 offen lds
    s_add_u32 m0, s45, 15360
    s_add_u32 s68, s69, 458752
    buffer_load_dwordx4 v2, s[52:55], s68 offen lds
    s_waitcnt vmcnt(0)
    ds_read_b128 v[24:27], v4 offset:8192
    ds_read_b128 v[28:31], v4 offset:12288
    ds_read_b64_tr_b16 v[32:33], v8 offset:24576
    ds_read_b64_tr_b16 v[34:35], v8 offset:25088
    ds_read_b64_tr_b16 v[36:37], v9 offset:24576
    ds_read_b64_tr_b16 v[38:39], v9 offset:25088
    ds_read_b128 v[40:43], v5 offset:8192
    ds_read_b128 v[44:47], v5 offset:12288
    ds_read_b64_tr_b16 v[48:49], v8 offset:26624
    ds_read_b64_tr_b16 v[50:51], v8 offset:27136
    ds_read_b64_tr_b16 v[52:53], v9 offset:26624
    ds_read_b64_tr_b16 v[54:55], v9 offset:27136
    s_waitcnt lgkmcnt(6)
    v_mfma_f32_32x32x16_bf16 v[96:111], v[32:35], v[24:27], v[96:111]
    s_add_u32 s69, s74, 7
    s_and_b32 s69, s69, 7
    s_add_u32 s69, s69, 8
    s_lshl_b32 s69, s69, 17
    s_add_u32 s69, s69, s73
    s_add_u32 m0, s45, 16384
    s_add_u32 s68, s69, 0
    buffer_load_dwordx4 v3, s[56:59], s68 offen lds
    v_mfma_f32_32x32x16_bf16 v[128:143], v[32:35], v[28:31], v[128:143]
    s_add_u32 m0, s45, 17408
    s_add_u32 s68, s69, 16384
    buffer_load_dwordx4 v3, s[56:59], s68 offen lds
    v_mfma_f32_32x32x16_bf16 v[112:127], v[36:39], v[24:27], v[112:127]
    s_add_u32 m0, s45, 18432
    s_add_u32 s68, s69, 32768
    buffer_load_dwordx4 v3, s[56:59], s68 offen lds
    v_mfma_f32_32x32x16_bf16 v[144:159], v[36:39], v[28:31], v[144:159]
    s_add_u32 m0, s45, 19456
    s_add_u32 s68, s69, 49152
    buffer_load_dwordx4 v3, s[56:59], s68 offen lds
    ds_read_b128 v[24:27], v6 offset:8192
    ds_read_b128 v[28:31], v6 offset:12288
    ds_read_b64_tr_b16 v[32:33], v8 offset:28672
    ds_read_b64_tr_b16 v[34:35], v8 offset:29184
    ds_read_b64_tr_b16 v[36:37], v9 offset:28672
    ds_read_b64_tr_b16 v[38:39], v9 offset:29184
    s_waitcnt lgkmcnt(6)
    v_mfma_f32_32x32x16_bf16 v[96:111], v[48:51], v[40:43], v[96:111]
    s_add_u32 m0, s45, 20480
    s_add_u32 s68, s69, 65536
    buffer_load_dwordx4 v3, s[56:59], s68 offen lds
    v_mfma_f32_32x32x16_bf16 v[128:143], v[48:51], v[44:47], v[128:143]
    s_add_u32 m0, s45, 21504
    s_add_u32 s68, s69, 81920
    buffer_load_dwordx4 v3, s[56:59], s68 offen lds
    v_mfma_f32_32x32x16_bf16 v[112:127], v[52:55], v[40:43], v[112:127]
    s_add_u32 m0, s45, 22528
    s_add_u32 s68, s69, 98304
    buffer_load_dwordx4 v3, s[56:59], s68 offen lds
    v_mfma_f32_32x32x16_bf16 v[144:159], v[52:55], v[44:47], v[144:159]
    s_add_u32 m0, s45, 23552
    s_add_u32 s68, s69, 114688
    buffer_load_dwordx4 v3, s[56:59], s68 offen lds
    ds_read_b128 v[40:43], v7 offset:8192
    ds_read_b128 v[44:47], v7 offset:12288
    ds_read_b64_tr_b16 v[48:49], v8 offset:30720
    ds_read_b64_tr_b16 v[50:51], v8 offset:31232
    ds_read_b64_tr_b16 v[52:53], v9 offset:30720
    ds_read_b64_tr_b16 v[54:55], v9 offset:31232
    s_waitcnt lgkmcnt(6)
    v_mfma_f32_32x32x16_bf16 v[96:111], v[32:35], v[24:27], v[96:111]
    v_mfma_f32_32x32x16_bf16 v[128:143], v[32:35], v[28:31], v[128:143]
    v_mfma_f32_32x32x16_bf16 v[112:127], v[36:39], v[24:27], v[112:127]
    v_mfma_f32_32x32x16_bf16 v[144:159], v[36:39], v[28:31], v[144:159]
    s_waitcnt lgkmcnt(0)
    v_mfma_f32_32x32x16_bf16 v[96:111], v[48:51], v[40:43], v[96:111]
    s_add_u32 s69, s74, 5
    s_and_b32 s69, s69, 7
    s_add_u32 s69, s69, 8
    s_lshl_b32 s69, s69, 7
    s_add_u32 s69, s69, s72
    s_add_u32 m0, s45, 8192
    s_add_u32 s68, s69, 0
    buffer_load_dwordx4 v1, s[52:55], s68 offen lds
    v_mfma_f32_32x32x16_bf16 v[128:143], v[48:51], v[44:47], v[128:143]
    s_add_u32 m0, s45, 9216
    s_add_u32 s68, s69, 65536
    buffer_load_dwordx4 v2, s[52:55], s68 offen lds
    v_mfma_f32_32x32x16_bf16 v[112:127], v[52:55], v[40:43], v[112:127]
    s_add_u32 m0, s45, 10240
    s_add_u32 s68, s69, 131072
    buffer_load_dwordx4 v1, s[52:55], s68 offen lds
    v_mfma_f32_32x32x16_bf16 v[144:159], v[52:55], v[44:47], v[144:159]
    s_add_u32 m0, s45, 11264
    s_add_u32 s68, s69, 196608
    buffer_load_dwordx4 v2, s[52:55], s68 offen lds
    s_add_u32 m0, s45, 12288
    s_add_u32 s68, s69, 262144
    buffer_load_dwordx4 v1, s[52:55], s68 offen lds
    s_add_u32 m0, s45, 13312
    s_add_u32 s68, s69, 327680
    buffer_load_dwordx4 v2, s[52:55], s68 offen lds
    s_add_u32 m0, s45, 14336
    s_add_u32 s68, s69, 393216
    buffer_load_dwordx4 v1, s[52:55], s68 offen lds
    s_add_u32 m0, s45, 15360
    s_add_u32 s68, s69, 458752
    buffer_load_dwordx4 v2, s[52:55], s68 offen lds
    s_waitcnt vmcnt(0)
    ds_read_b128 v[24:27], v4 offset:8192
    ds_read_b128 v[28:31], v4 offset:12288
    ds_read_b64_tr_b16 v[32:33], v8 offset:32768
    ds_read_b64_tr_b16 v[34:35], v8 offset:33280
    ds_read_b64_tr_b16 v[36:37], v9 offset:32768
    ds_read_b64_tr_b16 v[38:39], v9 offset:33280
    ds_read_b128 v[40:43], v5 offset:8192
    ds_read_b128 v[44:47], v5 offset:12288
    ds_read_b64_tr_b16 v[48:49], v8 offset:34816
    ds_read_b64_tr_b16 v[50:51], v8 offset:35328
    ds_read_b64_tr_b16 v[52:53], v9 offset:34816
    ds_read_b64_tr_b16 v[54:55], v9 offset:35328
    s_waitcnt lgkmcnt(6)
    v_mfma_f32_32x32x16_bf16 v[96:111], v[32:35], v[24:27], v[96:111]
    s_add_u32 s69, s74, 6
    s_and_b32 s69, s69, 7
    s_add_u32 s69, s69, 8
    s_lshl_b32 s69, s69, 7
    s_add_u32 s69, s69, s72
    s_add_u32 m0, s45, 24576
    s_add_u32 s68, s69, 0
    buffer_load_dwordx4 v1, s[52:55], s68 offen lds
    v_mfma_f32_32x32x16_bf16 v[128:143], v[32:35], v[28:31], v[128:143]
    s_add_u32 m0, s45, 25600
    s_add_u32 s68, s69, 65536
    buffer_load_dwordx4 v2, s[52:55], s68 offen lds
    v_mfma_f32_32x32x16_bf16 v[112:127], v[36:39], v[24:27], v[112:127]
    s_add_u32 m0, s45, 26624
    s_add_u32 s68, s69, 131072
    buffer_load_dwordx4 v1, s[52:55], s68 offen lds
    v_mfma_f32_32x32x16_bf16 v[144:159], v[36:39], v[28:31], v[144:159]
    s_add_u32 m0, s45, 27648
    s_add_u32 s68, s69, 196608
    buffer_load_dwordx4 v2, s[52:55], s68 offen lds
    ds_read_b128 v[24:27], v6 offset:8192
    ds_read_b128 v[28:31], v6 offset:12288
    ds_read_b64_tr_b16 v[32:33], v8 offset:36864
    ds_read_b64_tr_b16 v[34:35], v8 offset:37376
    ds_read_b64_tr_b16 v[36:37], v9 offset:36864
    ds_read_b64_tr_b16 v[38:39], v9 offset:37376
    s_waitcnt lgkmcnt(6)
    v_mfma_f32_32x32x16_bf16 v[96:111], v[48:51], v[40:43], v[96:111]
    s_add_u32 m0, s45, 28672
    s_add_u32 s68, s69, 262144
    buffer_load_dwordx4 v1, s[52:55], s68 offen lds
    v_mfma_f32_32x32x16_bf16 v[128:143], v[48:51], v[44:47], v[128:143]
    s_add_u32 m0, s45, 29696
    s_add_u32 s68, s69, 327680
    buffer_load_dwordx4 v2, s[52:55], s68 offen lds
    v_mfma_f32_32x32x16_bf16 v[112:127], v[52:55], v[40:43], v[112:127]
    s_add_u32 m0, s45, 30720
    s_add_u32 s68, s69, 393216
    buffer_load_dwordx4 v1, s[52:55], s68 offen lds
    v_mfma_f32_32x32x16_bf16 v[144:159], v[52:55], v[44:47], v[144:159]
    s_add_u32 m0, s45, 31744
    s_add_u32 s68, s69, 458752
    buffer_load_dwordx4 v2, s[52:55], s68 offen lds
    ds_read_b128 v[40:43], v7 offset:8192
    ds_read_b128 v[44:47], v7 offset:12288
    ds_read_b64_tr_b16 v[48:49], v8 offset:38912
    ds_read_b64_tr_b16 v[50:51], v8 offset:39424
    ds_read_b64_tr_b16 v[52:53], v9 offset:38912
    ds_read_b64_tr_b16 v[54:55], v9 offset:39424
    s_waitcnt lgkmcnt(6)
    v_mfma_f32_32x32x16_bf16 v[96:111], v[32:35], v[24:27], v[96:111]
    v_mfma_f32_32x32x16_bf16 v[128:143], v[32:35], v[28:31], v[128:143]
    v_mfma_f32_32x32x16_bf16 v[112:127], v[36:39], v[24:27], v[112:127]
    v_mfma_f32_32x32x16_bf16 v[144:159], v[36:39], v[28:31], v[144:159]
    s_waitcnt vmcnt(0)
    ds_read_b128 v[24:27], v4 offset:24576
    ds_read_b128 v[28:31], v4 offset:28672
    ds_read_b64_tr_b16 v[32:33], v8 offset:0
    ds_read_b64_tr_b16 v[34:35], v8 offset:512
    ds_read_b64_tr_b16 v[36:37], v9 offset:0
    ds_read_b64_tr_b16 v[38:39], v9 offset:512
    s_waitcnt lgkmcnt(6)
    v_mfma_f32_32x32x16_bf16 v[96:111], v[48:51], v[40:43], v[96:111]
    s_add_u32 s69, s74, 7
    s_and_b32 s69, s69, 7
    s_add_u32 s69, s69, 8
    s_lshl_b32 s69, s69, 7
    s_add_u32 s69, s69, s72
    s_add_u32 m0, s45, 8192
    s_add_u32 s68, s69, 0
    buffer_load_dwordx4 v1, s[52:55], s68 offen lds
    v_mfma_f32_32x32x16_bf16 v[128:143], v[48:51], v[44:47], v[128:143]
    s_add_u32 m0, s45, 9216
    s_add_u32 s68, s69, 65536
    buffer_load_dwordx4 v2, s[52:55], s68 offen lds
    v_mfma_f32_32x32x16_bf16 v[112:127], v[52:55], v[40:43], v[112:127]
    s_add_u32 m0, s45, 10240
    s_add_u32 s68, s69, 131072
    buffer_load_dwordx4 v1, s[52:55], s68 offen lds
    v_mfma_f32_32x32x16_bf16 v[144:159], v[52:55], v[44:47], v[144:159]
    s_add_u32 m0, s45, 11264
    s_add_u32 s68, s69, 196608
    buffer_load_dwordx4 v2, s[52:55], s68 offen lds
    ds_read_b128 v[40:43], v5 offset:24576
    ds_read_b128 v[44:47], v5 offset:28672
    ds_read_b64_tr_b16 v[48:49], v8 offset:2048
    ds_read_b64_tr_b16 v[50:51], v8 offset:2560
    ds_read_b64_tr_b16 v[52:53], v9 offset:2048
    ds_read_b64_tr_b16 v[54:55], v9 offset:2560
    s_waitcnt lgkmcnt(6)
    v_mfma_f32_32x32x16_bf16 v[96:111], v[32:35], v[24:27], v[96:111]
    s_add_u32 m0, s45, 12288
    s_add_u32 s68, s69, 262144
    buffer_load_dwordx4 v1, s[52:55], s68 offen lds
    v_mfma_f32_32x32x16_bf16 v[128:143], v[32:35], v[28:31], v[128:143]
    s_add_u32 m0, s45, 13312
    s_add_u32 s68, s69, 327680
    buffer_load_dwordx4 v2, s[52:55], s68 offen lds
    v_mfma_f32_32x32x16_bf16 v[112:127], v[36:39], v[24:27], v[112:127]
    s_add_u32 m0, s45, 14336
    s_add_u32 s68, s69, 393216
    buffer_load_dwordx4 v1, s[52:55], s68 offen lds
    v_mfma_f32_32x32x16_bf16 v[144:159], v[36:39], v[28:31], v[144:159]
    s_add_u32 m0, s45, 15360
    s_add_u32 s68, s69, 458752
    buffer_load_dwordx4 v2, s[52:55], s68 offen lds
    ds_read_b128 v[24:27], v6 offset:24576
    ds_read_b128 v[28:31], v6 offset:28672
    ds_read_b64_tr_b16 v[32:33], v8 offset:4096
    ds_read_b64_tr_b16 v[34:35], v8 offset:4608
    ds_read_b64_tr_b16 v[36:37], v9 offset:4096
    ds_read_b64_tr_b16 v[38:39], v9 offset:4608
    s_waitcnt lgkmcnt(6)
    v_mfma_f32_32x32x16_bf16 v[96:111], v[48:51], v[40:43], v[96:111]
    v_mfma_f32_32x32x16_bf16 v[128:143], v[48:51], v[44:47], v[128:143]
    v_mfma_f32_32x32x16_bf16 v[112:127], v[52:55], v[40:43], v[112:127]
    v_mfma_f32_32x32x16_bf16 v[144:159], v[52:55], v[44:47], v[144:159]
    ds_read_b128 v[40:43], v7 offset:24576
    ds_read_b128 v[44:47], v7 offset:28672
    ds_read_b64_tr_b16 v[48:49], v8 offset:6144
    ds_read_b64_tr_b16 v[50:51], v8 offset:6656
    ds_read_b64_tr_b16 v[52:53], v9 offset:6144
    ds_read_b64_tr_b16 v[54:55], v9 offset:6656
    s_waitcnt lgkmcnt(6)
    v_mfma_f32_32x32x16_bf16 v[96:111], v[32:35], v[24:27], v[96:111]
    v_mfma_f32_32x32x16_bf16 v[128:143], v[32:35], v[28:31], v[128:143]
    v_mfma_f32_32x32x16_bf16 v[112:127], v[36:39], v[24:27], v[112:127]
    v_mfma_f32_32x32x16_bf16 v[144:159], v[36:39], v[28:31], v[144:159]
    s_waitcnt vmcnt(0)
    ds_read_b128 v[24:27], v4 offset:8192
    ds_read_b128 v[28:31], v4 offset:12288
    ds_read_b64_tr_b16 v[32:33], v8 offset:16384
    ds_read_b64_tr_b16 v[34:35], v8 offset:16896
    ds_read_b64_tr_b16 v[36:37], v9 offset:16384
    ds_read_b64_tr_b16 v[38:39], v9 offset:16896
    s_waitcnt lgkmcnt(6)
    v_mfma_f32_32x32x16_bf16 v[96:111], v[48:51], v[40:43], v[96:111]
    v_mfma_f32_32x32x16_bf16 v[128:143], v[48:51], v[44:47], v[128:143]
    v_mfma_f32_32x32x16_bf16 v[112:127], v[52:55], v[40:43], v[112:127]
    v_mfma_f32_32x32x16_bf16 v[144:159], v[52:55], v[44:47], v[144:159]
    ds_read_b128 v[40:43], v5 offset:8192
    ds_read_b128 v[44:47], v5 offset:12288
    ds_read_b64_tr_b16 v[48:49], v8 offset:18432
    ds_read_b64_tr_b16 v[50:51], v8 offset:18944
    ds_read_b64_tr_b16 v[52:53], v9 offset:18432
    ds_read_b64_tr_b16 v[54:55], v9 offset:18944
    s_waitcnt lgkmcnt(6)
    v_mfma_f32_32x32x16_bf16 v[96:111], v[32:35], v[24:27], v[96:111]
    v_mfma_f32_32x32x16_bf16 v[128:143], v[32:35], v[28:31], v[128:143]
    v_mfma_f32_32x32x16_bf16 v[112:127], v[36:39], v[24:27], v[112:127]
    v_mfma_f32_32x32x16_bf16 v[144:159], v[36:39], v[28:31], v[144:159]
    ds_read_b128 v[24:27], v6 offset:8192
    ds_read_b128 v[28:31], v6 offset:12288
    ds_read_b64_tr_b16 v[32:33], v8 offset:20480
    ds_read_b64_tr_b16 v[34:35], v8 offset:20992
    ds_read_b64_tr_b16 v[36:37], v9 offset:20480
    ds_read_b64_tr_b16 v[38:39], v9 offset:20992
    s_waitcnt lgkmcnt(6)
    v_mfma_f32_32x32x16_bf16 v[96:111], v[48:51], v[40:43], v[96:111]
    v_mfma_f32_32x32x16_bf16 v[128:143], v[48:51], v[44:47], v[128:143]
    v_mfma_f32_32x32x16_bf16 v[112:127], v[52:55], v[40:43], v[112:127]
    v_mfma_f32_32x32x16_bf16 v[144:159], v[52:55], v[44:47], v[144:159]
    ds_read_b128 v[40:43], v7 offset:8192
    ds_read_b128 v[44:47], v7 offset:12288
    ds_read_b64_tr_b16 v[48:49], v8 offset:22528
    ds_read_b64_tr_b16 v[50:51], v8 offset:23040
    ds_read_b64_tr_b16 v[52:53], v9 offset:22528
    ds_read_b64_tr_b16 v[54:55], v9 offset:23040
    s_waitcnt lgkmcnt(6)
    v_mfma_f32_32x32x16_bf16 v[96:111], v[32:35], v[24:27], v[96:111]
    v_mfma_f32_32x32x16_bf16 v[128:143], v[32:35], v[28:31], v[128:143]
    v_mfma_f32_32x32x16_bf16 v[112:127], v[36:39], v[24:27], v[112:127]
    v_mfma_f32_32x32x16_bf16 v[144:159], v[36:39], v[28:31], v[144:159]
    s_waitcnt lgkmcnt(0)
    v_mfma_f32_32x32x16_bf16 v[96:111], v[48:51], v[40:43], v[96:111]
    v_mfma_f32_32x32x16_bf16 v[128:143], v[48:51], v[44:47], v[128:143]
    v_mfma_f32_32x32x16_bf16 v[112:127], v[52:55], v[40:43], v[112:127]
    v_mfma_f32_32x32x16_bf16 v[144:159], v[52:55], v[44:47], v[144:159]
    s_nop 15
    v_add_u32 v12, s45, v10
    ds_write_b128 v12, v[96:99] offset:0
    ds_write_b128 v12, v[100:103] offset:1024
    ds_write_b128 v12, v[104:107] offset:2048
    ds_write_b128 v12, v[108:111] offset:3072
    ds_write_b128 v12, v[112:115] offset:4096
    ds_write_b128 v12, v[116:119] offset:5120
    ds_write_b128 v12, v[120:123] offset:6144
    ds_write_b128 v12, v[124:127] offset:7168
    ds_write_b128 v12, v[128:131] offset:8192
    ds_write_b128 v12, v[132:135] offset:9216
    ds_write_b128 v12, v[136:139] offset:10240
    ds_write_b128 v12, v[140:143] offset:11264
    ds_write_b128 v12, v[144:147] offset:12288
    ds_write_b128 v12, v[148:151] offset:13312
    ds_write_b128 v12, v[152:155] offset:14336
    ds_write_b128 v12, v[156:159] offset:15360
    s_waitcnt lgkmcnt(0)
    s_barrier
    s_lshl_b32 s68, s3, 12
    v_add_u32 v12, s68, v10
    v_add_u32 v13, 81920, v12
    ds_read_b128 v[80:83], v12 offset:0
    ds_read_b128 v[84:87], v12 offset:1024
    ds_read_b128 v[88:91], v12 offset:2048
    ds_read_b128 v[92:95], v12 offset:3072
    ds_read_b128 v[24:27], v12 offset:40960
    ds_read_b128 v[28:31], v12 offset:41984
    ds_read_b128 v[32:35], v12 offset:43008
    ds_read_b128 v[36:39], v12 offset:44032
    ds_read_b128 v[40:43], v13 offset:0
    ds_read_b128 v[44:47], v13 offset:1024
    ds_read_b128 v[48:51], v13 offset:2048
    ds_read_b128 v[52:55], v13 offset:3072
    ds_read_b128 v[56:59], v13 offset:40960
    ds_read_b128 v[60:63], v13 offset:41984
    ds_read_b128 v[64:67], v13 offset:43008
    ds_read_b128 v[68:71], v13 offset:44032
    s_waitcnt lgkmcnt(0)
    v_add_f32 v80, v80, v24
    v_add_f32 v81, v81, v25
    v_add_f32 v82, v82, v26
    v_add_f32 v83, v83, v27
    v_add_f32 v84, v84, v28
    v_add_f32 v85, v85, v29
    v_add_f32 v86, v86, v30
    v_add_f32 v87, v87, v31
    v_add_f32 v88, v88, v32
    v_add_f32 v89, v89, v33
    v_add_f32 v90, v90, v34
    v_add_f32 v91, v91, v35
    v_add_f32 v92, v92, v36
    v_add_f32 v93, v93, v37
    v_add_f32 v94, v94, v38
    v_add_f32 v95, v95, v39
    v_add_f32 v80, v80, v40
    v_add_f32 v81, v81, v41
    v_add_f32 v82, v82, v42
    v_add_f32 v83, v83, v43
    v_add_f32 v84, v84, v44
    v_add_f32 v85, v85, v45
    v_add_f32 v86, v86, v46
    v_add_f32 v87, v87, v47
    v_add_f32 v88, v88, v48
    v_add_f32 v89, v89, v49
    v_add_f32 v90, v90, v50
    v_add_f32 v91, v91, v51
    v_add_f32 v92, v92, v52
    v_add_f32 v93, v93, v53
    v_add_f32 v94, v94, v54
    v_add_f32 v95, v95, v55
    v_add_f32 v80, v80, v56
    v_add_f32 v81, v81, v57
    v_add_f32 v82, v82, v58
    v_add_f32 v83, v83, v59
    v_add_f32 v84, v84, v60
    v_add_f32 v85, v85, v61
    v_add_f32 v86, v86, v62
    v_add_f32 v87, v87, v63
    v_add_f32 v88, v88, v64
    v_add_f32 v89, v89, v65
    v_add_f32 v90, v90, v66
    v_add_f32 v91, v91, v67
    v_add_f32 v92, v92, v68
    v_add_f32 v93, v93, v69
    v_add_f32 v94, v94, v70
    v_add_f32 v95, v95, v71
    v_cvt_pk_bf16_f32 v24, v80, v81
    v_cvt_pk_bf16_f32 v25, v82, v83
    v_cvt_pk_bf16_f32 v26, v84, v85
    v_cvt_pk_bf16_f32 v27, v86, v87
    v_cvt_pk_bf16_f32 v28, v88, v89
    v_cvt_pk_bf16_f32 v29, v90, v91
    v_cvt_pk_bf16_f32 v30, v92, v93
    v_cvt_pk_bf16_f32 v31, v94, v95
    buffer_store_dwordx4 v[24:27], v11, s[60:63], 0 offen
    buffer_store_dwordx4 v[28:31], v11, s[60:63], 0 offen offset:16
L_fin:
L_end:
    s_endpgm
.section .rodata,"a"
.p2align 6
.amdhsa_kernel concat_heads__gqa_block_cached__mha_block_cached__near_ridge_kernel
  .amdhsa_next_free_vgpr 512
  .amdhsa_next_free_sgpr 102
  .amdhsa_accum_offset 256
  .amdhsa_group_segment_fixed_size 0
  .amdhsa_kernarg_size 104
  .amdhsa_user_sgpr_count 2
  .amdhsa_user_sgpr_kernarg_segment_ptr 1
  .amdhsa_system_sgpr_workgroup_id_x 1
.end_amdhsa_kernel
```
